```python
import torch

def _softmax(x, axis=-1):
    return torch.softmax(x, dim=axis)
def _gelu(x):
    return torch.nn.functional.gelu(x, approximate="tanh")
def _silu(x):
    return torch.nn.functional.silu(x)
def _sigmoid(x):
    return torch.sigmoid(x)
def _layernorm(x, axis=-1, eps=1e-5):
    m = x.mean(dim=axis, keepdim=True)
    v = x.var(dim=axis, keepdim=True, unbiased=False)
    return (x - m) / torch.sqrt(v + eps)
def _scatter_add(tgt, idx, src, axis=0):
    return tgt.clone().index_add_(axis, idx, src)
def _segment_sum(src, seg, n):
    out = torch.zeros((n,) + src.shape[1:], dtype=src.dtype)
    return out.index_add_(0, seg, src)
def _pad(x, pw):
    flat = tuple(v for pair in reversed(pw) for v in pair)
    return torch.nn.functional.pad(x, flat)

kernel_name = 'interleave_layers__linear_attn_block__sliding_block__prompt'

def setup_inputs():

    _w = (lambda a: (lambda t: t.to(torch.bfloat16) if t.is_floating_point() else t)(torch.as_tensor(a)))
    def _A_setup():
        B, S, D = 1, 2048, 512
        return {
            "x": _w((lambda *s: torch.randn(*s, dtype=torch.bfloat16) * 0.05)(B, S, D)),
            "wqkv": _w((lambda *s: torch.randn(*s, dtype=torch.bfloat16) * 0.05)(D, 3 * D)),
            "wo": _w((lambda *s: torch.randn(*s, dtype=torch.bfloat16) * 0.05)(D, D)),
        }
    _A_in = _A_setup()

    def _B_setup():
        B, S, D = 1, 2048, 512
        return {
            "x": _w((lambda *s: torch.randn(*s, dtype=torch.bfloat16) * 0.05)(B, S, D)),
            "wqkv": _w((lambda *s: torch.randn(*s, dtype=torch.bfloat16) * 0.1)(D, 3 * D)),
            "wo": _w((lambda *s: torch.randn(*s, dtype=torch.bfloat16) * 0.05)(D, D)),
        }
    _B_in = _B_setup()

    return {
        "A_x": _A_in["x"],
        "A_wqkv": _A_in["wqkv"],
        "A_wo": _A_in["wo"],
        "B_x": _B_in["x"],
        "B_wqkv": _B_in["wqkv"],
        "B_wo": _B_in["wo"],
    }

def reference(A_x, A_wqkv, A_wo, B_x, B_wqkv, B_wo):
    def _A_ref(x, wqkv, wo):
        B, S, D = x.shape
        H = 32; Dh = D // H
        qkv = (lambda x, *d: x.permute(*d))((x @ wqkv).reshape(B, S, 3, H, Dh), 2, 0, 3, 1, 4)
        q, k, v = qkv[0], qkv[1], qkv[2]
        phi = lambda t: torch.where(t > 0, t + 1, torch.exp(t)) + 1e-6
        pq, pk = phi(q), phi(k)
        kv = torch.einsum("bhsd,bhse->bhde", pk, v)
        z = torch.einsum("bhsd->bhd", pk)
        num = torch.einsum("bhqd,bhde->bhqe", pq, kv)
        den = torch.einsum("bhqd,bhd->bhq", pq, z)[..., None] + 1e-6
        o = num / den
        return (lambda x, *d: x.permute(*d))(o, 0, 2, 1, 3).reshape(B, S, D) @ wo

    def _B_ref(x, wqkv, wo):
        B, S, D = x.shape
        H = 32; Dh = D // H; W = 256
        qkv = (lambda x, *d: x.permute(*d))((x @ wqkv).reshape(B, S, 3, H, Dh), 2, 0, 3, 1, 4)
        q, k, v = qkv[0], qkv[1], qkv[2]
        scores = torch.einsum("bhqd,bhkd->bhqk", q, k) * (Dh ** -0.5)
        idx = torch.arange(S)
        mask = (idx[:, None] - idx[None, :] >= 0) & (idx[:, None] - idx[None, :] < W)
        scores = torch.where(mask[None, None], scores, -1e9)
        p = _softmax(scores, axis=-1)
        o = torch.einsum("bhqk,bhkd->bhqd", p, v)
        return (lambda x, *d: x.permute(*d))(o, 0, 2, 1, 3).reshape(B, S, D) @ wo

    x = A_x
    x = x + _A_ref(_layernorm(x, axis=-1), A_wqkv, A_wo)
    x = x + _B_ref(_layernorm(x, axis=-1), B_wqkv, B_wo)
    x = x + _A_ref(_layernorm(x, axis=-1), A_wqkv, A_wo)
    x = x + _B_ref(_layernorm(x, axis=-1), B_wqkv, B_wo)
    return x
```

```asm
; @launch grid=(256,1,1) block=(256,1,1) lds=163840
.amdgcn_target "amdgcn-amd-amdhsa--gfx950"
.text
.globl interleave_layers__linear_attn_block__sliding_block__prompt_kernel
.p2align 8
.type interleave_layers__linear_attn_block__sliding_block__prompt_kernel,@function
interleave_layers__linear_attn_block__sliding_block__prompt_kernel:
    s_cmpk_ge_u32 s2, 0x100
    s_cbranch_scc1 L_end
    s_load_dwordx2 s[24:25], s[0:1], 64
    s_load_dwordx16 s[32:47], s[0:1], 0
    s_getpc_b64 s[96:97]
L_pc:
    s_lshr_b32 s3, s2, 3
    s_lshl_b32 s98, s3, 11
    v_readfirstlane_b32 s64, v0
    v_lshl_add_u32 v15, v0, 3, s98
    global_load_dword v254, v15, s[96:97]
    v_and_b32 v0, 63, v0
    s_lshr_b32 s64, s64, 6
    s_and_b32 s65, s2, 7
    s_lshr_b32 s75, s3, 4
    s_lshl1_add_u32 s65, s65, s75
    s_and_b32 s66, s3, 15
    s_lshl2_add_u32 s67, s65, s64
    s_and_b32 s3, s3, 1
    s_lshl1_add_u32 s75, s75, s3
    v_lshlrev_b32 v1, 4, v0
    s_lshl4_add_u32 s83, s67, s66
    s_lshl_b32 s83, s83, 11
    v_lshrrev_b32 v12, 2, v0
    v_and_b32 v13, 3, v0
    v_mul_u32_u24 v18, 3072, v12
    v_lshl_add_u32 v18, v13, 4, v18
    s_lshl2_add_u32 s82, s75, s64
    s_mulk_i32 s82, 1536
    s_add_u32 s82, s82, s66
    s_addk_i32 s82, 16
    s_lshl_b32 s82, s82, 6
    s_lshl_b32 m0, s64, 11
    v_lshlrev_b32 v9, 7, v0
    s_lshl4_add_u32 s81, s67, s66
    s_lshl_b32 s80, s81, 9
    s_mulk_i32 s81, 1536
    s_lshl_b32 s18, 1, 19
    s_mov_b32 s19, 0x20000
    s_lshl_b32 s6, 1, 21
    s_mov_b32 s7, 0x20000
    s_lshl_b32 s10, 3, 19
    s_mov_b32 s11, s7
    s_waitcnt lgkmcnt(0)
    s_load_dword s68, s[24:25], 0
    s_mov_b64 s[4:5], s[32:33]
    s_mov_b64 s[8:9], s[34:35]
    buffer_load_dwordx4 v[80:83], v1, s[4:7], s83 offen
    buffer_load_dwordx4 v[84:87], v1, s[4:7], s83 offen offset:1024
    s_mov_b64 exec, 0xfff
    buffer_load_dword a255, v9, s[8:11], s81 offen
    s_mov_b64 s[16:17], s[36:37]
    s_mov_b64 exec, 15
    buffer_load_dword a255, v9, s[16:19], s80 offen
    s_mov_b64 exec, -1
    buffer_load_dwordx4 v18, s[8:11], s82 offen lds
L_first:
    s_mul_i32 s34, s64, 98304
    s_lshl_b32 s35, s66, 6
    s_add_u32 s34, s34, s35
    v_lshlrev_b32 v9, 7, v0
    v_add_u32 v18, s34, v18
    v_mov_b32 v71, v15
    v_lshrrev_b32 v12, 4, v0
    v_and_b32 v13, 15, v0
    v_xor_b32 v13, v13, v12
    v_lshlrev_b32 v13, 4, v13
    v_lshl_add_u32 v120, v12, 10, v13
    s_lshl_b32 s70, s67, 15
    v_add_u32 v120, s70, v120
    v_xor_b32 v121, 64, v120
    v_xor_b32 v122, 128, v120
    v_xor_b32 v123, 192, v120
    s_lshl_b32 s77, s64, 11
    s_lshl_b32 s89, s64, 13
    s_add_u32 s0, s75, 0
    s_and_b32 s0, s0, 3
    s_lshl_b32 s0, s0, 13
    s_mul_i32 s48, s0, 48
    s_lshr_b32 s52, s0, 5
    s_add_u32 s1, s75, 1
    s_and_b32 s1, s1, 3
    s_lshl_b32 s1, s1, 13
    s_mul_i32 s49, s1, 48
    s_lshr_b32 s53, s1, 5
    s_add_u32 s2, s75, 2
    s_and_b32 s2, s2, 3
    s_lshl_b32 s2, s2, 13
    s_mul_i32 s50, s2, 48
    s_lshr_b32 s54, s2, 5
    s_add_u32 s3, s75, 3
    s_and_b32 s3, s3, 3
    s_lshl_b32 s3, s3, 13
    s_mul_i32 s51, s3, 48
    s_lshr_b32 s55, s3, 5
    s_add_u32 m0, s89, 98304
    s_add_u32 s93, s52, 0
    buffer_load_dwordx4 v120, s[4:7], s93 offen lds
    s_add_u32 m0, s89, 99328
    s_add_u32 s93, s52, 4096
    buffer_load_dwordx4 v121, s[4:7], s93 offen lds
    s_add_u32 m0, s89, 100352
    s_add_u32 s93, s52, 8192
    buffer_load_dwordx4 v122, s[4:7], s93 offen lds
    s_add_u32 m0, s89, 101376
    s_add_u32 s93, s52, 12288
    buffer_load_dwordx4 v123, s[4:7], s93 offen lds
    s_add_u32 m0, s77, 1024
    s_add_u32 s93, s48, 50176
    buffer_load_dwordx4 v18, s[8:11], s93 offen lds
    s_add_u32 m0, s77, 32768
    s_add_u32 s93, s48, 2048
    buffer_load_dwordx4 v18, s[8:11], s93 offen lds
    s_add_u32 m0, s77, 33792
    s_add_u32 s93, s48, 51200
    buffer_load_dwordx4 v18, s[8:11], s93 offen lds
    s_mov_b64 s[16:17], s[36:37]
    s_mov_b64 s[12:13], s[40:41]
    s_mov_b64 s[20:21], s[42:43]
    s_mov_b64 s[28:29], s[44:45]
    s_mov_b64 s[32:33], s[24:25]
    s_mov_b32 s14, 0x180000
    s_mov_b32 s15, s7
    s_mov_b32 s18, 0x80000
    s_mov_b32 s19, s7
    s_mov_b32 s22, 0x80000
    s_mov_b32 s23, s7
    s_mov_b32 s26, 0x10000000
    s_mov_b32 s27, s7
    s_mov_b32 s30, 0x200000
    s_mov_b32 s31, s7
    s_mov_b32 s34, 0xec00000
    s_mov_b32 s35, s7
    s_mov_b32 s98, 0
    v_lshrrev_b32 v12, 5, v0
    v_lshlrev_b32 v2, 9, v12
    v_bfe_u32 v13, v0, 2, 2
    v_lshl_add_u32 v2, v13, 6, v2
    v_bfe_u32 v13, v0, 4, 1
    v_lshl_add_u32 v2, v13, 5, v2
    v_bfe_u32 v13, v0, 0, 1
    v_lshl_add_u32 v2, v13, 4, v2
    v_bfe_u32 v13, v0, 1, 1
    v_lshl_add_u32 v2, v13, 3, v2
    v_add_u32 v3, 0x10000, v2
    v_add_u32 v4, s77, v1
    v_add_u32 v5, 0x10000, v4
    v_add_u32 v11, 131072, v1
    v_add_u32 v19, s77, v5
    s_lshl_b32 s91, s64, 7
    s_add_u32 s91, s91, 162816
    v_and_b32 v13, 31, v0
    v_lshlrev_b32 v6, 2, v13
    v_lshl_add_u32 v10, v12, 4, s91
    v_and_b32 v15, 15, v0
    v_xor_b32 v15, v15, v12
    v_lshlrev_b32 v15, 4, v15
    v_lshl_add_u32 v15, v13, 8, v15
    s_add_u32 s91, s89, 65536
    v_add_u32 v112, s91, v15
    v_xor_b32 v113, 32, v112
    v_xor_b32 v114, 64, v112
    v_xor_b32 v115, 96, v112
    v_xor_b32 v116, 128, v112
    v_xor_b32 v117, 160, v112
    v_xor_b32 v118, 192, v112
    v_xor_b32 v119, 224, v112
    v_mov_b32 v16, 0x3f803f80
    s_mov_b32 s92, 0xf0f00f0f
    s_mov_b32 s93, s92
    v_mov_b32 v25, 0x3f803f80
    v_cndmask_b32_e64 v24, 0, v25, s[92:93]
    v_mov_b32 v25, v24
    v_mov_b32 v26, v24
    v_mov_b32 v27, v24
    s_getreg_b32 s86, hwreg(HW_REG_XCC_ID, 0, 4)
    s_lshl_b32 s87, s67, 11
    s_add_u32 s87, s87, 327680
    s_lshl_b32 s84, s66, 7
    s_add_u32 s84, s84, s87
    v_lshrrev_b32 v15, 2, v0
    v_and_or_b32 v15, v0, 3, v15
    v_lshlrev_b32 v15, 3, v15
    v_lshrrev_b32 v14, 1, v13
    v_lshl_add_u32 v14, v14, 1, v12
    v_and_b32 v13, 1, v13
    v_lshl_add_u32 v14, v14, 1, v13
    v_add_u32 v13, s77, v2
    v_mov_b32 v96, 0
    v_mov_b32 v97, 0
    v_mov_b32 v98, 0
    v_mov_b32 v99, 0
    s_mov_b64 exec, 0
    s_cmp_eq_u32 s64, 0
    s_cbranch_scc1 L_pad0
    s_cmp_eq_u32 s64, 1
    s_cbranch_scc1 L_pad3
    s_cmp_eq_u32 s64, 2
    s_cbranch_scc1 L_pad6
    s_branch L_pad9
.p2align 12
L_wback:
    s_mov_b64 exec, -1
    s_mov_b32 s11, 0x20000
    s_mov_b32 s15, 0x20000
    s_mov_b32 s19, 0x20000
    s_waitcnt vmcnt(10)
    v_dot2c_f32_bf16 v96, v80, v16
    v_dot2c_f32_bf16 v97, v80, v80
    v_dot2c_f32_bf16 v98, v84, v16
    v_dot2c_f32_bf16 v99, v84, v84
    v_dot2c_f32_bf16 v96, v81, v16
    v_dot2c_f32_bf16 v97, v81, v81
    v_dot2c_f32_bf16 v98, v85, v16
    v_dot2c_f32_bf16 v99, v85, v85
    v_dot2c_f32_bf16 v96, v82, v16
    v_dot2c_f32_bf16 v97, v82, v82
    v_dot2c_f32_bf16 v98, v86, v16
    v_dot2c_f32_bf16 v99, v86, v86
    v_dot2c_f32_bf16 v96, v83, v16
    v_dot2c_f32_bf16 v97, v83, v83
    v_dot2c_f32_bf16 v98, v87, v16
    v_dot2c_f32_bf16 v99, v87, v87
    s_nop 0
    v_permlane32_swap_b32 v96, v97
    s_nop 0
    v_permlane32_swap_b32 v98, v99
    v_add_f32 v96, v96, v97
    v_add_f32 v98, v98, v99
    s_nop 1
    v_permlane16_swap_b32 v96, v98
    v_add_f32 v96, v96, v98
    s_nop 1
    v_add_f32_dpp v96, v96, v96 row_ror:8 row_mask:0xf bank_mask:0xf
    s_nop 1
    v_add_f32_dpp v96, v96, v96 row_ror:4 row_mask:0xf bank_mask:0xf
    s_nop 1
    v_add_f32_dpp v96, v96, v96 row_ror:2 row_mask:0xf bank_mask:0xf
    s_nop 1
    v_add_f32_dpp v96, v96, v96 row_ror:1 row_mask:0xf bank_mask:0xf
    s_waitcnt lgkmcnt(0)
    s_add_u32 s68, s68, 0x9e3779b9
    s_add_u32 s85, s68, 32
    s_add_u32 s91, s85, s86
    v_mov_b32 v97, s91
    s_mov_b32 exec_lo, 0xf000f
    s_mov_b32 exec_hi, 0xf000f
    buffer_store_dwordx2 v[96:97], v15, s[24:27], s84 offen sc1
    s_mov_b64 exec, -1
    v_lshlrev_b32 v16, 5, v14
    s_add_u32 m0, s89, 102400
    s_add_u32 s93, s52, 16384
    buffer_load_dwordx4 v120, s[4:7], s93 offen lds
    s_add_u32 m0, s89, 103424
    s_add_u32 s93, s52, 20480
    buffer_load_dwordx4 v121, s[4:7], s93 offen lds
    s_add_u32 m0, s89, 104448
    s_add_u32 s93, s52, 24576
    buffer_load_dwordx4 v122, s[4:7], s93 offen lds
    s_add_u32 m0, s89, 105472
    s_add_u32 s93, s52, 28672
    buffer_load_dwordx4 v123, s[4:7], s93 offen lds
    s_add_u32 m0, s89, 65536
    s_add_u32 s93, s53, 0
    buffer_load_dwordx4 v120, s[4:7], s93 offen lds
    s_add_u32 m0, s89, 66560
    s_add_u32 s93, s53, 4096
    buffer_load_dwordx4 v121, s[4:7], s93 offen lds
    s_add_u32 m0, s89, 67584
    s_add_u32 s93, s53, 8192
    buffer_load_dwordx4 v122, s[4:7], s93 offen lds
    s_add_u32 m0, s89, 68608
    s_add_u32 s93, s53, 12288
    buffer_load_dwordx4 v123, s[4:7], s93 offen lds
    s_cmp_ge_u32 s65, 12
    s_cselect_b64 vcc, -1, 0
    s_cselect_b64 s[12:13], s[20:21], s[12:13]
    s_cselect_b32 s14, s22, s14
    s_cselect_b32 s92, 1024, 0
    s_cselect_b32 s93, 0, 3072
    s_or_b32 s93, s93, s92
    v_lshrrev_b32 v64, 2, v0
    v_and_b32 v65, 3, v0
    v_lshlrev_b32 v65, 4, v65
    v_mad_u32_u24 v68, v64, s93, v65
    s_and_b32 s92, s65, 3
    s_lshl2_add_u32 s91, s92, s64
    s_lshl_b32 s91, s91, 5
    s_mul_i32 s91, s91, s93
    s_lshl_b32 s90, s93, 4
    s_lshr_b32 s93, s65, 2
    s_add_u32 s93, s93, 1
    s_cmp_ge_u32 s93, 3
    s_cselect_b32 s93, 0, s93
    s_lshl4_add_u32 s93, s93, s66
    s_lshl_b32 s93, s93, 6
    s_add_u32 s88, s91, s93
    s_add_u32 s90, s90, s88
    s_mul_i32 s91, s66, 12
    s_add_u32 s91, s91, s65
    s_lshl_b32 s91, s91, 13
    s_add_u32 s91, s91, 18874368
    v_add_u32 v69, s91, v4
    s_lshr_b32 s91, s66, 1
    s_lshl2_add_u32 s91, s91, s92
    s_lshl2_add_u32 s91, s91, s64
    s_and_b32 s92, s66, 1
    s_lshl1_add_u32 s91, s91, s92
    s_lshl_b32 s91, s91, 11
    s_add_u32 s91, s91, 20447232
    v_add_u32 v64, s91, v1
    v_cndmask_b32 v69, v69, v64, vcc
    v_lshrrev_b32 v64, 4, v0
    v_bfe_u32 v65, v0, 2, 2
    v_lshl_add_u32 v64, v64, 3, v65
    v_and_b32 v65, 3, v0
    v_lshl_add_u32 v64, v64, 3, v65
    v_lshlrev_b32 v64, 3, v64
    v_cndmask_b32 v64, v2, v64, vcc
    s_add_u32 s91, s77, 148480
    v_add_u32 v66, s91, v64
    s_cmp_ge_u32 s65, 12
    s_cselect_b32 s91, 32, 1024
    v_add_u32 v67, s91, v66
    v_add_u32 v70, s77, v11
    s_add_u32 m0, s89, 69632
    s_add_u32 s93, s53, 16384
    buffer_load_dwordx4 v120, s[4:7], s93 offen lds
    s_add_u32 m0, s89, 70656
    s_add_u32 s93, s53, 20480
    buffer_load_dwordx4 v121, s[4:7], s93 offen lds
    s_add_u32 m0, s89, 71680
    s_add_u32 s93, s53, 24576
    buffer_load_dwordx4 v122, s[4:7], s93 offen lds
    s_add_u32 m0, s89, 72704
    s_add_u32 s93, s53, 28672
    buffer_load_dwordx4 v123, s[4:7], s93 offen lds
    s_add_u32 m0, s77, 8192
    s_add_u32 s93, s49, 1024
    buffer_load_dwordx4 v18, s[8:11], s93 offen lds
    s_add_u32 m0, s77, 9216
    s_add_u32 s93, s49, 50176
    buffer_load_dwordx4 v18, s[8:11], s93 offen lds
    s_add_u32 m0, s77, 40960
    s_add_u32 s93, s49, 2048
    buffer_load_dwordx4 v18, s[8:11], s93 offen lds
    s_add_u32 m0, s77, 41984
    s_add_u32 s93, s49, 51200
    buffer_load_dwordx4 v18, s[8:11], s93 offen lds
    s_add_u32 m0, s77, 16384
    s_add_u32 s93, s50, 1024
    buffer_load_dwordx4 v18, s[8:11], s93 offen lds
    s_add_u32 m0, s77, 17408
    s_add_u32 s93, s50, 50176
    buffer_load_dwordx4 v18, s[8:11], s93 offen lds
    s_waitcnt vmcnt(14)
    ds_read_b128 v[128:131], v112 offset:32768
    ds_read_b128 v[132:135], v113 offset:32768
    ds_read_b128 v[136:139], v114 offset:32768
    ds_read_b128 v[140:143], v115 offset:32768
    ds_read_b128 v[144:147], v116 offset:32768
    ds_read_b128 v[148:151], v117 offset:32768
    ds_read_b128 v[152:155], v118 offset:32768
    ds_read_b128 v[156:159], v119 offset:32768
    ds_read_b64_tr_b16 a[0:1], v13 offset:0
    ds_read_b64_tr_b16 a[2:3], v13 offset:256
    ds_read_b64_tr_b16 a[32:33], v13 offset:32768
    ds_read_b64_tr_b16 a[34:35], v13 offset:33024
    ds_read_b64_tr_b16 a[4:5], v13 offset:1024
    ds_read_b64_tr_b16 a[6:7], v13 offset:1280
    ds_read_b64_tr_b16 a[36:37], v13 offset:33792
    ds_read_b64_tr_b16 a[38:39], v13 offset:34048
    s_waitcnt lgkmcnt(0)
    s_barrier
    ds_read_b64_tr_b16 v[32:33], v2 offset:0
    ds_read_b64_tr_b16 v[34:35], v2 offset:256
    ds_read_b64_tr_b16 v[48:49], v2 offset:32768
    ds_read_b64_tr_b16 v[50:51], v2 offset:33024
    ds_read_b64_tr_b16 v[36:37], v2 offset:1024
    ds_read_b64_tr_b16 v[38:39], v2 offset:1280
    ds_read_b64_tr_b16 v[52:53], v2 offset:33792
    ds_read_b64_tr_b16 v[54:55], v2 offset:34048
    v_mfma_f32_16x16x32_bf16 v[28:31], v[24:27], a[0:3], 0
    v_mfma_f32_16x16x32_bf16 v[124:127], v[24:27], a[32:35], 0
    v_mfma_f32_16x16x32_bf16 v[28:31], v[24:27], a[4:7], v[28:31]
    v_mfma_f32_16x16x32_bf16 v[124:127], v[24:27], a[36:39], v[124:127]
    s_waitcnt lgkmcnt(4)
    v_mfma_f32_32x32x16_bf16 v[80:95], v[128:131], v[32:35], 0
    ds_read_b64_tr_b16 v[40:41], v2 offset:2048
    ds_read_b64_tr_b16 v[42:43], v2 offset:2304
    ds_read_b64_tr_b16 v[56:57], v2 offset:34816
    ds_read_b64_tr_b16 v[58:59], v2 offset:35072
    v_mfma_f32_32x32x16_bf16 v[96:111], v[128:131], v[48:51], 0
    s_add_u32 m0, s77, 49152
    s_add_u32 s93, s50, 2048
    buffer_load_dwordx4 v18, s[8:11], s93 offen lds
    s_lshr_b32 s92, s64, 1
    s_lshl_b32 s92, s92, 9
    s_and_b32 s93, s64, 1
    s_lshl_b32 s93, s93, 3
    s_add_u32 s92, s92, s93
    s_add_u32 s92, s92, 156672
    v_and_b32 v17, 31, v0
    v_lshl_add_u32 v17, v17, 4, s92
    v_lshrrev_b32 v12, 3, v0
    v_and_b32 v224, 6, v12
    v_xor_b32 v224, v224, v0
    v_and_b32 v224, 7, v224
    v_lshlrev_b32 v224, 4, v224
    v_lshl_add_u32 v224, v12, 10, v224
    v_lshrrev_b32 v12, 5, v0
    v_lshl_add_u32 v12, v12, 12, v224
    s_lshl_b32 s92, s64, 15
    s_lshr_b32 s93, s66, 1
    s_lshl_b32 s93, s93, 7
    s_add_u32 s92, s92, s93
    v_add_u32 v12, s92, v12
    s_waitcnt lgkmcnt(4)
    v_mfma_f32_32x32x16_bf16 v[80:95], v[132:135], v[36:39], v[80:95]
    ds_read_b64_tr_b16 v[44:45], v2 offset:3072
    ds_read_b64_tr_b16 v[46:47], v2 offset:3328
    ds_read_b64_tr_b16 v[60:61], v2 offset:35840
    ds_read_b64_tr_b16 v[62:63], v2 offset:36096
    v_mfma_f32_32x32x16_bf16 v[96:111], v[132:135], v[52:55], v[96:111]
    s_add_u32 m0, s77, 50176
    s_add_u32 s93, s50, 51200
    buffer_load_dwordx4 v18, s[8:11], s93 offen lds
    s_waitcnt lgkmcnt(4)
    v_mfma_f32_32x32x16_bf16 v[80:95], v[136:139], v[40:43], v[80:95]
    ds_read_b64_tr_b16 v[32:33], v2 offset:4096
    ds_read_b64_tr_b16 v[34:35], v2 offset:4352
    ds_read_b64_tr_b16 v[48:49], v2 offset:36864
    ds_read_b64_tr_b16 v[50:51], v2 offset:37120
    v_mfma_f32_32x32x16_bf16 v[96:111], v[136:139], v[56:59], v[96:111]
    buffer_load_dwordx2 v[14:15], v16, s[24:27], s87 offen sc1
    s_mov_b32 s96, 0xffff0000
    s_mov_b32 s97, 0xffff0000
    s_add_u32 s71, s70, 6291456
    s_lshl_b32 s91, s67, 11
    s_add_u32 s72, s91, 524288
    s_lshl_b32 s91, s67, 7
    s_add_u32 s73, s91, 8192
    s_add_u32 s74, s91, 16384
    s_waitcnt lgkmcnt(4)
    v_mfma_f32_32x32x16_bf16 v[80:95], v[140:143], v[44:47], v[80:95]
    ds_read_b64_tr_b16 v[36:37], v2 offset:5120
    ds_read_b64_tr_b16 v[38:39], v2 offset:5376
    ds_read_b64_tr_b16 v[52:53], v2 offset:37888
    ds_read_b64_tr_b16 v[54:55], v2 offset:38144
    v_mfma_f32_32x32x16_bf16 v[96:111], v[140:143], v[60:63], v[96:111]
    buffer_load_dwordx4 v[72:75], v68, s[12:15], s88 offen
    buffer_load_dwordx4 v[76:79], v68, s[12:15], s90 offen
    s_lshl_b32 s47, s64, 12
    s_mul_i32 s91, s66, 98304
    s_add_u32 s91, s91, 18874368
    s_add_u32 s60, s0, s91
    s_add_u32 s61, s1, s91
    s_add_u32 s62, s2, s91
    s_add_u32 s63, s3, s91
    s_waitcnt lgkmcnt(4)
    v_mfma_f32_32x32x16_bf16 v[80:95], v[144:147], v[32:35], v[80:95]
    ds_read_b64_tr_b16 v[40:41], v2 offset:6144
    ds_read_b64_tr_b16 v[42:43], v2 offset:6400
    ds_read_b64_tr_b16 v[56:57], v2 offset:38912
    ds_read_b64_tr_b16 v[58:59], v2 offset:39168
    v_mfma_f32_32x32x16_bf16 v[96:111], v[144:147], v[48:51], v[96:111]
    s_add_u32 m0, s89, 131072
    s_add_u32 s93, s54, 0
    buffer_load_dwordx4 v120, s[4:7], s93 offen lds
    s_lshl_b32 s56, s0, 4
    s_lshl_b32 s57, s1, 4
    s_lshl_b32 s58, s2, 4
    s_lshl_b32 s59, s3, 4
    s_lshl2_add_u32 s46, s66, s64
    s_lshl_b32 s46, s46, 13
    s_add_u32 s46, s46, 1048576
    s_lshl_b32 s44, s65, 9
    s_and_b32 s45, s44, 0x1c00
    s_add_u32 s44, s44, s46
    s_waitcnt lgkmcnt(4)
    v_mfma_f32_32x32x16_bf16 v[80:95], v[148:151], v[36:39], v[80:95]
    ds_read_b64_tr_b16 v[44:45], v2 offset:7168
    ds_read_b64_tr_b16 v[46:47], v2 offset:7424
    ds_read_b64_tr_b16 v[60:61], v2 offset:39936
    ds_read_b64_tr_b16 v[62:63], v2 offset:40192
    v_mfma_f32_32x32x16_bf16 v[96:111], v[148:151], v[52:55], v[96:111]
    s_add_u32 m0, s89, 132096
    s_add_u32 s93, s54, 4096
    buffer_load_dwordx4 v121, s[4:7], s93 offen lds
    s_add_u32 m0, s89, 133120
    s_add_u32 s93, s54, 8192
    buffer_load_dwordx4 v122, s[4:7], s93 offen lds
    s_add_u32 m0, s89, 134144
    s_add_u32 s93, s54, 12288
    buffer_load_dwordx4 v123, s[4:7], s93 offen lds
    s_add_u32 m0, s89, 135168
    s_add_u32 s93, s54, 16384
    buffer_load_dwordx4 v120, s[4:7], s93 offen lds
    s_add_u32 m0, s89, 136192
    s_add_u32 s93, s54, 20480
    buffer_load_dwordx4 v121, s[4:7], s93 offen lds
    s_add_u32 m0, s89, 137216
    s_add_u32 s93, s54, 24576
    buffer_load_dwordx4 v122, s[4:7], s93 offen lds
    s_waitcnt vmcnt(14)
    ds_read_b128 v[160:163], v112 offset:0
    ds_read_b128 v[164:167], v113 offset:0
    ds_read_b128 v[168:171], v114 offset:0
    ds_read_b128 v[172:175], v115 offset:0
    ds_read_b128 v[176:179], v116 offset:0
    ds_read_b128 v[180:183], v117 offset:0
    ds_read_b128 v[184:187], v118 offset:0
    ds_read_b128 v[188:191], v119 offset:0
    ds_read_b64_tr_b16 a[8:9], v13 offset:8192
    ds_read_b64_tr_b16 a[10:11], v13 offset:8448
    ds_read_b64_tr_b16 a[40:41], v13 offset:40960
    ds_read_b64_tr_b16 a[42:43], v13 offset:41216
    ds_read_b64_tr_b16 a[12:13], v13 offset:9216
    ds_read_b64_tr_b16 a[14:15], v13 offset:9472
    ds_read_b64_tr_b16 a[44:45], v13 offset:41984
    ds_read_b64_tr_b16 a[46:47], v13 offset:42240
    s_addk_i32 s45, 1024
    s_and_b32 s45, s45, 0x1c00
    s_add_u32 s36, s45, s46
    s_addk_i32 s45, 1024
    s_and_b32 s45, s45, 0x1c00
    s_add_u32 s37, s45, s46
    s_addk_i32 s45, 1024
    s_and_b32 s45, s45, 0x1c00
    s_add_u32 s38, s45, s46
    s_waitcnt lgkmcnt(15)
    v_mfma_f32_32x32x16_bf16 v[80:95], v[152:155], v[40:43], v[80:95]
    s_waitcnt lgkmcnt(0)
    s_barrier
    ds_read_b64_tr_b16 v[32:33], v2 offset:8192
    ds_read_b64_tr_b16 v[34:35], v2 offset:8448
    ds_read_b64_tr_b16 v[48:49], v2 offset:40960
    ds_read_b64_tr_b16 v[50:51], v2 offset:41216
    v_mfma_f32_32x32x16_bf16 v[96:111], v[152:155], v[56:59], v[96:111]
    s_add_u32 m0, s89, 138240
    s_add_u32 s93, s54, 28672
    buffer_load_dwordx4 v123, s[4:7], s93 offen lds
    v_mfma_f32_16x16x32_bf16 v[28:31], v[24:27], a[8:11], v[28:31]
    v_mfma_f32_16x16x32_bf16 v[124:127], v[24:27], a[40:43], v[124:127]
    v_mfma_f32_16x16x32_bf16 v[28:31], v[24:27], a[12:15], v[28:31]
    v_mfma_f32_16x16x32_bf16 v[124:127], v[24:27], a[44:47], v[124:127]
    s_addk_i32 s45, 1024
    s_and_b32 s45, s45, 0x1c00
    s_add_u32 s39, s45, s46
    s_addk_i32 s45, 1024
    s_and_b32 s45, s45, 0x1c00
    s_add_u32 s40, s45, s46
    v_mfma_f32_32x32x16_bf16 v[80:95], v[156:159], v[44:47], v[80:95]
    ds_read_b64_tr_b16 v[36:37], v2 offset:9216
    ds_read_b64_tr_b16 v[38:39], v2 offset:9472
    ds_read_b64_tr_b16 v[52:53], v2 offset:41984
    ds_read_b64_tr_b16 v[54:55], v2 offset:42240
    v_mfma_f32_32x32x16_bf16 v[96:111], v[156:159], v[60:63], v[96:111]
    s_add_u32 m0, s77, 24576
    s_add_u32 s93, s51, 1024
    buffer_load_dwordx4 v18, s[8:11], s93 offen lds
    s_addk_i32 s45, 1024
    s_and_b32 s45, s45, 0x1c00
    s_add_u32 s41, s45, s46
    s_addk_i32 s45, 1024
    s_and_b32 s45, s45, 0x1c00
    s_add_u32 s42, s45, s46
    s_addk_i32 s45, 1024
    s_and_b32 s45, s45, 0x1c00
    s_add_u32 s43, s45, s46
    s_waitcnt lgkmcnt(4)
    v_mfma_f32_32x32x16_bf16 v[80:95], v[160:163], v[32:35], v[80:95]
    ds_read_b64_tr_b16 v[40:41], v2 offset:10240
    ds_read_b64_tr_b16 v[42:43], v2 offset:10496
    ds_read_b64_tr_b16 v[56:57], v2 offset:43008
    ds_read_b64_tr_b16 v[58:59], v2 offset:43264
    v_mfma_f32_32x32x16_bf16 v[96:111], v[160:163], v[48:51], v[96:111]
    s_add_u32 m0, s77, 25600
    s_add_u32 s93, s51, 50176
    buffer_load_dwordx4 v18, s[8:11], s93 offen lds
    s_lshl_b32 s45, s66, 11
    s_add_u32 s45, s45, s71
    s_lshl3_add_u32 s46, s66, s74
    s_lshr_b32 s91, s64, 1
    s_lshl1_add_u32 s91, s65, s91
    s_and_b32 s92, s66, 1
    s_lshl1_add_u32 s91, s91, s92
    s_lshr_b32 s92, s66, 1
    s_and_b32 s93, s64, 1
    s_lshl_b32 s83, s91, 7
    s_add_u32 s80, s83, s93
    s_lshl_b32 s80, s80, 8
    s_add_u32 s75, s80, 6291456
    s_lshl1_add_u32 s93, s92, s93
    s_lshl3_add_u32 s82, s93, s83
    s_add_u32 s82, s82, 8192
    s_add_u32 s83, s83, 16384
    s_lshl_b32 s93, s92, 12
    s_add_u32 s80, s80, s93
    s_lshr_b32 s93, s92, 2
    s_lshl1_add_u32 s93, s91, s93
    s_lshl_b32 s93, s93, 10
    s_and_b32 s81, s92, 3
    s_lshl2_add_u32 s81, s81, s93
    s_add_u32 s81, s81, 524288
    s_waitcnt lgkmcnt(4)
    v_mfma_f32_32x32x16_bf16 v[80:95], v[164:167], v[36:39], v[80:95]
    ds_read_b64_tr_b16 v[44:45], v2 offset:11264
    ds_read_b64_tr_b16 v[46:47], v2 offset:11520
    ds_read_b64_tr_b16 v[60:61], v2 offset:44032
    ds_read_b64_tr_b16 v[62:63], v2 offset:44288
    v_mfma_f32_32x32x16_bf16 v[96:111], v[164:167], v[52:55], v[96:111]
    s_add_u32 m0, s77, 57344
    s_add_u32 s93, s51, 2048
    buffer_load_dwordx4 v18, s[8:11], s93 offen lds
    s_waitcnt lgkmcnt(4)
    v_mfma_f32_32x32x16_bf16 v[80:95], v[168:171], v[40:43], v[80:95]
    ds_read_b64_tr_b16 v[32:33], v2 offset:12288
    ds_read_b64_tr_b16 v[34:35], v2 offset:12544
    ds_read_b64_tr_b16 v[48:49], v2 offset:45056
    ds_read_b64_tr_b16 v[50:51], v2 offset:45312
    v_mfma_f32_32x32x16_bf16 v[96:111], v[168:171], v[56:59], v[96:111]
    s_add_u32 m0, s77, 58368
    s_add_u32 s93, s51, 51200
    buffer_load_dwordx4 v18, s[8:11], s93 offen lds
    s_waitcnt lgkmcnt(4)
    v_mfma_f32_32x32x16_bf16 v[80:95], v[172:175], v[44:47], v[80:95]
    ds_read_b64_tr_b16 v[36:37], v2 offset:13312
    ds_read_b64_tr_b16 v[38:39], v2 offset:13568
    ds_read_b64_tr_b16 v[52:53], v2 offset:46080
    ds_read_b64_tr_b16 v[54:55], v2 offset:46336
    v_mfma_f32_32x32x16_bf16 v[96:111], v[172:175], v[60:63], v[96:111]
    s_add_u32 m0, s89, 98304
    s_add_u32 s93, s55, 0
    buffer_load_dwordx4 v120, s[4:7], s93 offen lds
    s_mov_b64 s[92:93], 0x101
    v_mov_b32 v229, 0x3f803f80
    v_cndmask_b32_e64 v228, 0, v229, s[92:93]
    v_mov_b32 v229, v228
    v_mov_b32 v230, v228
    v_mov_b32 v231, v228
    v_lshrrev_b32 v232, 3, v0
    v_lshl_add_u32 v232, v232, 10, v1
    v_mov_b32 v233, 0
    s_lshl_b32 s91, s66, 6
    s_add_u32 s91, s91, s67
    s_mul_i32 s91, s91, 4352
    s_add_u32 s91, s91, 8388608
    s_mov_b64 exec, 0xffff
    buffer_store_dwordx4 v[228:231], v232, s[24:27], s91 offen offset:3072 sc1
    s_add_u32 s91, s91, 20971520
    buffer_store_dwordx4 v[228:231], v232, s[24:27], s91 offen offset:3072 sc1
    s_mov_b64 exec, -1
    buffer_store_dword v233, v1, s[24:27], s81 offen
    s_waitcnt lgkmcnt(4)
    v_mfma_f32_32x32x16_bf16 v[80:95], v[176:179], v[32:35], v[80:95]
    ds_read_b64_tr_b16 v[40:41], v2 offset:14336
    ds_read_b64_tr_b16 v[42:43], v2 offset:14592
    ds_read_b64_tr_b16 v[56:57], v2 offset:47104
    ds_read_b64_tr_b16 v[58:59], v2 offset:47360
    v_mfma_f32_32x32x16_bf16 v[96:111], v[176:179], v[48:51], v[96:111]
    s_add_u32 m0, s89, 99328
    s_add_u32 s93, s55, 4096
    buffer_load_dwordx4 v121, s[4:7], s93 offen lds
    s_sub_u32 s91, s83, 16384
    s_lshl_b32 s91, s91, 8
    s_and_b32 s92, s64, 1
    s_lshl_b32 s92, s92, 14
    s_add_u32 s91, s91, s92
    s_lshr_b32 s92, s66, 1
    s_lshl_b32 s92, s92, 7
    s_add_u32 s91, s91, s92
    s_mov_b32 s69, s91
    s_waitcnt lgkmcnt(4)
    v_mfma_f32_32x32x16_bf16 v[80:95], v[180:183], v[36:39], v[80:95]
    ds_read_b64_tr_b16 v[44:45], v2 offset:15360
    ds_read_b64_tr_b16 v[46:47], v2 offset:15616
    ds_read_b64_tr_b16 v[60:61], v2 offset:48128
    ds_read_b64_tr_b16 v[62:63], v2 offset:48384
    v_mfma_f32_32x32x16_bf16 v[96:111], v[180:183], v[52:55], v[96:111]
    s_add_u32 m0, s89, 100352
    s_add_u32 s93, s55, 8192
    buffer_load_dwordx4 v122, s[4:7], s93 offen lds
    s_add_u32 m0, s89, 101376
    s_add_u32 s93, s55, 12288
    buffer_load_dwordx4 v123, s[4:7], s93 offen lds
    s_add_u32 m0, s89, 102400
    s_add_u32 s93, s55, 16384
    buffer_load_dwordx4 v120, s[4:7], s93 offen lds
    s_add_u32 m0, s89, 103424
    s_add_u32 s93, s55, 20480
    buffer_load_dwordx4 v121, s[4:7], s93 offen lds
    s_add_u32 m0, s89, 104448
    s_add_u32 s93, s55, 24576
    buffer_load_dwordx4 v122, s[4:7], s93 offen lds
    v_add_u32 v112, 0x8000, v112
    v_add_u32 v113, 0x8000, v113
    v_add_u32 v114, 0x8000, v114
    v_add_u32 v115, 0x8000, v115
    v_add_u32 v116, 0x8000, v116
    v_add_u32 v117, 0x8000, v117
    v_add_u32 v118, 0x8000, v118
    v_add_u32 v119, 0x8000, v119
    s_waitcnt vmcnt(14)
    ds_read_b128 v[192:195], v112 offset:32768
    ds_read_b128 v[196:199], v113 offset:32768
    ds_read_b128 v[200:203], v114 offset:32768
    ds_read_b128 v[204:207], v115 offset:32768
    ds_read_b128 v[208:211], v116 offset:32768
    ds_read_b128 v[212:215], v117 offset:32768
    ds_read_b128 v[216:219], v118 offset:32768
    ds_read_b128 v[220:223], v119 offset:32768
    ds_read_b64_tr_b16 a[16:17], v13 offset:16384
    ds_read_b64_tr_b16 a[18:19], v13 offset:16640
    ds_read_b64_tr_b16 a[48:49], v13 offset:49152
    ds_read_b64_tr_b16 a[50:51], v13 offset:49408
    ds_read_b64_tr_b16 a[20:21], v13 offset:17408
    ds_read_b64_tr_b16 a[22:23], v13 offset:17664
    ds_read_b64_tr_b16 a[52:53], v13 offset:50176
    ds_read_b64_tr_b16 a[54:55], v13 offset:50432
    v_subrev_u32 v15, s85, v15
    v_cmp_lt_u32 vcc, 15, v15
    s_cbranch_vccnz L_ro_2
L_rb_3:
    v_cmp_ne_u32 vcc, s86, v15
    s_nop 0
    s_cmp_lg_u64 vcc, 0
    s_cselect_b32 s76, 0x2800000, 0
    s_waitcnt lgkmcnt(15)
    v_mfma_f32_32x32x16_bf16 v[80:95], v[184:187], v[40:43], v[80:95]
    s_waitcnt lgkmcnt(0)
    s_barrier
    ds_read_b64_tr_b16 v[32:33], v2 offset:16384
    ds_read_b64_tr_b16 v[34:35], v2 offset:16640
    ds_read_b64_tr_b16 v[48:49], v2 offset:49152
    ds_read_b64_tr_b16 v[50:51], v2 offset:49408
    v_mfma_f32_32x32x16_bf16 v[96:111], v[184:187], v[56:59], v[96:111]
    s_add_u32 m0, s89, 105472
    s_add_u32 s93, s55, 28672
    buffer_load_dwordx4 v123, s[4:7], s93 offen lds
    v_mfma_f32_16x16x32_bf16 v[28:31], v[24:27], a[16:19], v[28:31]
    v_mfma_f32_16x16x32_bf16 v[124:127], v[24:27], a[48:51], v[124:127]
    v_mfma_f32_16x16x32_bf16 v[28:31], v[24:27], a[20:23], v[28:31]
    v_mfma_f32_16x16x32_bf16 v[124:127], v[24:27], a[52:55], v[124:127]
    v_mfma_f32_32x32x16_bf16 v[80:95], v[188:191], v[44:47], v[80:95]
    ds_read_b64_tr_b16 v[36:37], v2 offset:17408
    ds_read_b64_tr_b16 v[38:39], v2 offset:17664
    ds_read_b64_tr_b16 v[52:53], v2 offset:50176
    ds_read_b64_tr_b16 v[54:55], v2 offset:50432
    v_mfma_f32_32x32x16_bf16 v[96:111], v[188:191], v[60:63], v[96:111]
    s_add_u32 m0, s77, 65536
    s_add_u32 s93, s48, 0
    buffer_load_dwordx4 v18, s[8:11], s93 offen lds
    v_mov_b32 v15, v14
    s_nop 1
    v_permlane32_swap_b32 v14, v15
    v_mul_f32 v14, 0xbb000000, v14
    v_mul_f32 v15, 0x3b000000, v15
    s_waitcnt lgkmcnt(4)
    v_mfma_f32_32x32x16_bf16 v[80:95], v[192:195], v[32:35], v[80:95]
    ds_read_b64_tr_b16 v[40:41], v2 offset:18432
    ds_read_b64_tr_b16 v[42:43], v2 offset:18688
    ds_read_b64_tr_b16 v[56:57], v2 offset:51200
    ds_read_b64_tr_b16 v[58:59], v2 offset:51456
    v_mfma_f32_32x32x16_bf16 v[96:111], v[192:195], v[48:51], v[96:111]
    s_add_u32 m0, s77, 66560
    s_add_u32 s93, s48, 49152
    buffer_load_dwordx4 v18, s[8:11], s93 offen lds
    v_fma_f32 v15, -v14, v14, v15
    v_max_f32 v15, 0, v15
    v_add_f32 v15, 0x3727c5ac, v15
    v_rsq_f32 v8, v15
    s_waitcnt lgkmcnt(4)
    v_mfma_f32_32x32x16_bf16 v[80:95], v[196:199], v[36:39], v[80:95]
    ds_read_b64_tr_b16 v[44:45], v2 offset:19456
    ds_read_b64_tr_b16 v[46:47], v2 offset:19712
    ds_read_b64_tr_b16 v[60:61], v2 offset:52224
    ds_read_b64_tr_b16 v[62:63], v2 offset:52480
    v_mfma_f32_32x32x16_bf16 v[96:111], v[196:199], v[52:55], v[96:111]
    ds_write_b128 v70, v[72:75] offset:17408
    ds_write_b128 v70, v[76:79] offset:18432
    ds_read_b64_tr_b16 v[72:73], v66 offset:0
    ds_read_b64_tr_b16 v[74:75], v66 offset:256
    ds_read_b64_tr_b16 v[76:77], v67 offset:0
    ds_read_b64_tr_b16 v[78:79], v67 offset:256
    v_cvt_pk_bf16_f32 v15, v14, v14
    v_mul_f32 v8, 0x3fb8aa3b, v8
    v_lshlrev_b32 v15, 16, v15
    s_lshl_b32 s91, s64, 7
    s_add_u32 s91, s91, 162816
    v_add_u32 v20, s91, v6
    s_waitcnt lgkmcnt(10)
    v_mfma_f32_32x32x16_bf16 v[80:95], v[200:203], v[40:43], v[80:95]
    ds_read_b64_tr_b16 v[32:33], v2 offset:20480
    ds_read_b64_tr_b16 v[34:35], v2 offset:20736
    ds_read_b64_tr_b16 v[48:49], v2 offset:53248
    ds_read_b64_tr_b16 v[50:51], v2 offset:53504
    v_mfma_f32_32x32x16_bf16 v[96:111], v[200:203], v[56:59], v[96:111]
    ds_write_b32 v20, v8
    v_sub_f32 v15, v14, v15
    s_waitcnt lgkmcnt(11)
    v_mfma_f32_32x32x16_bf16 v[80:95], v[204:207], v[44:47], v[80:95]
    ds_read_b64_tr_b16 v[36:37], v2 offset:21504
    ds_read_b64_tr_b16 v[38:39], v2 offset:21760
    ds_read_b64_tr_b16 v[52:53], v2 offset:54272
    ds_read_b64_tr_b16 v[54:55], v2 offset:54528
    v_mfma_f32_32x32x16_bf16 v[96:111], v[204:207], v[60:63], v[96:111]
    s_waitcnt lgkmcnt(9)
    buffer_store_dwordx4 v[72:75], v69, s[24:27], 0 offen offset:0 sc1
    buffer_store_dwordx4 v[76:79], v69, s[24:27], 0 offen offset:1024 sc1
    v_mfma_f32_16x16x32_bf16 v[64:67], v[24:27], v[72:75], 0
    v_mfma_f32_16x16x32_bf16 v[64:67], v[24:27], v[76:79], v[64:67]
    v_lshrrev_b32 v68, 3, v0
    v_xor_b32 v70, v68, v0
    v_and_b32 v70, 7, v70
    v_lshlrev_b32 v70, 4, v70
    v_lshl_add_u32 v68, v68, 10, v70
    v_cvt_pk_bf16_f32 v20, v14, v15
    v_cvt_pk_bf16_f32 v21, v14, v15
    v_cvt_pk_bf16_f32 v22, v14, v15
    v_cvt_pk_bf16_f32 v23, v14, v15
    s_waitcnt lgkmcnt(5)
    v_mfma_f32_32x32x16_bf16 v[80:95], v[208:211], v[32:35], v[80:95]
L_pad0:
    s_cbranch_execz L_pad1
    ds_read_b64_tr_b16 v[40:41], v2 offset:22528
    ds_read_b64_tr_b16 v[42:43], v2 offset:22784
    ds_read_b64_tr_b16 v[56:57], v2 offset:55296
    ds_read_b64_tr_b16 v[58:59], v2 offset:55552
    v_mfma_f32_32x32x16_bf16 v[96:111], v[208:211], v[48:51], v[96:111]
    s_add_u32 s88, s68, 16
    s_mov_b32 s84, s69
    s_mov_b32 s86, 0x3f317218
    s_mov_b32 s87, 0x358637bd
    s_waitcnt lgkmcnt(4)
    v_mfma_f32_32x32x16_bf16 v[80:95], v[212:215], v[36:39], v[80:95]
    ds_read_b64_tr_b16 v[44:45], v2 offset:23552
    ds_read_b64_tr_b16 v[46:47], v2 offset:23808
    ds_read_b64_tr_b16 v[60:61], v2 offset:56320
    ds_read_b64_tr_b16 v[62:63], v2 offset:56576
    v_mfma_f32_32x32x16_bf16 v[96:111], v[212:215], v[52:55], v[96:111]
    s_waitcnt vmcnt(4)
    ds_read_b128 v[224:227], v112 offset:0
    ds_read_b128 v[228:231], v113 offset:0
    ds_read_b128 v[232:235], v114 offset:0
    ds_read_b128 v[236:239], v115 offset:0
    ds_read_b128 v[240:243], v116 offset:0
    ds_read_b128 v[244:247], v117 offset:0
    ds_read_b128 v[248:251], v118 offset:0
    ds_read_b128 v[252:255], v119 offset:0
    ds_read_b64_tr_b16 a[24:25], v13 offset:24576
    ds_read_b64_tr_b16 a[26:27], v13 offset:24832
    ds_read_b64_tr_b16 a[56:57], v13 offset:57344
    ds_read_b64_tr_b16 a[58:59], v13 offset:57600
    ds_read_b64_tr_b16 a[28:29], v13 offset:25600
    ds_read_b64_tr_b16 a[30:31], v13 offset:25856
    ds_read_b64_tr_b16 a[60:61], v13 offset:58368
    ds_read_b64_tr_b16 a[62:63], v13 offset:58624
    s_cmp_eq_u32 s64, 4
    s_cselect_b32 s91, 0x40000000, 0
    v_add_u32 v15, s91, v1
    s_waitcnt lgkmcnt(15)
    v_mfma_f32_32x32x16_bf16 v[80:95], v[216:219], v[40:43], v[80:95]
    s_waitcnt lgkmcnt(0)
    s_barrier
    ds_read_b64_tr_b16 v[32:33], v2 offset:24576
    ds_read_b64_tr_b16 v[34:35], v2 offset:24832
    ds_read_b64_tr_b16 v[48:49], v2 offset:57344
    ds_read_b64_tr_b16 v[50:51], v2 offset:57600
    v_mfma_f32_32x32x16_bf16 v[96:111], v[216:219], v[56:59], v[96:111]
    s_add_u32 m0, s47, 98304
    s_add_u32 s93, s56, 0
    buffer_load_dwordx4 v12, s[16:19], s93 offen lds
    v_mfma_f32_16x16x32_bf16 v[28:31], v[24:27], a[24:27], v[28:31]
    v_mfma_f32_16x16x32_bf16 v[124:127], v[24:27], a[56:59], v[124:127]
    v_mfma_f32_16x16x32_bf16 v[28:31], v[24:27], a[28:31], v[28:31]
    v_mfma_f32_16x16x32_bf16 v[124:127], v[24:27], a[60:63], v[124:127]
    s_mul_i32 s91, s64, 4096
    v_add_u32 v14, s91, v11
    v_mfma_f32_32x32x16_bf16 v[80:95], v[220:223], v[44:47], v[80:95]
    ds_read_b64_tr_b16 v[36:37], v2 offset:25600
    ds_read_b64_tr_b16 v[38:39], v2 offset:25856
    ds_read_b64_tr_b16 v[52:53], v2 offset:58368
    ds_read_b64_tr_b16 v[54:55], v2 offset:58624
    v_mfma_f32_32x32x16_bf16 v[96:111], v[220:223], v[60:63], v[96:111]
    s_add_u32 m0, s47, 99328
    s_add_u32 s93, s56, 4096
    buffer_load_dwordx4 v12, s[16:19], s93 offen lds
    s_lshl_b32 s91, s64, 10
    v_add_u32 v13, s91, v11
    v_cvt_pk_bf16_f32 v30, v28, v28
    v_lshlrev_b32 v31, 16, v30
    s_waitcnt lgkmcnt(4)
    v_mfma_f32_32x32x16_bf16 v[80:95], v[224:227], v[32:35], v[80:95]
    ds_read_b64_tr_b16 v[40:41], v2 offset:26624
    ds_read_b64_tr_b16 v[42:43], v2 offset:26880
    ds_read_b64_tr_b16 v[56:57], v2 offset:59392
    ds_read_b64_tr_b16 v[58:59], v2 offset:59648
    v_mfma_f32_32x32x16_bf16 v[96:111], v[224:227], v[48:51], v[96:111]
    s_add_u32 m0, s47, 100352
    s_add_u32 s93, s56, 16384
    buffer_load_dwordx4 v12, s[16:19], s93 offen lds
    v_sub_f32 v31, v28, v31
    v_cvt_pk_bf16_f32 v31, v31, v31
    ds_write_b64 v17, v[30:31] offset:0
    v_cvt_pk_bf16_f32 v126, v124, v124
    v_lshlrev_b32 v127, 16, v126
    s_waitcnt lgkmcnt(5)
    v_mfma_f32_32x32x16_bf16 v[80:95], v[228:231], v[36:39], v[80:95]
    ds_read_b64_tr_b16 v[44:45], v2 offset:27648
    ds_read_b64_tr_b16 v[46:47], v2 offset:27904
    ds_read_b64_tr_b16 v[60:61], v2 offset:60416
    ds_read_b64_tr_b16 v[62:63], v2 offset:60672
    v_mfma_f32_32x32x16_bf16 v[96:111], v[228:231], v[52:55], v[96:111]
    s_add_u32 m0, s47, 101376
    s_add_u32 s93, s56, 20480
    buffer_load_dwordx4 v12, s[16:19], s93 offen lds
    v_sub_f32 v127, v124, v127
    v_cvt_pk_bf16_f32 v127, v127, v127
    ds_write_b64 v17, v[126:127] offset:1024
    ds_read_b128 v[112:115], v10 offset:0
    ds_read_b128 v[116:119], v10 offset:32
    s_waitcnt lgkmcnt(8)
    v_mfma_f32_32x32x16_bf16 v[80:95], v[232:235], v[40:43], v[80:95]
    ds_read_b64_tr_b16 v[32:33], v2 offset:28672
    ds_read_b64_tr_b16 v[34:35], v2 offset:28928
    ds_read_b64_tr_b16 v[48:49], v2 offset:61440
    ds_read_b64_tr_b16 v[50:51], v2 offset:61696
    v_mfma_f32_32x32x16_bf16 v[96:111], v[232:235], v[56:59], v[96:111]
    s_add_u32 m0, s77, 73728
    s_add_u32 s93, s49, 0
    buffer_load_dwordx4 v18, s[8:11], s93 offen lds
    ds_read_b128 v[120:123], v10 offset:64
    ds_read_b128 v[124:127], v10 offset:96
    s_waitcnt lgkmcnt(11)
    v_mfma_f32_32x32x16_bf16 v[80:95], v[236:239], v[44:47], v[80:95]
    ds_read_b64_tr_b16 v[36:37], v2 offset:29696
    ds_read_b64_tr_b16 v[38:39], v2 offset:29952
    ds_read_b64_tr_b16 v[40:41], v2 offset:30720
    ds_read_b64_tr_b16 v[42:43], v2 offset:30976
    s_waitcnt lgkmcnt(8)
    v_mfma_f32_32x32x16_bf16 v[80:95], v[240:243], v[32:35], v[80:95]
    ds_read_b64_tr_b16 v[44:45], v2 offset:31744
    ds_read_b64_tr_b16 v[46:47], v2 offset:32000
    ds_read_b64_tr_b16 v[52:53], v2 offset:62464
    ds_read_b64_tr_b16 v[54:55], v2 offset:62720
    s_add_u32 m0, s77, 74752
    s_add_u32 s93, s49, 49152
    buffer_load_dwordx4 v18, s[8:11], s93 offen lds
    s_waitcnt lgkmcnt(6)
    v_mfma_f32_32x32x16_bf16 v[80:95], v[244:247], v[36:39], v[80:95]
    s_waitcnt lgkmcnt(0)
    s_barrier
    ds_read_b128 v[32:35], v11 offset:25600
    ds_read_b64_tr_b16 v[56:57], v2 offset:63488
    ds_read_b64_tr_b16 v[58:59], v2 offset:63744
    v_mfma_f32_32x32x16_bf16 v[80:95], v[248:251], v[40:43], v[80:95]
    v_mfma_f32_32x32x16_bf16 v[80:95], v[252:255], v[44:47], v[80:95]
    s_waitcnt lgkmcnt(2)
    v_mfma_f32_32x32x16_bf16 v[80:95], v[20:23], v[32:35], v[80:95]
    s_add_u32 m0, s77, 81920
    s_add_u32 s93, s50, 0
    buffer_load_dwordx4 v18, s[8:11], s93 offen lds
    v_mfma_f32_32x32x16_bf16 v[96:111], v[236:239], v[60:63], v[96:111]
    ds_read_b64_tr_b16 v[60:61], v2 offset:64512
    ds_read_b64_tr_b16 v[62:63], v2 offset:64768
    v_mfma_f32_32x32x16_bf16 v[96:111], v[240:243], v[48:51], v[96:111]
    ds_read_b128 v[48:51], v11 offset:26624
    s_nop 3
    v_pk_mul_f32 v[80:81], v[80:81], v[112:113]
    v_pk_mul_f32 v[82:83], v[82:83], v[114:115]
    v_pk_mul_f32 v[84:85], v[84:85], v[116:117]
    v_pk_mul_f32 v[86:87], v[86:87], v[118:119]
    v_mfma_f32_32x32x16_bf16 v[96:111], v[244:247], v[52:55], v[96:111]
    v_exp_f32_e64 v40, v80 clamp
    v_exp_f32_e64 v41, v81 clamp
    v_exp_f32_e64 v42, v82 clamp
    v_exp_f32_e64 v43, v83 clamp
    s_waitcnt lgkmcnt(3)
    v_mfma_f32_32x32x16_bf16 v[96:111], v[248:251], v[56:59], v[96:111]
    v_exp_f32_e64 v44, v84 clamp
    v_exp_f32_e64 v45, v85 clamp
    v_exp_f32_e64 v46, v86 clamp
    v_exp_f32_e64 v47, v87 clamp
    s_waitcnt lgkmcnt(1)
    v_mfma_f32_32x32x16_bf16 v[96:111], v[252:255], v[60:63], v[96:111]
    v_pk_fma_f32 v[80:81], v[80:81], s[86:87], s[86:87] op_sel:[0,0,1] op_sel_hi:[1,0,1]
    v_pk_fma_f32 v[82:83], v[82:83], s[86:87], s[86:87] op_sel:[0,0,1] op_sel_hi:[1,0,1]
    v_pk_fma_f32 v[84:85], v[84:85], s[86:87], s[86:87] op_sel:[0,0,1] op_sel_hi:[1,0,1]
    v_pk_fma_f32 v[86:87], v[86:87], s[86:87], s[86:87] op_sel:[0,0,1] op_sel_hi:[1,0,1]
    s_waitcnt lgkmcnt(0)
    v_mfma_f32_32x32x16_bf16 v[96:111], v[20:23], v[48:51], v[96:111]
    v_max_f32 v80, s87, v80
    v_max_f32 v81, s87, v81
    v_max_f32 v82, s87, v82
    v_max_f32 v83, s87, v83
    s_add_u32 m0, s77, 82944
    s_add_u32 s93, s50, 49152
    buffer_load_dwordx4 v18, s[8:11], s93 offen lds
    s_add_u32 m0, s77, 90112
    s_add_u32 s93, s51, 0
    buffer_load_dwordx4 v18, s[8:11], s93 offen lds
    s_add_u32 m0, s77, 91136
    s_add_u32 s93, s51, 49152
    buffer_load_dwordx4 v18, s[8:11], s93 offen lds
    v_max_f32 v84, s87, v84
    v_max_f32 v85, s87, v85
    v_max_f32 v86, s87, v86
    v_max_f32 v87, s87, v87
    v_pk_add_f32 v[80:81], v[80:81], v[40:41]
    v_pk_add_f32 v[82:83], v[82:83], v[42:43]
    v_pk_add_f32 v[84:85], v[84:85], v[44:45]
    v_pk_add_f32 v[86:87], v[86:87], v[46:47]
    v_cvt_pk_bf16_f32 v32, v80, v81
    v_cvt_pk_bf16_f32 v33, v82, v83
    v_cvt_pk_bf16_f32 v34, v84, v85
    v_cvt_pk_bf16_f32 v35, v86, v87
    v_pk_mul_f32 v[88:89], v[88:89], v[120:121]
    v_pk_mul_f32 v[90:91], v[90:91], v[122:123]
    v_pk_mul_f32 v[92:93], v[92:93], v[124:125]
    v_pk_mul_f32 v[94:95], v[94:95], v[126:127]
    v_mfma_f32_16x16x32_bf16 v[28:31], v[24:27], v[32:35], 0
    v_exp_f32_e64 v40, v88 clamp
    v_exp_f32_e64 v41, v89 clamp
    v_exp_f32_e64 v42, v90 clamp
    v_exp_f32_e64 v43, v91 clamp
    v_exp_f32_e64 v44, v92 clamp
    v_exp_f32_e64 v45, v93 clamp
    v_exp_f32_e64 v46, v94 clamp
    v_exp_f32_e64 v47, v95 clamp
    v_pk_fma_f32 v[88:89], v[88:89], s[86:87], s[86:87] op_sel:[0,0,1] op_sel_hi:[1,0,1]
    v_pk_fma_f32 v[90:91], v[90:91], s[86:87], s[86:87] op_sel:[0,0,1] op_sel_hi:[1,0,1]
    v_pk_fma_f32 v[92:93], v[92:93], s[86:87], s[86:87] op_sel:[0,0,1] op_sel_hi:[1,0,1]
    v_pk_fma_f32 v[94:95], v[94:95], s[86:87], s[86:87] op_sel:[0,0,1] op_sel_hi:[1,0,1]
    v_max_f32 v88, s87, v88
    v_max_f32 v89, s87, v89
    v_max_f32 v90, s87, v90
    v_max_f32 v91, s87, v91
    v_max_f32 v92, s87, v92
    v_max_f32 v93, s87, v93
    v_max_f32 v94, s87, v94
    v_max_f32 v95, s87, v95
    v_pk_add_f32 v[88:89], v[88:89], v[40:41]
    v_pk_add_f32 v[90:91], v[90:91], v[42:43]
    v_pk_add_f32 v[92:93], v[92:93], v[44:45]
    v_pk_add_f32 v[94:95], v[94:95], v[46:47]
    v_cvt_pk_bf16_f32 v36, v88, v89
    v_cvt_pk_bf16_f32 v37, v90, v91
    v_cvt_pk_bf16_f32 v38, v92, v93
    v_cvt_pk_bf16_f32 v39, v94, v95
    v_pk_mul_f32 v[96:97], v[96:97], v[112:113]
    v_pk_mul_f32 v[98:99], v[98:99], v[114:115]
    v_pk_mul_f32 v[100:101], v[100:101], v[116:117]
    v_pk_mul_f32 v[102:103], v[102:103], v[118:119]
    v_pk_mul_f32 v[104:105], v[104:105], v[120:121]
    v_pk_mul_f32 v[106:107], v[106:107], v[122:123]
    v_pk_mul_f32 v[108:109], v[108:109], v[124:125]
    v_pk_mul_f32 v[110:111], v[110:111], v[126:127]
    v_mfma_f32_16x16x32_bf16 v[28:31], v[24:27], v[36:39], v[28:31]
    v_cvt_pk_bf16_f32 v40, v96, v97
    v_cvt_pk_bf16_f32 v41, v98, v99
    v_cvt_pk_bf16_f32 v42, v100, v101
    v_cvt_pk_bf16_f32 v43, v102, v103
    v_cvt_pk_bf16_f32 v44, v104, v105
    v_cvt_pk_bf16_f32 v45, v106, v107
    v_mfma_f32_32x32x16_bf16 v[80:95], v[32:35], v[40:43], 0
    v_cvt_pk_bf16_f32 v46, v108, v109
    v_cvt_pk_bf16_f32 v47, v110, v111
    v_mov_b32 v106, v28
    s_nop 0
    v_mfma_f32_32x32x16_bf16 v[80:95], v[36:39], v[44:47], v[80:95]
    s_lshr_b32 s91, s65, 2
    s_cmp_eq_u32 s91, 0
    s_cselect_b32 s91, -1, 0
    v_and_b32 v108, s91, v64
    s_lshr_b32 s91, s65, 2
    s_cmp_eq_u32 s91, 1
    s_cselect_b32 s91, -1, 0
    v_and_b32 v109, s91, v64
    s_lshr_b32 s91, s65, 2
    s_cmp_eq_u32 s91, 2
    s_cselect_b32 s91, -1, 0
    v_and_b32 v110, s91, v64
    ds_write_b96 v14, v[108:110] offset:3072
    v_cndmask_b32_e64 v96, v80, v88, s[96:97]
    v_cndmask_b32_e64 v97, v81, v89, s[96:97]
    v_cndmask_b32_e64 v98, v82, v90, s[96:97]
    ds_write_b96 v14, v[96:98] offset:0
    v_cndmask_b32_e64 v100, v83, v91, s[96:97]
    v_cndmask_b32_e64 v101, v84, v92, s[96:97]
    v_cndmask_b32_e64 v102, v85, v93, s[96:97]
    ds_write_b96 v14, v[100:102] offset:1024
    v_cndmask_b32_e64 v104, v86, v94, s[96:97]
    v_cndmask_b32_e64 v105, v87, v95, s[96:97]
    ds_write_b96 v14, v[104:106] offset:2048
    v_mov_b32 v83, s88
    s_waitcnt vmcnt(0)
    s_waitcnt lgkmcnt(0)
    s_barrier
    ds_read_b96 v[80:82], v13 offset:0
    ds_read_b96 v[84:86], v13 offset:4096
    ds_read_b96 v[88:90], v13 offset:8192
    ds_read_b96 v[92:94], v13 offset:12288
    s_cmp_eq_u32 s64, 3
    s_waitcnt lgkmcnt(2)
    v_pk_add_f32 v[80:81], v[80:81], v[84:85]
    v_add_f32 v82, v82, v86
    s_waitcnt lgkmcnt(1)
    v_pk_add_f32 v[80:81], v[80:81], v[88:89]
    v_add_f32 v82, v82, v90
    s_waitcnt lgkmcnt(0)
    v_pk_add_f32 v[80:81], v[80:81], v[92:93]
    v_add_f32 v82, v82, v94
    s_cbranch_scc0 L_csb_4
    s_mov_b32 exec_lo, 0
    v_cvt_pk_bf16_f32 v84, v80, v80
    v_cvt_pk_bf16_f32 v85, v81, v81
    v_cvt_pk_bf16_f32 v86, v82, v82
    v_lshlrev_b32 v84, 16, v84
    v_lshlrev_b32 v85, 16, v85
    v_lshlrev_b32 v86, 16, v86
    v_sub_f32 v80, v80, v84
    v_sub_f32 v81, v81, v85
    v_sub_f32 v82, v82, v86
    s_mov_b32 exec_lo, -1
L_csb_4:
    v_cvt_pk_bf16_f32 v80, v80, v81
    v_permlane32_swap_b32 v82, v84
    s_nop 0
    v_permlane32_swap_b32 v80, v81
    v_cvt_pk_bf16_f32 v82, v82, v84
    s_mov_b32 exec_hi, 0
    buffer_store_dwordx4 v[80:83], v15, s[32:35], s44 offen sc1
    s_mov_b32 exec_hi, -1
    s_sub_u32 s92, s45, 6291456
    s_mov_b64 exec, 0xffff
    buffer_load_dword a255, v9, s[24:27], s45 offen
    buffer_load_dword a255, v9, s[28:31], s92 offen
    s_lshl_b32 s91, s66, 7
    s_add_u32 s91, s91, s72
    s_mov_b64 exec, 1
    buffer_load_dword a255, v9, s[24:27], s91 offen
    buffer_load_dword a255, v9, s[24:27], s73 offen
    buffer_load_dword a255, v9, s[24:27], s74 offen
    s_mov_b64 exec, -1
    v_add_u32 v13, s77, v3
    ds_read_b64_tr_b16 a[64:65], v13 offset:0
    ds_read_b64_tr_b16 a[66:67], v13 offset:256
    ds_read_b64_tr_b16 a[68:69], v13 offset:1024
    ds_read_b64_tr_b16 a[70:71], v13 offset:1280
    ds_read_b64_tr_b16 a[72:73], v13 offset:8192
    ds_read_b64_tr_b16 a[74:75], v13 offset:8448
    ds_read_b64_tr_b16 a[76:77], v13 offset:9216
    ds_read_b64_tr_b16 a[78:79], v13 offset:9472
    ds_read_b64_tr_b16 a[80:81], v13 offset:16384
    ds_read_b64_tr_b16 a[82:83], v13 offset:16640
    ds_read_b64_tr_b16 a[84:85], v13 offset:17408
    ds_read_b64_tr_b16 a[86:87], v13 offset:17664
    ds_read_b64_tr_b16 a[88:89], v13 offset:24576
    ds_read_b64_tr_b16 a[90:91], v13 offset:24832
    ds_read_b64_tr_b16 a[92:93], v13 offset:25600
    ds_read_b64_tr_b16 a[94:95], v13 offset:25856
    s_waitcnt lgkmcnt(8)
    ds_read_b64_tr_b16 v[48:49], v3 offset:0
    ds_read_b64_tr_b16 v[50:51], v3 offset:256
    ds_read_b64_tr_b16 v[52:53], v3 offset:1024
    ds_read_b64_tr_b16 v[54:55], v3 offset:1280
    ds_read_b64_tr_b16 v[56:57], v3 offset:2048
    ds_read_b64_tr_b16 v[58:59], v3 offset:2304
    ds_read_b64_tr_b16 v[60:61], v3 offset:3072
    ds_read_b64_tr_b16 v[62:63], v3 offset:3328
    v_mfma_f32_16x16x32_bf16 v[88:91], v[24:27], a[64:67], 0
    v_mfma_f32_16x16x32_bf16 v[88:91], v[24:27], a[68:71], v[88:91]
    v_mfma_f32_16x16x32_bf16 v[88:91], v[24:27], a[72:75], v[88:91]
    v_mfma_f32_16x16x32_bf16 v[88:91], v[24:27], a[76:79], v[88:91]
    s_waitcnt lgkmcnt(14)
    v_mfma_f32_16x16x32_bf16 v[88:91], v[24:27], a[80:83], v[88:91]
    s_waitcnt lgkmcnt(12)
    v_mfma_f32_16x16x32_bf16 v[88:91], v[24:27], a[84:87], v[88:91]
    s_waitcnt lgkmcnt(10)
    v_mfma_f32_16x16x32_bf16 v[88:91], v[24:27], a[88:91], v[88:91]
    s_waitcnt lgkmcnt(8)
    v_mfma_f32_16x16x32_bf16 v[88:91], v[24:27], a[92:95], v[88:91]
    s_waitcnt lgkmcnt(6)
    v_mfma_f32_32x32x16_bf16 v[112:127], v[48:51], v[128:131], 0
    ds_read_b64_tr_b16 v[32:33], v3 offset:4096
    ds_read_b64_tr_b16 v[34:35], v3 offset:4352
    s_mul_i32 s91, s64, 12
    s_add_u32 s91, s91, 143360
    v_lshl_add_u32 v14, v0, 5, s91
    s_add_u32 m0, s47, 114688
    s_add_u32 s93, s57, 0
    buffer_load_dwordx4 v12, s[16:19], s93 offen lds
    s_waitcnt lgkmcnt(6)
    v_mfma_f32_32x32x16_bf16 v[112:127], v[52:55], v[132:135], v[112:127]
    ds_read_b64_tr_b16 v[36:37], v3 offset:5120
    ds_read_b64_tr_b16 v[38:39], v3 offset:5376
    v_cvt_pk_bf16_f32 v28, v88, v88
    v_and_b32 v15, 3, v0
    v_bfe_u32 v16, v0, 2, 1
    s_waitcnt lgkmcnt(6)
    v_mfma_f32_32x32x16_bf16 v[112:127], v[56:59], v[136:139], v[112:127]
    ds_read_b64_tr_b16 v[40:41], v3 offset:6144
    ds_read_b64_tr_b16 v[42:43], v3 offset:6400
    v_lshlrev_b32 v29, 16, v28
    v_lshl_add_u32 v15, v16, 3, v15
    v_bfe_u32 v16, v0, 3, 1
    s_add_u32 m0, s47, 115712
    s_add_u32 s93, s57, 4096
    buffer_load_dwordx4 v12, s[16:19], s93 offen lds
    s_waitcnt lgkmcnt(6)
    v_mfma_f32_32x32x16_bf16 v[112:127], v[60:63], v[140:143], v[112:127]
    ds_read_b64_tr_b16 v[44:45], v3 offset:7168
    ds_read_b64_tr_b16 v[46:47], v3 offset:7424
    v_sub_f32 v29, v88, v29
    v_lshl_add_u32 v15, v16, 2, v15
    v_bfe_u32 v16, v0, 4, 1
    s_waitcnt lgkmcnt(6)
    v_mfma_f32_32x32x16_bf16 v[112:127], v[32:35], v[144:147], v[112:127]
    ds_read_b64_tr_b16 v[48:49], v3 offset:8192
    ds_read_b64_tr_b16 v[50:51], v3 offset:8448
    v_cvt_pk_bf16_f32 v29, v29, v29
    v_lshl_add_u32 v15, v16, 7, v15
    v_lshlrev_b32 v15, 2, v15
    s_add_u32 m0, s47, 116736
    s_add_u32 s93, s57, 16384
    buffer_load_dwordx4 v12, s[16:19], s93 offen lds
    s_waitcnt lgkmcnt(6)
    v_mfma_f32_32x32x16_bf16 v[112:127], v[36:39], v[148:151], v[112:127]
    ds_read_b64_tr_b16 v[52:53], v3 offset:9216
    ds_read_b64_tr_b16 v[54:55], v3 offset:9472
    ds_write_b64 v17, v[28:29] offset:2048
    v_add_u32 v15, 145408, v15
    v_add_u32 v16, 8, v14
    s_waitcnt lgkmcnt(7)
    v_mfma_f32_32x32x16_bf16 v[112:127], v[40:43], v[152:155], v[112:127]
    ds_read_b64_tr_b16 v[56:57], v3 offset:10240
    ds_read_b64_tr_b16 v[58:59], v3 offset:10496
    s_cmp_eq_u32 s64, 2
    s_cselect_b64 vcc, -1, 0
    v_cndmask_b32 v15, v16, v15, vcc
    v_lshrrev_b32 v16, 5, v0
    s_add_u32 m0, s47, 117760
    s_add_u32 s93, s57, 20480
    buffer_load_dwordx4 v12, s[16:19], s93 offen lds
    s_waitcnt lgkmcnt(7)
    v_mfma_f32_32x32x16_bf16 v[112:127], v[44:47], v[156:159], v[112:127]
    ds_read_b64_tr_b16 v[60:61], v3 offset:11264
    ds_read_b64_tr_b16 v[62:63], v3 offset:11520
    v_lshlrev_b32 v16, 5, v16
    v_add_u32 v16, 145408, v16
    s_waitcnt lgkmcnt(7)
    v_mfma_f32_32x32x16_bf16 v[112:127], v[48:51], v[160:163], v[112:127]
    ds_read_b64_tr_b16 v[32:33], v3 offset:12288
    ds_read_b64_tr_b16 v[34:35], v3 offset:12544
    v_lshlrev_b32 v13, 5, v0
    v_add_u32 v13, 143360, v13
    s_add_u32 s93, s58, 0
    buffer_load_dwordx4 a[160:163], v12, s[16:19], s93 offen
    s_waitcnt lgkmcnt(7)
    v_mfma_f32_32x32x16_bf16 v[112:127], v[52:55], v[164:167], v[112:127]
    ds_read_b64_tr_b16 v[36:37], v3 offset:13312
    ds_read_b64_tr_b16 v[38:39], v3 offset:13568
    v_cndmask_b32_e64 v16, v13, v16, s[96:97]
    s_cmp_eq_u32 s64, 4
    s_cselect_b64 vcc, 0, -1
    s_waitcnt lgkmcnt(6)
    v_mfma_f32_32x32x16_bf16 v[112:127], v[56:59], v[168:171], v[112:127]
    ds_read_b64_tr_b16 v[40:41], v3 offset:14336
    ds_read_b64_tr_b16 v[42:43], v3 offset:14592
    s_mul_i32 s89, s76, 1
    s_add_u32 s89, s89, s45
    s_add_u32 s69, s68, 8
    s_add_u32 s93, s58, 4096
    buffer_load_dwordx4 a[164:167], v12, s[16:19], s93 offen
    s_waitcnt lgkmcnt(6)
    v_mfma_f32_32x32x16_bf16 v[112:127], v[60:63], v[172:175], v[112:127]
    ds_read_b64_tr_b16 v[44:45], v3 offset:15360
    ds_read_b64_tr_b16 v[46:47], v3 offset:15616
    s_mov_b32 s92, 0x66226622
    s_mov_b32 s93, s92
    v_mov_b32 v103, 0x3f80
    v_cndmask_b32_e64 v103, v103, 1.0, s[92:93]
    s_waitcnt lgkmcnt(6)
    v_mfma_f32_32x32x16_bf16 v[112:127], v[32:35], v[176:179], v[112:127]
    ds_read_b64_tr_b16 v[48:49], v3 offset:16384
    ds_read_b64_tr_b16 v[50:51], v3 offset:16640
    s_barrier
    s_mov_b32 s92, 0x300003
    s_mov_b32 s93, s92
    v_cndmask_b32_e64 v100, 0, v103, s[92:93]
    s_add_u32 s93, s58, 16384
    buffer_load_dwordx4 a[168:171], v12, s[16:19], s93 offen
    s_waitcnt lgkmcnt(6)
    v_mfma_f32_32x32x16_bf16 v[112:127], v[36:39], v[180:183], v[112:127]
    ds_read_b64_tr_b16 v[52:53], v3 offset:17408
    ds_read_b64_tr_b16 v[54:55], v3 offset:17664
    s_mov_b32 s92, 0x30000300
    s_mov_b32 s93, s92
    v_cndmask_b32_e64 v101, 0, v103, s[92:93]
    s_waitcnt lgkmcnt(6)
    v_mfma_f32_32x32x16_bf16 v[112:127], v[40:43], v[184:187], v[112:127]
    ds_read_b64_tr_b16 v[56:57], v3 offset:18432
    ds_read_b64_tr_b16 v[58:59], v3 offset:18688
    s_mov_b32 s92, 0x40400404
    s_mov_b32 s93, s92
    v_cndmask_b32_e64 v102, 0, v103, s[92:93]
    s_add_u32 s93, s58, 20480
    buffer_load_dwordx4 a[172:175], v12, s[16:19], s93 offen
    s_waitcnt lgkmcnt(6)
    v_mfma_f32_32x32x16_bf16 v[112:127], v[44:47], v[188:191], v[112:127]
    ds_read_b64_tr_b16 v[60:61], v3 offset:19456
    ds_read_b64_tr_b16 v[62:63], v3 offset:19712
    v_mov_b32 v103, 0
    s_waitcnt lgkmcnt(6)
    v_mfma_f32_32x32x16_bf16 v[112:127], v[48:51], v[192:195], v[112:127]
    ds_read_b64_tr_b16 v[32:33], v3 offset:20480
    ds_read_b64_tr_b16 v[34:35], v3 offset:20736
    s_add_u32 s93, s59, 0
    buffer_load_dwordx4 a[176:179], v12, s[16:19], s93 offen
    s_waitcnt lgkmcnt(6)
    v_mfma_f32_32x32x16_bf16 v[112:127], v[52:55], v[196:199], v[112:127]
    ds_read_b64_tr_b16 v[36:37], v3 offset:21504
    ds_read_b64_tr_b16 v[38:39], v3 offset:21760
    s_waitcnt lgkmcnt(6)
    v_mfma_f32_32x32x16_bf16 v[112:127], v[56:59], v[200:203], v[112:127]
    ds_read_b64_tr_b16 v[40:41], v3 offset:22528
    ds_read_b64_tr_b16 v[42:43], v3 offset:22784
    s_add_u32 s93, s59, 4096
    buffer_load_dwordx4 a[180:183], v12, s[16:19], s93 offen
    s_waitcnt lgkmcnt(6)
    v_mfma_f32_32x32x16_bf16 v[112:127], v[60:63], v[204:207], v[112:127]
    ds_read_b64_tr_b16 v[44:45], v3 offset:23552
    ds_read_b64_tr_b16 v[46:47], v3 offset:23808
    s_waitcnt lgkmcnt(6)
    v_mfma_f32_32x32x16_bf16 v[112:127], v[32:35], v[208:211], v[112:127]
    ds_read_b64_tr_b16 v[48:49], v3 offset:24576
    ds_read_b64_tr_b16 v[50:51], v3 offset:24832
    s_waitcnt lgkmcnt(6)
    v_mfma_f32_32x32x16_bf16 v[112:127], v[36:39], v[212:215], v[112:127]
    ds_read_b64_tr_b16 v[52:53], v3 offset:25600
    ds_read_b64_tr_b16 v[54:55], v3 offset:25856
    s_waitcnt lgkmcnt(6)
    v_mfma_f32_32x32x16_bf16 v[112:127], v[40:43], v[216:219], v[112:127]
    ds_read_b64_tr_b16 v[56:57], v3 offset:26624
    ds_read_b64_tr_b16 v[58:59], v3 offset:26880
    s_cbranch_vccz L_g3_5
    buffer_load_dwordx4 v[128:131], v1, s[32:35], s36 offen sc1
L_g3_5:
    s_waitcnt lgkmcnt(6)
    v_mfma_f32_32x32x16_bf16 v[112:127], v[44:47], v[220:223], v[112:127]
    ds_read_b64_tr_b16 v[60:61], v3 offset:27648
    ds_read_b64_tr_b16 v[62:63], v3 offset:27904
    s_waitcnt lgkmcnt(6)
    v_mfma_f32_32x32x16_bf16 v[112:127], v[48:51], v[224:227], v[112:127]
    ds_read_b64_tr_b16 v[32:33], v3 offset:28672
    ds_read_b64_tr_b16 v[34:35], v3 offset:28928
    s_cbranch_vccz L_g3_6
    buffer_load_dwordx4 v[132:135], v1, s[32:35], s37 offen sc1
L_g3_6:
    s_waitcnt lgkmcnt(6)
    v_mfma_f32_32x32x16_bf16 v[112:127], v[52:55], v[228:231], v[112:127]
    ds_read_b64_tr_b16 v[36:37], v3 offset:29696
    ds_read_b64_tr_b16 v[38:39], v3 offset:29952
    s_waitcnt lgkmcnt(6)
    v_mfma_f32_32x32x16_bf16 v[112:127], v[56:59], v[232:235], v[112:127]
    ds_read_b64_tr_b16 v[40:41], v3 offset:30720
    ds_read_b64_tr_b16 v[42:43], v3 offset:30976
    s_cbranch_vccz L_g3_7
    buffer_load_dwordx4 v[136:139], v1, s[32:35], s38 offen sc1
L_g3_7:
    s_waitcnt lgkmcnt(6)
    v_mfma_f32_32x32x16_bf16 v[112:127], v[60:63], v[236:239], v[112:127]
    ds_read_b64_tr_b16 v[44:45], v3 offset:31744
    ds_read_b64_tr_b16 v[46:47], v3 offset:32000
    s_waitcnt lgkmcnt(6)
    v_mfma_f32_32x32x16_bf16 v[112:127], v[32:35], v[240:243], v[112:127]
    ds_read_b128 v[48:51], v11 offset:27648
    s_cbranch_vccz L_g3_8
    buffer_load_dwordx4 v[140:143], v1, s[32:35], s39 offen sc1
L_g3_8:
    s_waitcnt lgkmcnt(5)
    v_mfma_f32_32x32x16_bf16 v[112:127], v[36:39], v[244:247], v[112:127]
    s_waitcnt lgkmcnt(3)
    v_mfma_f32_32x32x16_bf16 v[112:127], v[40:43], v[248:251], v[112:127]
    s_cbranch_vccz L_g3_9
    buffer_load_dwordx4 v[144:147], v1, s[32:35], s40 offen sc1
L_g3_9:
    s_waitcnt lgkmcnt(1)
    v_mfma_f32_32x32x16_bf16 v[112:127], v[44:47], v[252:255], v[112:127]
    s_waitcnt lgkmcnt(0)
    v_mfma_f32_32x32x16_bf16 v[112:127], v[48:51], v[20:23], v[112:127]
    s_cbranch_vccz L_g3_10
    buffer_load_dwordx4 v[148:151], v1, s[32:35], s41 offen sc1
L_g3_10:
    s_cbranch_vccz L_g3_11
    buffer_load_dwordx4 v[152:155], v1, s[32:35], s42 offen sc1
L_g3_11:
    s_nop 9
    v_pk_mul_f32 v[112:113], v[112:113], v[8:9] op_sel_hi:[1,0]
    v_pk_mul_f32 v[114:115], v[114:115], v[8:9] op_sel_hi:[1,0]
    v_pk_mul_f32 v[116:117], v[116:117], v[8:9] op_sel_hi:[1,0]
    v_pk_mul_f32 v[118:119], v[118:119], v[8:9] op_sel_hi:[1,0]
    v_pk_mul_f32 v[120:121], v[120:121], v[8:9] op_sel_hi:[1,0]
    v_pk_mul_f32 v[122:123], v[122:123], v[8:9] op_sel_hi:[1,0]
    v_pk_mul_f32 v[124:125], v[124:125], v[8:9] op_sel_hi:[1,0]
    v_pk_mul_f32 v[126:127], v[126:127], v[8:9] op_sel_hi:[1,0]
    v_exp_f32_e64 v48, v112 clamp
    v_exp_f32_e64 v49, v113 clamp
    v_exp_f32_e64 v50, v114 clamp
    v_exp_f32_e64 v51, v115 clamp
    v_exp_f32_e64 v52, v116 clamp
    v_exp_f32_e64 v53, v117 clamp
    s_cbranch_vccz L_g3_12
    buffer_load_dwordx4 v[156:159], v1, s[32:35], s43 offen sc1
L_g3_12:
    v_exp_f32_e64 v54, v118 clamp
    v_exp_f32_e64 v55, v119 clamp
    v_exp_f32_e64 v56, v120 clamp
    v_exp_f32_e64 v57, v121 clamp
    v_exp_f32_e64 v58, v122 clamp
    v_exp_f32_e64 v59, v123 clamp
    v_exp_f32_e64 v60, v124 clamp
    v_exp_f32_e64 v61, v125 clamp
    v_exp_f32_e64 v62, v126 clamp
    v_exp_f32_e64 v63, v127 clamp
    v_pk_fma_f32 v[112:113], v[112:113], s[86:87], s[86:87] op_sel:[0,0,1] op_sel_hi:[1,0,1]
    v_pk_fma_f32 v[114:115], v[114:115], s[86:87], s[86:87] op_sel:[0,0,1] op_sel_hi:[1,0,1]
    v_pk_fma_f32 v[116:117], v[116:117], s[86:87], s[86:87] op_sel:[0,0,1] op_sel_hi:[1,0,1]
L_pad1:
    s_cbranch_execz L_pad2
    v_pk_fma_f32 v[118:119], v[118:119], s[86:87], s[86:87] op_sel:[0,0,1] op_sel_hi:[1,0,1]
    v_pk_fma_f32 v[120:121], v[120:121], s[86:87], s[86:87] op_sel:[0,0,1] op_sel_hi:[1,0,1]
    v_pk_fma_f32 v[122:123], v[122:123], s[86:87], s[86:87] op_sel:[0,0,1] op_sel_hi:[1,0,1]
    v_pk_fma_f32 v[124:125], v[124:125], s[86:87], s[86:87] op_sel:[0,0,1] op_sel_hi:[1,0,1]
    v_pk_fma_f32 v[126:127], v[126:127], s[86:87], s[86:87] op_sel:[0,0,1] op_sel_hi:[1,0,1]
    v_max_f32 v112, s87, v112
    v_max_f32 v113, s87, v113
    v_max_f32 v114, s87, v114
    v_max_f32 v115, s87, v115
    v_max_f32 v116, s87, v116
    v_max_f32 v117, s87, v117
    v_max_f32 v118, s87, v118
    v_max_f32 v119, s87, v119
    v_max_f32 v120, s87, v120
    v_max_f32 v121, s87, v121
    v_max_f32 v122, s87, v122
    v_max_f32 v123, s87, v123
    v_max_f32 v124, s87, v124
    v_max_f32 v125, s87, v125
    v_max_f32 v126, s87, v126
    v_max_f32 v127, s87, v127
    v_pk_add_f32 v[112:113], v[112:113], v[48:49]
    v_pk_add_f32 v[114:115], v[114:115], v[50:51]
    v_pk_add_f32 v[116:117], v[116:117], v[52:53]
    v_pk_add_f32 v[118:119], v[118:119], v[54:55]
    v_pk_add_f32 v[120:121], v[120:121], v[56:57]
    v_pk_add_f32 v[122:123], v[122:123], v[58:59]
    v_pk_add_f32 v[124:125], v[124:125], v[60:61]
    v_pk_add_f32 v[126:127], v[126:127], v[62:63]
    v_cvt_pk_bf16_f32 v24, v112, v113
    v_cvt_pk_bf16_f32 v25, v114, v115
    v_cvt_pk_bf16_f32 v26, v116, v117
    v_cvt_pk_bf16_f32 v27, v118, v119
    v_cvt_pk_bf16_f32 v28, v120, v121
    v_cvt_pk_bf16_f32 v29, v122, v123
    v_cvt_pk_bf16_f32 v30, v124, v125
    v_cvt_pk_bf16_f32 v31, v126, v127
    s_add_u32 s93, s59, 16384
    buffer_load_dwordx4 a[184:187], v12, s[16:19], s93 offen
    s_add_u32 s93, s59, 20480
    buffer_load_dwordx4 a[188:191], v12, s[16:19], s93 offen
    s_add_u32 m0, s77, 148480
    s_add_u32 s92, s84, 7168
    buffer_load_dwordx4 v68, s[4:7], s84 offen lds
    buffer_load_dwordx4 v68, s[4:7], s92 offen offset:1024 lds
    s_getpc_b64 s[92:93]
L_pc_1:
    s_sub_u32 s92, s92, L_pc_1-L_pc
    s_subb_u32 s93, s93, 0
    global_load_dword a255, v71, s[92:93]
    s_cbranch_vccz L_gather3_15
    s_waitcnt vmcnt(11)
    v_xor_b32 v131, s88, v131
    v_xor_b32 v135, s88, v135
    s_waitcnt vmcnt(10)
    v_xor_b32 v139, s88, v139
    v_mfma_f32_16x16x32_bf16 v[168:171], v[100:103], v[128:131], 0
    s_waitcnt vmcnt(9)
    v_xor_b32 v143, s88, v143
    v_mfma_f32_16x16x32_bf16 v[168:171], v[100:103], v[132:135], v[168:171]
    s_waitcnt vmcnt(8)
    v_xor_b32 v147, s88, v147
    v_mfma_f32_16x16x32_bf16 v[168:171], v[100:103], v[136:139], v[168:171]
    s_waitcnt vmcnt(7)
    v_xor_b32 v151, s88, v151
    v_mfma_f32_16x16x32_bf16 v[168:171], v[100:103], v[140:143], v[168:171]
    s_waitcnt vmcnt(6)
    v_xor_b32 v155, s88, v155
    v_mfma_f32_16x16x32_bf16 v[168:171], v[100:103], v[144:147], v[168:171]
    s_waitcnt vmcnt(5)
    v_xor_b32 v159, s88, v159
    v_mfma_f32_16x16x32_bf16 v[168:171], v[100:103], v[148:151], v[168:171]
    v_mfma_f32_16x16x32_bf16 v[168:171], v[100:103], v[152:155], v[168:171]
    v_mfma_f32_16x16x32_bf16 v[168:171], v[100:103], v[156:159], v[168:171]
L_gatherj_14:
    v_or3_b32 v160, v131, v135, v139
    v_or3_b32 v160, v160, v143, v147
    v_or3_b32 v160, v160, v151, v155
    v_or_b32 v160, v160, v159
    v_cmp_ne_u32 vcc, 0, v160
    s_cbranch_vccz L_gok_16
L_gather_13:
    s_add_u32 s98, s98, 1
    s_cmp_lt_u32 s98, 400000
    s_cbranch_scc0 L_gok_16
    v_cmp_ne_u32 vcc, 0, v131
    v_xor_b32 v131, s88, v131
    s_cbranch_vccz L_gs_17
    buffer_load_dwordx4 v[128:131], v1, s[32:35], s36 offen sc1
L_gs_17:
    v_cmp_ne_u32 vcc, 0, v135
    v_xor_b32 v135, s88, v135
    s_cbranch_vccz L_gs_18
    buffer_load_dwordx4 v[132:135], v1, s[32:35], s37 offen sc1
L_gs_18:
    v_cmp_ne_u32 vcc, 0, v139
    v_xor_b32 v139, s88, v139
    s_cbranch_vccz L_gs_19
    buffer_load_dwordx4 v[136:139], v1, s[32:35], s38 offen sc1
L_gs_19:
    v_cmp_ne_u32 vcc, 0, v143
    v_xor_b32 v143, s88, v143
    s_cbranch_vccz L_gs_20
    buffer_load_dwordx4 v[140:143], v1, s[32:35], s39 offen sc1
L_gs_20:
    v_cmp_ne_u32 vcc, 0, v147
    v_xor_b32 v147, s88, v147
    s_cbranch_vccz L_gs_21
    buffer_load_dwordx4 v[144:147], v1, s[32:35], s40 offen sc1
L_gs_21:
    v_cmp_ne_u32 vcc, 0, v151
    v_xor_b32 v151, s88, v151
    s_cbranch_vccz L_gs_22
    buffer_load_dwordx4 v[148:151], v1, s[32:35], s41 offen sc1
L_gs_22:
    v_cmp_ne_u32 vcc, 0, v155
    v_xor_b32 v155, s88, v155
    s_cbranch_vccz L_gs_23
    buffer_load_dwordx4 v[152:155], v1, s[32:35], s42 offen sc1
L_gs_23:
    v_cmp_ne_u32 vcc, 0, v159
    v_xor_b32 v159, s88, v159
    s_cbranch_vccz L_gs_24
    buffer_load_dwordx4 v[156:159], v1, s[32:35], s43 offen sc1
L_gs_24:
    s_waitcnt vmcnt(0)
    v_xor_b32 v131, s88, v131
    v_xor_b32 v135, s88, v135
    v_xor_b32 v139, s88, v139
    v_xor_b32 v143, s88, v143
    v_xor_b32 v147, s88, v147
    v_xor_b32 v151, s88, v151
    v_xor_b32 v155, s88, v155
    v_xor_b32 v159, s88, v159
    v_mfma_f32_16x16x32_bf16 v[168:171], v[100:103], v[128:131], 0
    v_mfma_f32_16x16x32_bf16 v[168:171], v[100:103], v[132:135], v[168:171]
    v_mfma_f32_16x16x32_bf16 v[168:171], v[100:103], v[136:139], v[168:171]
    v_mfma_f32_16x16x32_bf16 v[168:171], v[100:103], v[140:143], v[168:171]
    v_mfma_f32_16x16x32_bf16 v[168:171], v[100:103], v[144:147], v[168:171]
    v_mfma_f32_16x16x32_bf16 v[168:171], v[100:103], v[148:151], v[168:171]
    v_mfma_f32_16x16x32_bf16 v[168:171], v[100:103], v[152:155], v[168:171]
    v_mfma_f32_16x16x32_bf16 v[168:171], v[100:103], v[156:159], v[168:171]
    s_branch L_gatherj_14
L_gok_16:
    s_cmp_eq_u32 s64, 3
    s_cbranch_scc1 L_gather3_15
    ds_write2_b32 v14, v168, v169 offset0:0 offset1:1
    ds_write_b32 v15, v170
L_gather3_15:
    s_waitcnt vmcnt(11)
    s_waitcnt lgkmcnt(0)
    s_barrier
    ds_read_b128 v[32:35], v16 offset:0
    ds_read_b128 v[36:39], v16 offset:16
    ds_read_b128 v[40:43], v16 offset:512
    ds_read_b128 v[44:47], v16 offset:528
    s_add_u32 m0, s77, 0
    s_add_u32 s93, s60, 0
    buffer_load_dwordx4 v4, s[24:27], s93 offen sc1 lds
    buffer_load_dwordx4 v4, s[24:27], s93 offen offset:1024 sc1 lds
    s_add_u32 m0, s77, 32768
    s_add_u32 s93, s60, 32768
    buffer_load_dwordx4 v4, s[24:27], s93 offen sc1 lds
    buffer_load_dwordx4 v4, s[24:27], s93 offen offset:1024 sc1 lds
    v_mov_b32 v12, s69
    v_mov_b32 v13, s69
    v_mov_b32 v14, 0x3fb8aa3b
    v_and_b32 v16, 48, v0
    v_lshl_add_u32 v15, v16, 4, v1
    v_and_b32 v16, 16, v0
    v_mad_u32_u24 v16, v16, 48, v1
    v_bfe_u32 v21, v0, 2, 3
    v_lshlrev_b32 v20, 7, v21
    v_lshrrev_b32 v21, 1, v21
    v_lshl_add_u32 v20, v21, 5, v20
    v_and_b32 v21, 3, v0
    v_lshl_add_u32 v20, v21, 3, v20
    v_lshrrev_b32 v21, 5, v0
    v_or_b32 v21, 32, v21
    v_lshl_add_u32 v20, v21, 11, v20
    v_xor_b32 v21, 32, v20
    v_xor_b32 v22, 64, v20
    v_xor_b32 v23, 96, v20
    s_add_u32 s75, s75, s76
    s_waitcnt lgkmcnt(2)
    v_cvt_pk_bf16_f32 v48, v32, v33
    v_cvt_pk_bf16_f32 v49, v34, v35
    v_cvt_pk_bf16_f32 v50, v36, v37
    v_cvt_pk_bf16_f32 v51, v38, v39
    s_nop 1
    v_mfma_f32_32x32x16_bf16 v[80:95], v[48:51], v[24:27], 0
    s_waitcnt lgkmcnt(0)
    v_cvt_pk_bf16_f32 v52, v40, v41
    v_cvt_pk_bf16_f32 v53, v42, v43
    v_cvt_pk_bf16_f32 v54, v44, v45
    v_cvt_pk_bf16_f32 v55, v46, v47
    s_nop 1
    v_mfma_f32_32x32x16_bf16 v[96:111], v[52:55], v[28:31], 0
    s_nop 3
    v_fmaak_f32 v88, v88, v14, 0x35c1a2a0
    v_rcp_f32 v88, v88
    s_nop 0
    v_pk_mul_f32 v[80:81], v[80:81], v[88:89] op_sel_hi:[1,0]
    v_pk_mul_f32 v[82:83], v[82:83], v[88:89] op_sel_hi:[1,0]
    v_pk_mul_f32 v[84:85], v[84:85], v[88:89] op_sel_hi:[1,0]
    v_pk_mul_f32 v[86:87], v[86:87], v[88:89] op_sel_hi:[1,0]
    v_cvt_pk_bf16_f32 v112, v80, v81
    v_cvt_pk_bf16_f32 v113, v82, v83
    v_cvt_pk_bf16_f32 v114, v84, v85
    v_cvt_pk_bf16_f32 v115, v86, v87
    s_cmp_lg_u32 s76, 0
    s_cbranch_scc1 L_slow_25
    buffer_store_dwordx4 v[112:115], v1, s[24:27], s89 offen offset:0
L_back_26:
    v_fmaak_f32 v104, v104, v14, 0x35c1a2a0
    v_rcp_f32 v104, v104
    s_nop 0
    v_pk_mul_f32 v[96:97], v[96:97], v[104:105] op_sel_hi:[1,0]
    v_pk_mul_f32 v[98:99], v[98:99], v[104:105] op_sel_hi:[1,0]
    v_pk_mul_f32 v[100:101], v[100:101], v[104:105] op_sel_hi:[1,0]
    v_pk_mul_f32 v[102:103], v[102:103], v[104:105] op_sel_hi:[1,0]
    v_cvt_pk_bf16_f32 v116, v96, v97
    v_cvt_pk_bf16_f32 v117, v98, v99
    v_cvt_pk_bf16_f32 v118, v100, v101
    v_cvt_pk_bf16_f32 v119, v102, v103
    s_cmp_lg_u32 s76, 0
    s_cbranch_scc1 L_slow_27
    buffer_store_dwordx4 v[116:119], v1, s[24:27], s89 offen offset:1024
L_back_28:
    s_waitcnt vmcnt(7)
    v_bfe_u32 v64, v0, 4, 1
    v_lshrrev_b32 v65, 5, v0
    v_lshl_add_u32 v64, v64, 1, v65
    v_xor_b32 v64, v64, v0
    v_and_b32 v64, 7, v64
    v_and_b32 v65, 15, v0
    v_lshl_add_u32 v64, v65, 3, v64
    s_add_u32 s92, s77, 148480
    v_lshl_add_u32 v64, v64, 4, s92
    v_xor_b32 v65, 64, v64
    ds_read_b128 v[68:71], v64
    ds_read_b128 v[76:79], v65
    ds_write_b128 v19, a[160:163] offset:0
    ds_write_b128 v19, a[164:167] offset:1024
    s_waitcnt lgkmcnt(2)
    v_permlane16_swap_b32 v68, v70
    v_permlane16_swap_b32 v69, v71
    v_permlane16_swap_b32 v76, v78
    v_permlane16_swap_b32 v77, v79
    v_lshlrev_b32 v64, 16, v68
    v_and_b32 v65, 0xffff0000, v68
    v_lshlrev_b32 v66, 16, v69
    v_and_b32 v67, 0xffff0000, v69
    v_lshlrev_b32 v68, 16, v70
    v_and_b32 v69, 0xffff0000, v70
    v_lshlrev_b32 v70, 16, v71
    v_and_b32 v71, 0xffff0000, v71
    v_lshlrev_b32 v72, 16, v76
    v_and_b32 v73, 0xffff0000, v76
    v_lshlrev_b32 v74, 16, v77
    v_and_b32 v75, 0xffff0000, v77
    v_lshlrev_b32 v76, 16, v78
    v_and_b32 v77, 0xffff0000, v78
    v_lshlrev_b32 v78, 16, v79
    v_and_b32 v79, 0xffff0000, v79
    s_mov_b64 exec, 1
    s_cmp_lg_u32 s76, 0
    s_cbranch_scc1 L_slow_29
    s_waitcnt vmcnt(0)
    buffer_store_dwordx2 v[12:13], v6, s[24:27], s46 offen
L_back_30:
    s_mov_b64 exec, -1
    buffer_load_dword v12, v6, s[24:27], s83 offen sc1
    ds_write_b128 v19, a[168:171] offset:2048
    ds_write_b128 v19, a[172:175] offset:3072
    ds_write_b128 v19, a[176:179] offset:16384
    ds_write_b128 v19, a[180:183] offset:17408
    ds_write_b128 v19, a[184:187] offset:18432
    ds_write_b128 v19, a[188:191] offset:19456
    s_cmp_eq_u32 s64, 3
    s_cbranch_scc0 L_cst_31
    v_cvt_pk_bf16_f32 v172, v168, v168
    v_lshlrev_b32 v173, 16, v172
    v_sub_f32 v173, v168, v173
    v_cvt_pk_bf16_f32 v173, v173, v173
    v_mov_b32 v174, 0
    v_mov_b32 v175, 0
    ds_write_b128 v11, v[172:175] offset:28672
    v_cvt_pk_bf16_f32 v176, v169, v169
    v_lshlrev_b32 v177, 16, v176
    v_sub_f32 v177, v169, v177
    v_cvt_pk_bf16_f32 v177, v177, v177
    v_mov_b32 v178, 0
    v_mov_b32 v179, 0
    ds_write_b128 v11, v[176:179] offset:29696
    v_cvt_pk_bf16_f32 v180, v170, v170
    v_lshlrev_b32 v181, 16, v180
    v_sub_f32 v181, v170, v181
    v_cvt_pk_bf16_f32 v181, v181, v181
    v_mov_b32 v182, 0
    v_mov_b32 v183, 0
    ds_write_b128 v11, v[180:183] offset:30720
L_cst_31:
    s_cmp_lg_u32 s76, 0
    s_cselect_b64 s[4:5], s[24:25], s[28:29]
    s_cselect_b32 s6, s26, s30
    s_cselect_b32 s91, 0x400000, 0
    s_add_u32 s70, s70, s91
    s_add_u32 s80, s80, s91
    ds_read_b64_tr_b16 v[192:193], v20 offset:32768
    ds_read_b64_tr_b16 v[194:195], v20 offset:33792
    ds_read_b64_tr_b16 v[196:197], v21 offset:32768
    ds_read_b64_tr_b16 v[198:199], v21 offset:33792
    ds_read_b64_tr_b16 v[200:201], v22 offset:32768
    ds_read_b64_tr_b16 v[202:203], v22 offset:33792
    ds_read_b64_tr_b16 v[204:205], v23 offset:32768
    ds_read_b64_tr_b16 v[206:207], v23 offset:33792
    ds_read_b64_tr_b16 v[208:209], v20 offset:36864
    ds_read_b64_tr_b16 v[210:211], v20 offset:37888
    ds_read_b64_tr_b16 v[212:213], v21 offset:36864
    ds_read_b64_tr_b16 v[214:215], v21 offset:37888
    ds_read_b64_tr_b16 v[216:217], v22 offset:36864
    ds_read_b64_tr_b16 v[218:219], v22 offset:37888
    ds_read_b64_tr_b16 v[220:221], v23 offset:36864
    ds_read_b64_tr_b16 v[222:223], v23 offset:37888
    ds_read_b64_tr_b16 v[224:225], v20 offset:40960
    ds_read_b64_tr_b16 v[226:227], v20 offset:41984
    ds_read_b64_tr_b16 v[228:229], v21 offset:40960
    ds_read_b64_tr_b16 v[230:231], v21 offset:41984
L_poll_32:
    s_add_u32 s98, s98, 1
    s_cmp_lt_u32 s98, 400000
    s_cselect_b64 s[94:95], -1, 0
    s_waitcnt vmcnt(0)
    v_cmp_ne_u32 vcc, s69, v12
    buffer_load_dword v12, v6, s[24:27], s83 offen sc1
    s_and_b64 vcc, vcc, s[94:95]
    s_cbranch_scc1 L_poll_32
    s_add_u32 s90, s75, s0
    buffer_load_dwordx4 v[128:131], v15, s[24:27], s90 offen offset:0 sc1
    buffer_load_dwordx4 v[132:135], v15, s[24:27], s90 offen offset:2048 sc1
    ds_read_b64_tr_b16 v[232:233], v22 offset:40960
    ds_read_b64_tr_b16 v[234:235], v22 offset:41984
    ds_read_b64_tr_b16 v[236:237], v23 offset:40960
    ds_read_b64_tr_b16 v[238:239], v23 offset:41984
    ds_read_b64_tr_b16 v[240:241], v20 offset:45056
    ds_read_b64_tr_b16 v[242:243], v20 offset:46080
    s_add_u32 s90, s90, 4096
    buffer_load_dwordx4 v[136:139], v15, s[24:27], s90 offen offset:0 sc1
    ds_read_b64_tr_b16 v[244:245], v21 offset:45056
    ds_read_b64_tr_b16 v[246:247], v21 offset:46080
    ds_read_b64_tr_b16 v[248:249], v22 offset:45056
    ds_read_b64_tr_b16 v[250:251], v22 offset:46080
    ds_read_b64_tr_b16 v[252:253], v23 offset:45056
    ds_read_b64_tr_b16 v[254:255], v23 offset:46080
    buffer_load_dwordx4 v[140:143], v15, s[24:27], s90 offen offset:2048 sc1
    ds_read_b64_tr_b16 v[32:33], v20 offset:49152
    ds_read_b64_tr_b16 v[34:35], v20 offset:50176
    ds_read_b64_tr_b16 v[36:37], v21 offset:49152
    ds_read_b64_tr_b16 v[38:39], v21 offset:50176
    ds_read_b64_tr_b16 v[40:41], v22 offset:49152
    ds_read_b64_tr_b16 v[42:43], v22 offset:50176
    s_add_u32 s90, s75, s1
    buffer_load_dwordx4 v[144:147], v15, s[24:27], s90 offen offset:0 sc1
    ds_read_b64_tr_b16 v[44:45], v23 offset:49152
    ds_read_b64_tr_b16 v[46:47], v23 offset:50176
    ds_read_b64_tr_b16 v[48:49], v20 offset:53248
    ds_read_b64_tr_b16 v[50:51], v20 offset:54272
    ds_read_b64_tr_b16 v[52:53], v21 offset:53248
    ds_read_b64_tr_b16 v[54:55], v21 offset:54272
    buffer_load_dwordx4 v[148:151], v15, s[24:27], s90 offen offset:2048 sc1
    ds_read_b64_tr_b16 v[56:57], v22 offset:53248
    ds_read_b64_tr_b16 v[58:59], v22 offset:54272
    ds_read_b64_tr_b16 v[60:61], v23 offset:53248
    ds_read_b64_tr_b16 v[62:63], v23 offset:54272
    ds_read_b64_tr_b16 v[80:81], v20 offset:57344
    ds_read_b64_tr_b16 v[82:83], v20 offset:58368
    s_add_u32 s90, s90, 4096
    buffer_load_dwordx4 v[152:155], v15, s[24:27], s90 offen offset:0 sc1
    ds_read_b64_tr_b16 v[84:85], v21 offset:57344
    ds_read_b64_tr_b16 v[86:87], v21 offset:58368
    ds_read_b64_tr_b16 v[88:89], v22 offset:57344
    ds_read_b64_tr_b16 v[90:91], v22 offset:58368
    ds_read_b64_tr_b16 v[92:93], v23 offset:57344
    ds_read_b64_tr_b16 v[94:95], v23 offset:58368
    buffer_load_dwordx4 v[156:159], v15, s[24:27], s90 offen offset:2048 sc1
    ds_read_b64_tr_b16 v[96:97], v20 offset:61440
    ds_read_b64_tr_b16 v[98:99], v20 offset:62464
    ds_read_b64_tr_b16 v[100:101], v21 offset:61440
    ds_read_b64_tr_b16 v[102:103], v21 offset:62464
    ds_read_b64_tr_b16 v[104:105], v22 offset:61440
    ds_read_b64_tr_b16 v[106:107], v22 offset:62464
    s_waitcnt vmcnt(7) lgkmcnt(15)
    v_mfma_f32_16x16x32_bf16 v[64:67], v[192:195], v[128:131], v[64:67]
    ds_read_b64_tr_b16 v[108:109], v23 offset:61440
    ds_read_b64_tr_b16 v[110:111], v23 offset:62464
    v_mfma_f32_16x16x32_bf16 v[68:71], v[196:199], v[128:131], v[68:71]
    s_barrier
    s_add_u32 s90, s75, s2
    buffer_load_dwordx4 v[160:163], v15, s[24:27], s90 offen offset:0 sc1
    v_mfma_f32_16x16x32_bf16 v[72:75], v[200:203], v[128:131], v[72:75]
    ds_read_b64_tr_b16 v[192:193], v20 offset:0
    ds_read_b64_tr_b16 v[194:195], v20 offset:1024
    v_mfma_f32_16x16x32_bf16 v[76:79], v[204:207], v[128:131], v[76:79]
    s_waitcnt vmcnt(7) lgkmcnt(15)
    v_mfma_f32_16x16x32_bf16 v[64:67], v[208:211], v[132:135], v[64:67]
    ds_read_b64_tr_b16 v[196:197], v21 offset:0
    ds_read_b64_tr_b16 v[198:199], v21 offset:1024
    v_mfma_f32_16x16x32_bf16 v[68:71], v[212:215], v[132:135], v[68:71]
    buffer_load_dwordx4 v[164:167], v15, s[24:27], s90 offen offset:2048 sc1
    v_mfma_f32_16x16x32_bf16 v[72:75], v[216:219], v[132:135], v[72:75]
    ds_read_b64_tr_b16 v[200:201], v22 offset:0
    ds_read_b64_tr_b16 v[202:203], v22 offset:1024
    v_mfma_f32_16x16x32_bf16 v[76:79], v[220:223], v[132:135], v[76:79]
    s_waitcnt vmcnt(7) lgkmcnt(15)
    v_mfma_f32_16x16x32_bf16 v[64:67], v[224:227], v[136:139], v[64:67]
    ds_read_b64_tr_b16 v[204:205], v23 offset:0
    ds_read_b64_tr_b16 v[206:207], v23 offset:1024
    v_mfma_f32_16x16x32_bf16 v[68:71], v[228:231], v[136:139], v[68:71]
    s_add_u32 s90, s90, 4096
    buffer_load_dwordx4 v[168:171], v15, s[24:27], s90 offen offset:0 sc1
    v_mfma_f32_16x16x32_bf16 v[72:75], v[232:235], v[136:139], v[72:75]
    ds_read_b64_tr_b16 v[208:209], v20 offset:4096
    ds_read_b64_tr_b16 v[210:211], v20 offset:5120
    v_mfma_f32_16x16x32_bf16 v[76:79], v[236:239], v[136:139], v[76:79]
    s_waitcnt vmcnt(7) lgkmcnt(15)
    v_mfma_f32_16x16x32_bf16 v[64:67], v[240:243], v[140:143], v[64:67]
    ds_read_b64_tr_b16 v[212:213], v21 offset:4096
    ds_read_b64_tr_b16 v[214:215], v21 offset:5120
    v_mfma_f32_16x16x32_bf16 v[68:71], v[244:247], v[140:143], v[68:71]
    buffer_load_dwordx4 v[172:175], v15, s[24:27], s90 offen offset:2048 sc1
    v_mfma_f32_16x16x32_bf16 v[72:75], v[248:251], v[140:143], v[72:75]
    ds_read_b64_tr_b16 v[216:217], v22 offset:4096
    ds_read_b64_tr_b16 v[218:219], v22 offset:5120
    v_mfma_f32_16x16x32_bf16 v[76:79], v[252:255], v[140:143], v[76:79]
    s_waitcnt vmcnt(7) lgkmcnt(15)
    v_mfma_f32_16x16x32_bf16 v[64:67], v[32:35], v[144:147], v[64:67]
    ds_read_b64_tr_b16 v[220:221], v23 offset:4096
    ds_read_b64_tr_b16 v[222:223], v23 offset:5120
    v_mfma_f32_16x16x32_bf16 v[68:71], v[36:39], v[144:147], v[68:71]
    s_add_u32 s90, s75, s3
    buffer_load_dwordx4 v[176:179], v15, s[24:27], s90 offen offset:0 sc1
    v_mfma_f32_16x16x32_bf16 v[72:75], v[40:43], v[144:147], v[72:75]
    ds_read_b64_tr_b16 v[224:225], v20 offset:8192
    ds_read_b64_tr_b16 v[226:227], v20 offset:9216
    v_mfma_f32_16x16x32_bf16 v[76:79], v[44:47], v[144:147], v[76:79]
    s_waitcnt vmcnt(7) lgkmcnt(15)
    v_mfma_f32_16x16x32_bf16 v[64:67], v[48:51], v[148:151], v[64:67]
    ds_read_b64_tr_b16 v[228:229], v21 offset:8192
    ds_read_b64_tr_b16 v[230:231], v21 offset:9216
    v_mfma_f32_16x16x32_bf16 v[68:71], v[52:55], v[148:151], v[68:71]
    buffer_load_dwordx4 v[180:183], v15, s[24:27], s90 offen offset:2048 sc1
    v_mfma_f32_16x16x32_bf16 v[72:75], v[56:59], v[148:151], v[72:75]
    ds_read_b64_tr_b16 v[232:233], v22 offset:8192
    ds_read_b64_tr_b16 v[234:235], v22 offset:9216
    v_mfma_f32_16x16x32_bf16 v[76:79], v[60:63], v[148:151], v[76:79]
    s_waitcnt vmcnt(7) lgkmcnt(15)
    v_mfma_f32_16x16x32_bf16 v[64:67], v[80:83], v[152:155], v[64:67]
    ds_read_b64_tr_b16 v[236:237], v23 offset:8192
    ds_read_b64_tr_b16 v[238:239], v23 offset:9216
    v_mfma_f32_16x16x32_bf16 v[68:71], v[84:87], v[152:155], v[68:71]
    s_add_u32 s90, s90, 4096
    buffer_load_dwordx4 v[184:187], v15, s[24:27], s90 offen offset:0 sc1
    v_mfma_f32_16x16x32_bf16 v[72:75], v[88:91], v[152:155], v[72:75]
    ds_read_b64_tr_b16 v[240:241], v20 offset:12288
    ds_read_b64_tr_b16 v[242:243], v20 offset:13312
    v_mfma_f32_16x16x32_bf16 v[76:79], v[92:95], v[152:155], v[76:79]
    s_waitcnt vmcnt(7) lgkmcnt(15)
    v_mfma_f32_16x16x32_bf16 v[64:67], v[96:99], v[156:159], v[64:67]
    ds_read_b64_tr_b16 v[244:245], v21 offset:12288
    ds_read_b64_tr_b16 v[246:247], v21 offset:13312
    v_mfma_f32_16x16x32_bf16 v[68:71], v[100:103], v[156:159], v[68:71]
    buffer_load_dwordx4 v[188:191], v15, s[24:27], s90 offen offset:2048 sc1
    v_mfma_f32_16x16x32_bf16 v[72:75], v[104:107], v[156:159], v[72:75]
    ds_read_b64_tr_b16 v[248:249], v22 offset:12288
    ds_read_b64_tr_b16 v[250:251], v22 offset:13312
    v_mfma_f32_16x16x32_bf16 v[76:79], v[108:111], v[156:159], v[76:79]
    s_waitcnt vmcnt(7) lgkmcnt(15)
    v_mfma_f32_16x16x32_bf16 v[64:67], v[192:195], v[160:163], v[64:67]
    ds_read_b64_tr_b16 v[252:253], v23 offset:12288
    ds_read_b64_tr_b16 v[254:255], v23 offset:13312
    v_mfma_f32_16x16x32_bf16 v[68:71], v[196:199], v[160:163], v[68:71]
    ds_read_b64_tr_b16 v[32:33], v20 offset:16384
    ds_read_b64_tr_b16 v[34:35], v20 offset:17408
    s_add_u32 m0, s77, 8192
    s_add_u32 s93, s61, 0
    buffer_load_dwordx4 v4, s[24:27], s93 offen sc1 lds
    buffer_load_dwordx4 v4, s[24:27], s93 offen offset:1024 sc1 lds
    v_mfma_f32_16x16x32_bf16 v[72:75], v[200:203], v[160:163], v[72:75]
    ds_read_b64_tr_b16 v[36:37], v21 offset:16384
    ds_read_b64_tr_b16 v[38:39], v21 offset:17408
    v_mfma_f32_16x16x32_bf16 v[76:79], v[204:207], v[160:163], v[76:79]
    ds_read_b64_tr_b16 v[40:41], v22 offset:16384
    ds_read_b64_tr_b16 v[42:43], v22 offset:17408
    s_waitcnt vmcnt(8) lgkmcnt(15)
    v_mfma_f32_16x16x32_bf16 v[64:67], v[208:211], v[164:167], v[64:67]
    ds_read_b64_tr_b16 v[44:45], v23 offset:16384
    ds_read_b64_tr_b16 v[46:47], v23 offset:17408
    v_mfma_f32_16x16x32_bf16 v[68:71], v[212:215], v[164:167], v[68:71]
    ds_read_b64_tr_b16 v[48:49], v20 offset:20480
    ds_read_b64_tr_b16 v[50:51], v20 offset:21504
    s_add_u32 m0, s77, 40960
    s_add_u32 s93, s61, 32768
    buffer_load_dwordx4 v4, s[24:27], s93 offen sc1 lds
    buffer_load_dwordx4 v4, s[24:27], s93 offen offset:1024 sc1 lds
    v_mfma_f32_16x16x32_bf16 v[72:75], v[216:219], v[164:167], v[72:75]
    ds_read_b64_tr_b16 v[52:53], v21 offset:20480
    ds_read_b64_tr_b16 v[54:55], v21 offset:21504
    v_mfma_f32_16x16x32_bf16 v[76:79], v[220:223], v[164:167], v[76:79]
    ds_read_b64_tr_b16 v[56:57], v22 offset:20480
    ds_read_b64_tr_b16 v[58:59], v22 offset:21504
    s_waitcnt vmcnt(9) lgkmcnt(15)
    v_mfma_f32_16x16x32_bf16 v[64:67], v[224:227], v[168:171], v[64:67]
    ds_read_b64_tr_b16 v[60:61], v23 offset:20480
    ds_read_b64_tr_b16 v[62:63], v23 offset:21504
    v_mfma_f32_16x16x32_bf16 v[68:71], v[228:231], v[168:171], v[68:71]
    ds_read_b64_tr_b16 v[80:81], v20 offset:24576
    ds_read_b64_tr_b16 v[82:83], v20 offset:25600
    v_mfma_f32_16x16x32_bf16 v[72:75], v[232:235], v[168:171], v[72:75]
    ds_read_b64_tr_b16 v[84:85], v21 offset:24576
    ds_read_b64_tr_b16 v[86:87], v21 offset:25600
    v_mfma_f32_16x16x32_bf16 v[76:79], v[236:239], v[168:171], v[76:79]
    ds_read_b64_tr_b16 v[88:89], v22 offset:24576
    ds_read_b64_tr_b16 v[90:91], v22 offset:25600
    s_waitcnt vmcnt(8) lgkmcnt(15)
    v_mfma_f32_16x16x32_bf16 v[64:67], v[240:243], v[172:175], v[64:67]
    ds_read_b64_tr_b16 v[92:93], v23 offset:24576
    ds_read_b64_tr_b16 v[94:95], v23 offset:25600
    v_mfma_f32_16x16x32_bf16 v[68:71], v[244:247], v[172:175], v[68:71]
    ds_read_b64_tr_b16 v[96:97], v20 offset:28672
    ds_read_b64_tr_b16 v[98:99], v20 offset:29696
    v_mfma_f32_16x16x32_bf16 v[72:75], v[248:251], v[172:175], v[72:75]
    ds_read_b64_tr_b16 v[100:101], v21 offset:28672
    ds_read_b64_tr_b16 v[102:103], v21 offset:29696
    v_mfma_f32_16x16x32_bf16 v[76:79], v[252:255], v[172:175], v[76:79]
    ds_read_b64_tr_b16 v[104:105], v22 offset:28672
    ds_read_b64_tr_b16 v[106:107], v22 offset:29696
    s_waitcnt vmcnt(7) lgkmcnt(15)
    v_mfma_f32_16x16x32_bf16 v[64:67], v[32:35], v[176:179], v[64:67]
    ds_read_b64_tr_b16 v[108:109], v23 offset:28672
    ds_read_b64_tr_b16 v[110:111], v23 offset:29696
    v_mfma_f32_16x16x32_bf16 v[68:71], v[36:39], v[176:179], v[68:71]
    s_add_u32 m0, s77, 16384
    s_add_u32 s93, s62, 0
    buffer_load_dwordx4 v4, s[24:27], s93 offen sc1 lds
    buffer_load_dwordx4 v4, s[24:27], s93 offen offset:1024 sc1 lds
    v_mfma_f32_16x16x32_bf16 v[72:75], v[40:43], v[176:179], v[72:75]
    v_mfma_f32_16x16x32_bf16 v[76:79], v[44:47], v[176:179], v[76:79]
    s_add_u32 s70, s70, s76
    s_add_u32 s72, s72, s76
    s_add_u32 s80, s80, s76
    s_add_u32 s81, s81, s76
    s_waitcnt vmcnt(8) lgkmcnt(15)
    v_mfma_f32_16x16x32_bf16 v[64:67], v[48:51], v[180:183], v[64:67]
    v_mfma_f32_16x16x32_bf16 v[68:71], v[52:55], v[180:183], v[68:71]
    s_add_u32 m0, s77, 49152
    s_add_u32 s93, s62, 32768
    buffer_load_dwordx4 v4, s[24:27], s93 offen sc1 lds
    buffer_load_dwordx4 v4, s[24:27], s93 offen offset:1024 sc1 lds
    v_mfma_f32_16x16x32_bf16 v[72:75], v[56:59], v[180:183], v[72:75]
    v_mfma_f32_16x16x32_bf16 v[76:79], v[60:63], v[180:183], v[76:79]
    s_add_u32 s69, s68, 1
    v_mov_b32 v28, s69
    v_mov_b32 v29, s69
    s_waitcnt vmcnt(9) lgkmcnt(8)
    v_mfma_f32_16x16x32_bf16 v[64:67], v[80:83], v[184:187], v[64:67]
    v_mfma_f32_16x16x32_bf16 v[68:71], v[84:87], v[184:187], v[68:71]
    v_mfma_f32_16x16x32_bf16 v[72:75], v[88:91], v[184:187], v[72:75]
    v_mfma_f32_16x16x32_bf16 v[76:79], v[92:95], v[184:187], v[76:79]
    s_not_b64 s[86:87], s[96:97]
    s_bitcmp1_b32 s64, 0
    s_cselect_b64 s[86:87], s[96:97], s[86:87]
    s_waitcnt vmcnt(8) lgkmcnt(0)
    v_mfma_f32_16x16x32_bf16 v[64:67], v[96:99], v[188:191], v[64:67]
    v_mfma_f32_16x16x32_bf16 v[68:71], v[100:103], v[188:191], v[68:71]
    v_mfma_f32_16x16x32_bf16 v[72:75], v[104:107], v[188:191], v[72:75]
    v_mfma_f32_16x16x32_bf16 v[76:79], v[108:111], v[188:191], v[76:79]
    v_add_u32 v20, s47, v20
    v_add_u32 v21, s47, v21
    v_add_u32 v22, s47, v22
    v_add_u32 v23, s47, v23
    ds_read_b64_tr_b16 a[128:129], v20 offset:32768
    ds_read_b64_tr_b16 a[130:131], v20 offset:33792
    v_cvt_pk_bf16_f32 v112, v64, v65
    v_cvt_pk_bf16_f32 v114, v68, v69
    v_cvt_pk_bf16_f32 v113, v66, v67
    v_cvt_pk_bf16_f32 v115, v70, v71
    v_cvt_pk_bf16_f32 v116, v72, v73
    v_cvt_pk_bf16_f32 v118, v76, v77
    v_cvt_pk_bf16_f32 v117, v74, v75
    v_cvt_pk_bf16_f32 v119, v78, v79
    v_permlane16_swap_b32 v112, v114
    v_permlane16_swap_b32 v113, v115
    s_cmp_lg_u32 s76, 0
    s_cbranch_scc1 L_slow_33
    buffer_store_dwordx4 v[112:115], v16, s[4:7], s80 offen offset:0
L_back_34:
    v_permlane16_swap_b32 v116, v118
    v_permlane16_swap_b32 v117, v119
    s_cmp_lg_u32 s76, 0
    s_cbranch_scc1 L_slow_35
    buffer_store_dwordx4 v[116:119], v16, s[4:7], s80 offen offset:2048
L_back_36:
    v_pk_add_f32 v[12:13], v[64:65], v[66:67]
    v_pk_mul_f32 v[14:15], v[64:65], v[64:65]
    v_pk_fma_f32 v[14:15], v[66:67], v[66:67], v[14:15]
    v_pk_add_f32 v[12:13], v[12:13], v[68:69]
    v_pk_fma_f32 v[14:15], v[68:69], v[68:69], v[14:15]
    v_pk_add_f32 v[12:13], v[12:13], v[70:71]
    v_pk_fma_f32 v[14:15], v[70:71], v[70:71], v[14:15]
    ds_read_b64_tr_b16 a[132:133], v21 offset:32768
    ds_read_b64_tr_b16 a[134:135], v21 offset:33792
    ds_read_b64_tr_b16 a[136:137], v22 offset:32768
    ds_read_b64_tr_b16 a[138:139], v22 offset:33792
    ds_read_b64_tr_b16 a[140:141], v23 offset:32768
    ds_read_b64_tr_b16 a[142:143], v23 offset:33792
    v_pk_add_f32 v[12:13], v[12:13], v[72:73]
    v_pk_fma_f32 v[14:15], v[72:73], v[72:73], v[14:15]
    v_pk_add_f32 v[12:13], v[12:13], v[74:75]
    v_pk_fma_f32 v[14:15], v[74:75], v[74:75], v[14:15]
    v_pk_add_f32 v[12:13], v[12:13], v[76:77]
    v_pk_fma_f32 v[14:15], v[76:77], v[76:77], v[14:15]
    ds_read_b64_tr_b16 a[144:145], v20 offset:49152
    ds_read_b64_tr_b16 a[146:147], v20 offset:50176
    ds_read_b64_tr_b16 a[148:149], v21 offset:49152
    ds_read_b64_tr_b16 a[150:151], v21 offset:50176
    ds_read_b64_tr_b16 a[152:153], v22 offset:49152
    ds_read_b64_tr_b16 a[154:155], v22 offset:50176
    v_pk_add_f32 v[12:13], v[12:13], v[78:79]
    v_pk_fma_f32 v[14:15], v[78:79], v[78:79], v[14:15]
    v_add_f32 v12, v12, v13
L_pad2:
    s_cbranch_execz L_wback
    v_add_f32 v14, v14, v15
    s_nop 1
    v_permlane32_swap_b32 v12, v14
    v_add_f32 v12, v12, v14
    v_mov_b32 v13, v12
    s_nop 1
    v_permlane16_swap_b32 v12, v13
    v_add_f32 v12, v12, v13
    v_or_b32 v12, 1, v12
    s_cmp_lg_u32 s76, 0
    s_cbranch_scc1 L_slow_37
    s_mov_b64 exec, s[86:87]
    buffer_store_dword v12, v1, s[24:27], s81 offen
L_back_38:
    s_mov_b64 exec, -1
    s_add_u32 m0, s77, 24576
    s_add_u32 s93, s63, 0
    buffer_load_dwordx4 v4, s[24:27], s93 offen sc1 lds
    buffer_load_dwordx4 v4, s[24:27], s93 offen offset:1024 sc1 lds
    s_add_u32 m0, s77, 57344
    s_add_u32 s93, s63, 32768
    buffer_load_dwordx4 v4, s[24:27], s93 offen sc1 lds
    buffer_load_dwordx4 v4, s[24:27], s93 offen offset:1024 sc1 lds
    ds_read_b64_tr_b16 a[156:157], v23 offset:49152
    ds_read_b64_tr_b16 a[158:159], v23 offset:50176
    ds_read_b64_tr_b16 a[160:161], v20 offset:0
    ds_read_b64_tr_b16 a[162:163], v20 offset:1024
    ds_read_b64_tr_b16 a[164:165], v21 offset:0
    ds_read_b64_tr_b16 a[166:167], v21 offset:1024
    ds_read_b64_tr_b16 a[168:169], v22 offset:0
    ds_read_b64_tr_b16 a[170:171], v22 offset:1024
    ds_read_b64_tr_b16 a[172:173], v23 offset:0
    ds_read_b64_tr_b16 a[174:175], v23 offset:1024
    ds_read_b64_tr_b16 a[176:177], v20 offset:16384
    ds_read_b64_tr_b16 a[178:179], v20 offset:17408
    s_mov_b64 exec, 1
    s_cmp_lg_u32 s76, 0
    s_cbranch_scc1 L_slow_39
    s_waitcnt vmcnt(5)
    buffer_store_dwordx2 v[28:29], v6, s[24:27], s82 offen
L_back_40:
    s_mov_b64 exec, -1
    buffer_load_dword v16, v6, s[24:27], s73 offen sc1
    ds_read_b64_tr_b16 a[180:181], v21 offset:16384
    ds_read_b64_tr_b16 a[182:183], v21 offset:17408
    ds_read_b64_tr_b16 a[184:185], v22 offset:16384
    ds_read_b64_tr_b16 a[186:187], v22 offset:17408
    ds_read_b64_tr_b16 a[188:189], v23 offset:16384
    ds_read_b64_tr_b16 a[190:191], v23 offset:17408
    v_mov_b32 v2, v1
    v_add_u32 v3, 0x10000, v1
    s_lshl_b32 s91, s66, 6
    s_add_u32 s91, s91, s67
    s_mul_i32 s48, s91, 4352
    s_add_u32 s48, s48, 8388608
    s_lshl_b32 s49, s91, 7
    s_add_u32 s49, s49, 65536
    s_sub_u32 s91, s91, s64
    s_lshl_b32 s50, s91, 7
    s_add_u32 s50, s50, 64512
    s_mul_i32 s91, s91, 4352
    s_add_u32 s12, s91, 8384256
    s_add_u32 s13, s91, 8379904
    s_add_u32 s14, s91, 8375552
    s_add_u32 s15, s91, 8371200
    s_add_u32 s16, s91, 8366848
    s_add_u32 s17, s91, 8362496
    s_add_u32 s18, s91, 8358144
    s_add_u32 s19, s91, 8353792
    s_cmp_ge_u32 s65, 2
    s_cselect_b32 s52, 15, 0
    s_cselect_b32 s54, 0, 0x40000000
    s_cmp_ge_u32 s65, 1
    s_cselect_b32 s53, 0xf0, 0
    s_cselect_b32 s51, 0, 0x40000000
    s_or_b32 s52, s52, s53
    s_mov_b32 s53, 0
    s_lshr_b32 s91, s66, 1
    s_lshl_b32 s91, s91, 16
    s_add_u32 s91, s91, s47
    s_add_u32 s55, s91, 20447232
    s_lshr_b32 s92, s64, 1
    s_xor_b32 s56, s92, s64
    s_and_b32 s56, s56, 1
    s_lshl1_add_u32 s92, s66, s92
    s_sub_i32 s91, s56, s64
    s_lshl_b32 s91, s91, 5
    s_add_u32 s91, s91, s92
    s_lshl_b32 s8, s91, 10
    s_add_u32 s8, s8, s71
    s_lshl2_add_u32 s10, s91, s74
    s_cmp_eq_u32 s56, 1
    s_cselect_b32 s91, 1, 3
    s_lshl_b32 s92, s91, 15
    s_add_u32 s9, s8, s92
    s_lshl_b32 s92, s91, 7
    s_add_u32 s11, s10, s92
    s_waitcnt vmcnt(2)
    s_waitcnt lgkmcnt(0)
    s_barrier
    ds_read_b128 v[32:35], v2 offset:0
    ds_read_b128 v[48:51], v2 offset:32768
    ds_read_b128 v[36:39], v2 offset:1024
    ds_read_b128 v[52:55], v2 offset:33792
L_warmb1:
    ds_read_b128 a[192:195], v4 offset:0
    ds_read_b128 a[196:199], v4 offset:1024
L_poll_41:
    s_add_u32 s98, s98, 1
    s_cmp_lt_u32 s98, 400000
    s_cselect_b64 s[94:95], -1, 0
    s_waitcnt vmcnt(0)
    v_cmp_ne_u32 vcc, s69, v16
    buffer_load_dword v16, v6, s[24:27], s73 offen sc1
    s_and_b64 vcc, vcc, s[94:95]
    s_cbranch_scc1 L_poll_41
    s_add_u32 s90, s70, s0
    buffer_load_dwordx4 v[128:131], v1, s[4:7], s90 offen offset:0 sc1
    buffer_load_dwordx4 v[132:135], v1, s[4:7], s90 offen offset:1024 sc1
    ds_read_b128 a[200:203], v4 offset:8192
    ds_read_b128 a[204:207], v4 offset:9216
    buffer_load_dwordx4 v[136:139], v1, s[4:7], s90 offen offset:2048 sc1
    ds_read_b128 a[208:211], v4 offset:16384
    ds_read_b128 a[212:215], v4 offset:17408
    buffer_load_dwordx4 v[140:143], v1, s[4:7], s90 offen offset:3072 sc1
    ds_read_b128 a[216:219], v4 offset:24576
    ds_read_b128 a[220:223], v4 offset:25600
    s_add_u32 s90, s90, 4096
    buffer_load_dwordx4 v[144:147], v1, s[4:7], s90 offen offset:0 sc1
    ds_read_b128 a[224:227], v4 offset:32768
    ds_read_b128 a[228:231], v4 offset:33792
    buffer_load_dwordx4 v[148:151], v1, s[4:7], s90 offen offset:1024 sc1
    ds_read_b128 a[232:235], v4 offset:40960
    ds_read_b128 a[236:239], v4 offset:41984
    buffer_load_dwordx4 v[152:155], v1, s[4:7], s90 offen offset:2048 sc1
    ds_read_b128 a[240:243], v4 offset:49152
    ds_read_b128 a[244:247], v4 offset:50176
    buffer_load_dwordx4 v[156:159], v1, s[4:7], s90 offen offset:3072 sc1
    ds_read_b128 a[248:251], v4 offset:57344
    ds_read_b128 a[252:255], v4 offset:58368
    s_waitcnt vmcnt(7) lgkmcnt(15)
    v_mfma_f32_32x32x16_bf16 v[80:95], v[32:35], v[128:131], 0
    ds_read_b128 v[40:43], v2 offset:2048
    ds_read_b128 v[56:59], v2 offset:34816
    v_mfma_f32_32x32x16_bf16 v[96:111], v[128:131], v[48:51], 0
    buffer_load_dwordx4 v[112:115], v1, s[24:27], s72 offen offset:0 sc1
    s_waitcnt vmcnt(7) lgkmcnt(15)
    v_mfma_f32_32x32x16_bf16 v[80:95], v[36:39], v[132:135], v[80:95]
    ds_read_b128 v[44:47], v2 offset:3072
    ds_read_b128 v[60:63], v2 offset:35840
    v_mfma_f32_32x32x16_bf16 v[96:111], v[132:135], v[52:55], v[96:111]
    buffer_load_dwordx4 v[116:119], v1, s[24:27], s72 offen offset:1024 sc1
    s_waitcnt vmcnt(7) lgkmcnt(2)
    v_mfma_f32_32x32x16_bf16 v[80:95], v[40:43], v[136:139], v[80:95]
    ds_read_b128 v[32:35], v2 offset:4096
    ds_read_b128 v[48:51], v2 offset:36864
    v_mfma_f32_32x32x16_bf16 v[96:111], v[136:139], v[56:59], v[96:111]
    s_add_u32 s90, s70, s1
    buffer_load_dwordx4 v[160:163], v1, s[4:7], s90 offen offset:0 sc1
    s_waitcnt vmcnt(7) lgkmcnt(2)
    v_mfma_f32_32x32x16_bf16 v[80:95], v[44:47], v[140:143], v[80:95]
    ds_read_b128 v[36:39], v2 offset:5120
    ds_read_b128 v[52:55], v2 offset:37888
    v_mfma_f32_32x32x16_bf16 v[96:111], v[140:143], v[60:63], v[96:111]
    buffer_load_dwordx4 v[164:167], v1, s[4:7], s90 offen offset:1024 sc1
    buffer_load_dwordx4 v[168:171], v1, s[4:7], s90 offen offset:2048 sc1
    s_waitcnt vmcnt(8) lgkmcnt(2)
    v_mfma_f32_32x32x16_bf16 v[80:95], v[32:35], v[144:147], v[80:95]
    ds_read_b128 v[40:43], v2 offset:6144
    ds_read_b128 v[56:59], v2 offset:38912
    v_mfma_f32_32x32x16_bf16 v[96:111], v[144:147], v[48:51], v[96:111]
    buffer_load_dwordx4 v[172:175], v1, s[4:7], s90 offen offset:3072 sc1
    s_add_u32 s90, s90, 4096
    buffer_load_dwordx4 v[176:179], v1, s[4:7], s90 offen offset:0 sc1
    s_waitcnt vmcnt(9) lgkmcnt(2)
    v_mfma_f32_32x32x16_bf16 v[80:95], v[36:39], v[148:151], v[80:95]
    ds_read_b128 v[44:47], v2 offset:7168
    ds_read_b128 v[60:63], v2 offset:39936
    v_mfma_f32_32x32x16_bf16 v[96:111], v[148:151], v[52:55], v[96:111]
    buffer_load_dwordx4 v[180:183], v1, s[4:7], s90 offen offset:1024 sc1
    buffer_load_dwordx4 v[184:187], v1, s[4:7], s90 offen offset:2048 sc1
    s_waitcnt vmcnt(10) lgkmcnt(2)
    v_mfma_f32_32x32x16_bf16 v[80:95], v[40:43], v[152:155], v[80:95]
    ds_read_b128 v[32:35], v2 offset:8192
    ds_read_b128 v[48:51], v2 offset:40960
    v_mfma_f32_32x32x16_bf16 v[96:111], v[152:155], v[56:59], v[96:111]
    buffer_load_dwordx4 v[188:191], v1, s[4:7], s90 offen offset:3072 sc1
    s_add_u32 s90, s70, s2
    buffer_load_dwordx4 v[192:195], v1, s[4:7], s90 offen offset:0 sc1
    s_waitcnt vmcnt(11) lgkmcnt(2)
    v_mfma_f32_32x32x16_bf16 v[80:95], v[44:47], v[156:159], v[80:95]
    ds_read_b128 v[36:39], v2 offset:9216
    ds_read_b128 v[52:55], v2 offset:41984
    v_mfma_f32_32x32x16_bf16 v[96:111], v[156:159], v[60:63], v[96:111]
    buffer_load_dwordx4 v[196:199], v1, s[4:7], s90 offen offset:1024 sc1
    buffer_load_dwordx4 v[200:203], v1, s[4:7], s90 offen offset:2048 sc1
    s_waitcnt vmcnt(10) lgkmcnt(2)
    v_mfma_f32_32x32x16_bf16 v[80:95], v[32:35], v[160:163], v[80:95]
    ds_read_b128 v[40:43], v2 offset:10240
    ds_read_b128 v[56:59], v2 offset:43008
    v_mfma_f32_32x32x16_bf16 v[96:111], v[160:163], v[48:51], v[96:111]
    buffer_load_dwordx4 v[204:207], v1, s[4:7], s90 offen offset:3072 sc1
    s_add_u32 s90, s90, 4096
    buffer_load_dwordx4 v[208:211], v1, s[4:7], s90 offen offset:0 sc1
    v_bitop3_b32 v14, v112, v113, v114 bitop3:0x80
    v_bitop3_b32 v14, v14, v115, v116 bitop3:0x80
    v_bitop3_b32 v14, v14, v117, v118 bitop3:0x80
    s_waitcnt vmcnt(11) lgkmcnt(2)
    v_mfma_f32_32x32x16_bf16 v[80:95], v[36:39], v[164:167], v[80:95]
    ds_read_b128 v[44:47], v2 offset:11264
    ds_read_b128 v[60:63], v2 offset:44032
    v_mfma_f32_32x32x16_bf16 v[96:111], v[164:167], v[52:55], v[96:111]
    buffer_load_dwordx4 v[212:215], v1, s[4:7], s90 offen offset:1024 sc1
    buffer_load_dwordx4 v[216:219], v1, s[4:7], s90 offen offset:2048 sc1
    v_bitop3_b32 v14, v14, v119, v119 bitop3:0x80
    v_and_b32 v14, 1, v14
    v_cmp_ne_u32 vcc, 1, v14
    s_cbranch_vccnz L_ro_42
L_rb_43:
    s_waitcnt vmcnt(12) lgkmcnt(2)
    v_mfma_f32_32x32x16_bf16 v[80:95], v[40:43], v[168:171], v[80:95]
    ds_read_b128 v[32:35], v2 offset:12288
    ds_read_b128 v[48:51], v2 offset:45056
    v_mfma_f32_32x32x16_bf16 v[96:111], v[168:171], v[56:59], v[96:111]
    buffer_load_dwordx4 v[220:223], v1, s[4:7], s90 offen offset:3072 sc1
    s_add_u32 s90, s70, s3
    buffer_load_dwordx4 v[224:227], v1, s[4:7], s90 offen offset:0 sc1
    v_pk_add_f32 v[112:113], v[112:113], v[116:117]
    s_waitcnt vmcnt(13) lgkmcnt(2)
    v_mfma_f32_32x32x16_bf16 v[80:95], v[44:47], v[172:175], v[80:95]
    ds_read_b128 v[36:39], v2 offset:13312
    ds_read_b128 v[52:55], v2 offset:46080
    v_mfma_f32_32x32x16_bf16 v[96:111], v[172:175], v[60:63], v[96:111]
    buffer_load_dwordx4 v[228:231], v1, s[4:7], s90 offen offset:1024 sc1
    buffer_load_dwordx4 v[232:235], v1, s[4:7], s90 offen offset:2048 sc1
    v_pk_add_f32 v[114:115], v[114:115], v[118:119]
    v_pk_add_f32 v[112:113], v[112:113], v[114:115]
    v_add_f32 v14, v112, v113
    s_waitcnt vmcnt(14) lgkmcnt(2)
    v_mfma_f32_32x32x16_bf16 v[80:95], v[32:35], v[176:179], v[80:95]
    ds_read_b128 v[40:43], v2 offset:14336
    ds_read_b128 v[56:59], v2 offset:47104
    v_mfma_f32_32x32x16_bf16 v[96:111], v[176:179], v[48:51], v[96:111]
    buffer_load_dwordx4 v[236:239], v1, s[4:7], s90 offen offset:3072 sc1
    s_add_u32 s90, s90, 4096
    buffer_load_dwordx4 v[240:243], v1, s[4:7], s90 offen offset:0 sc1
    v_mov_b32 v15, v14
    s_nop 1
    v_permlane32_swap_b32 v14, v15
    v_mul_f32 v14, 0xbb000000, v14
    s_waitcnt vmcnt(15) lgkmcnt(2)
    v_mfma_f32_32x32x16_bf16 v[80:95], v[36:39], v[180:183], v[80:95]
    ds_read_b128 v[44:47], v2 offset:15360
    ds_read_b128 v[60:63], v2 offset:48128
    v_mfma_f32_32x32x16_bf16 v[96:111], v[180:183], v[52:55], v[96:111]
    buffer_load_dwordx4 v[244:247], v1, s[4:7], s90 offen offset:1024 sc1
    buffer_load_dwordx4 v[248:251], v1, s[4:7], s90 offen offset:2048 sc1
    v_mul_f32 v15, 0x3b000000, v15
    v_fma_f32 v15, -v14, v14, v15
    v_max_f32 v15, 0, v15
    s_waitcnt vmcnt(16) lgkmcnt(2)
    v_mfma_f32_32x32x16_bf16 v[80:95], v[40:43], v[184:187], v[80:95]
    ds_read_b128 v[32:35], v2 offset:16384
    ds_read_b128 v[48:51], v2 offset:49152
    v_mfma_f32_32x32x16_bf16 v[96:111], v[184:187], v[56:59], v[96:111]
    buffer_load_dwordx4 v[252:255], v1, s[4:7], s90 offen offset:3072 sc1
    v_add_f32 v15, 0x3727c5ac, v15
    v_rsq_f32 v8, v15
    v_cvt_pk_bf16_f32 v15, v14, v14
    v_lshlrev_b32 v15, 16, v15
    s_lshl_b32 s91, s64, 7
    s_add_u32 s91, s91, 162816
    v_add_u32 v20, s91, v6
    s_waitcnt vmcnt(16) lgkmcnt(2)
    v_mfma_f32_32x32x16_bf16 v[80:95], v[44:47], v[188:191], v[80:95]
    ds_read_b128 v[36:39], v2 offset:17408
    ds_read_b128 v[52:55], v2 offset:50176
    v_mfma_f32_32x32x16_bf16 v[96:111], v[188:191], v[60:63], v[96:111]
    ds_write_b32 v20, v8
    v_sub_f32 v15, v14, v15
    v_cvt_pk_bf16_f32 v20, v14, v15
    v_cvt_pk_bf16_f32 v21, v14, v15
    v_cvt_pk_bf16_f32 v22, v14, v15
    s_waitcnt vmcnt(15) lgkmcnt(3)
    v_mfma_f32_32x32x16_bf16 v[80:95], v[32:35], v[192:195], v[80:95]
    ds_read_b128 v[40:43], v2 offset:18432
    ds_read_b128 v[56:59], v2 offset:51200
    v_mfma_f32_32x32x16_bf16 v[96:111], v[192:195], v[48:51], v[96:111]
    s_add_u32 m0, s77, 65536
    s_add_u32 s93, s60, 65536
    buffer_load_dwordx4 v4, s[24:27], s93 offen sc1 lds
    buffer_load_dwordx4 v4, s[24:27], s93 offen offset:1024 sc1 lds
    v_cvt_pk_bf16_f32 v23, v14, v15
    ds_read_b128 v[112:115], v10 offset:0
    ds_read_b128 v[116:119], v10 offset:32
    ds_read_b128 v[120:123], v10 offset:64
    ds_read_b128 v[124:127], v10 offset:96
    s_waitcnt vmcnt(16) lgkmcnt(7)
    v_mfma_f32_32x32x16_bf16 v[80:95], v[36:39], v[196:199], v[80:95]
    ds_read_b128 v[44:47], v2 offset:19456
    ds_read_b128 v[60:63], v2 offset:52224
    v_mfma_f32_32x32x16_bf16 v[96:111], v[196:199], v[52:55], v[96:111]
    s_mul_i32 s91, s64, 4352
    v_add_u32 v12, s91, v11
    v_lshrrev_b32 v15, 3, v0
    v_lshl_add_u32 v15, v15, 10, v12
    v_mov_b32 v28, s68
    s_mov_b64 s[92:93], 0x101
    v_mov_b32 v25, 0x3f803f80
    v_cndmask_b32_e64 v24, 0, v25, s[92:93]
    s_waitcnt vmcnt(15) lgkmcnt(6)
    v_mfma_f32_32x32x16_bf16 v[80:95], v[40:43], v[200:203], v[80:95]
    ds_read_b128 v[32:35], v2 offset:20480
    ds_read_b128 v[48:51], v2 offset:53248
    v_mfma_f32_32x32x16_bf16 v[96:111], v[200:203], v[56:59], v[96:111]
    s_add_u32 m0, s77, 73728
    s_add_u32 s93, s61, 65536
    buffer_load_dwordx4 v4, s[24:27], s93 offen sc1 lds
    buffer_load_dwordx4 v4, s[24:27], s93 offen offset:1024 sc1 lds
    v_mov_b32 v25, v24
    v_mov_b32 v26, v24
    v_mov_b32 v27, v24
    s_lshl1_add_u32 s8, s76, s8
    s_lshl1_add_u32 s9, s76, s9
    s_waitcnt vmcnt(16) lgkmcnt(2)
    v_mfma_f32_32x32x16_bf16 v[80:95], v[44:47], v[204:207], v[80:95]
    ds_read_b128 v[36:39], v2 offset:21504
    ds_read_b128 v[52:55], v2 offset:54272
    v_mfma_f32_32x32x16_bf16 v[96:111], v[204:207], v[60:63], v[96:111]
    s_waitcnt vmcnt(15) lgkmcnt(2)
    v_mfma_f32_32x32x16_bf16 v[80:95], v[32:35], v[208:211], v[80:95]
    ds_read_b128 v[40:43], v2 offset:22528
    ds_read_b128 v[56:59], v2 offset:55296
    v_mfma_f32_32x32x16_bf16 v[96:111], v[208:211], v[48:51], v[96:111]
    s_add_u32 m0, s77, 81920
    s_add_u32 s93, s62, 65536
    buffer_load_dwordx4 v4, s[24:27], s93 offen sc1 lds
    buffer_load_dwordx4 v4, s[24:27], s93 offen offset:1024 sc1 lds
    s_waitcnt vmcnt(16) lgkmcnt(2)
    v_mfma_f32_32x32x16_bf16 v[80:95], v[36:39], v[212:215], v[80:95]
    ds_read_b128 v[44:47], v2 offset:23552
    ds_read_b128 v[60:63], v2 offset:56320
    v_mfma_f32_32x32x16_bf16 v[96:111], v[212:215], v[52:55], v[96:111]
    s_waitcnt vmcnt(15) lgkmcnt(2)
    v_mfma_f32_32x32x16_bf16 v[80:95], v[40:43], v[216:219], v[80:95]
    ds_read_b128 v[32:35], v2 offset:24576
    ds_read_b128 v[48:51], v2 offset:57344
    v_mfma_f32_32x32x16_bf16 v[96:111], v[216:219], v[56:59], v[96:111]
    s_add_u32 m0, s77, 90112
    s_add_u32 s93, s63, 65536
    buffer_load_dwordx4 v4, s[24:27], s93 offen sc1 lds
    buffer_load_dwordx4 v4, s[24:27], s93 offen offset:1024 sc1 lds
    s_waitcnt vmcnt(16) lgkmcnt(2)
    v_mfma_f32_32x32x16_bf16 v[80:95], v[44:47], v[220:223], v[80:95]
    ds_read_b128 v[36:39], v2 offset:25600
    ds_read_b128 v[52:55], v2 offset:58368
    v_mfma_f32_32x32x16_bf16 v[96:111], v[220:223], v[60:63], v[96:111]
    s_waitcnt vmcnt(15) lgkmcnt(2)
    v_mfma_f32_32x32x16_bf16 v[80:95], v[32:35], v[224:227], v[80:95]
    s_barrier
    ds_read_b128 v[40:43], v2 offset:26624
    ds_read_b128 v[56:59], v2 offset:59392
    v_mfma_f32_32x32x16_bf16 v[96:111], v[224:227], v[48:51], v[96:111]
    s_waitcnt vmcnt(14) lgkmcnt(2)
    v_mfma_f32_32x32x16_bf16 v[80:95], v[36:39], v[228:231], v[80:95]
    ds_read_b128 v[44:47], v2 offset:27648
    ds_read_b128 v[60:63], v2 offset:60416
    v_mfma_f32_32x32x16_bf16 v[96:111], v[228:231], v[52:55], v[96:111]
    s_waitcnt vmcnt(13) lgkmcnt(3)
    v_mfma_f32_32x32x16_bf16 v[80:95], v[40:43], v[232:235], v[80:95]
    ds_read_b128 v[32:35], v2 offset:28672
    ds_read_b128 v[36:39], v2 offset:29696
    s_waitcnt vmcnt(12) lgkmcnt(3)
    v_mfma_f32_32x32x16_bf16 v[80:95], v[44:47], v[236:239], v[80:95]
    ds_read_b128 v[40:43], v2 offset:30720
    ds_read_b128 v[48:51], v2 offset:61440
    s_waitcnt vmcnt(11) lgkmcnt(3)
    v_mfma_f32_32x32x16_bf16 v[80:95], v[32:35], v[240:243], v[80:95]
    ds_read_b128 v[44:47], v2 offset:31744
    ds_read_b128 v[52:55], v2 offset:62464
    s_waitcnt vmcnt(10) lgkmcnt(4)
    v_mfma_f32_32x32x16_bf16 v[80:95], v[36:39], v[244:247], v[80:95]
    ds_read_b128 v[32:35], v11 offset:28672
    s_waitcnt vmcnt(9) lgkmcnt(4)
    v_mfma_f32_32x32x16_bf16 v[80:95], v[40:43], v[248:251], v[80:95]
    s_waitcnt vmcnt(8) lgkmcnt(2)
    v_mfma_f32_32x32x16_bf16 v[80:95], v[44:47], v[252:255], v[80:95]
    s_waitcnt lgkmcnt(0)
    v_mfma_f32_32x32x16_bf16 v[80:95], v[32:35], v[20:23], v[80:95]
    v_mfma_f32_32x32x16_bf16 v[96:111], v[232:235], v[56:59], v[96:111]
    ds_read_b128 v[56:59], v2 offset:63488
    v_mfma_f32_32x32x16_bf16 v[96:111], v[236:239], v[60:63], v[96:111]
    ds_read_b128 v[60:63], v2 offset:64512
    s_nop 7
    v_pk_mul_f32 v[80:81], v[80:81], v[8:9] op_sel_hi:[1,0]
    v_pk_mul_f32 v[82:83], v[82:83], v[8:9] op_sel_hi:[1,0]
    v_pk_mul_f32 v[84:85], v[84:85], v[8:9] op_sel_hi:[1,0]
    v_pk_mul_f32 v[86:87], v[86:87], v[8:9] op_sel_hi:[1,0]
    v_mfma_f32_32x32x16_bf16 v[96:111], v[240:243], v[48:51], v[96:111]
    ds_read_b128 v[48:51], v11 offset:29696
    v_cvt_pk_bf16_f32 v32, v80, v81
    v_cvt_pk_bf16_f32 v33, v82, v83
    v_cvt_pk_bf16_f32 v34, v84, v85
    v_cvt_pk_bf16_f32 v35, v86, v87
    v_mfma_f32_32x32x16_bf16 v[96:111], v[244:247], v[52:55], v[96:111]
    buffer_store_dwordx4 v[32:35], v1, s[32:35], s48 offen offset:0 sc1
    v_pk_mul_f32 v[88:89], v[88:89], v[8:9] op_sel_hi:[1,0]
    v_pk_mul_f32 v[90:91], v[90:91], v[8:9] op_sel_hi:[1,0]
    v_pk_mul_f32 v[92:93], v[92:93], v[8:9] op_sel_hi:[1,0]
    s_waitcnt lgkmcnt(2)
    v_mfma_f32_32x32x16_bf16 v[96:111], v[248:251], v[56:59], v[96:111]
    v_pk_mul_f32 v[94:95], v[94:95], v[8:9] op_sel_hi:[1,0]
    v_cvt_pk_bf16_f32 v36, v88, v89
    v_cvt_pk_bf16_f32 v37, v90, v91
    v_cvt_pk_bf16_f32 v38, v92, v93
    s_waitcnt lgkmcnt(1)
    v_mfma_f32_32x32x16_bf16 v[96:111], v[252:255], v[60:63], v[96:111]
    v_cvt_pk_bf16_f32 v39, v94, v95
    buffer_store_dwordx4 v[36:39], v1, s[32:35], s48 offen offset:1024 sc1
    ds_write_b128 v12, v[32:35] offset:0
    ds_write_b128 v12, v[36:39] offset:1024
    s_waitcnt lgkmcnt(2)
    v_mfma_f32_32x32x16_bf16 v[96:111], v[20:23], v[48:51], v[96:111]
    s_mov_b64 exec, 0xffff
    ds_write_b128 v15, v[24:27] offset:3072
    s_mov_b64 exec, -1
    s_waitcnt vmcnt(2)
    s_barrier
    ds_read_b128 v[48:51], v3 offset:0
    ds_read_b128 v[52:55], v3 offset:1024
    ds_read_b128 v[56:59], v3 offset:2048
    ds_read_b128 v[60:63], v3 offset:3072
    s_nop 2
    v_pk_mul_f32 v[96:97], v[96:97], v[112:113]
    v_pk_mul_f32 v[98:99], v[98:99], v[114:115]
    v_pk_mul_f32 v[100:101], v[100:101], v[116:117]
    v_pk_mul_f32 v[102:103], v[102:103], v[118:119]
    v_cvt_pk_bf16_f32 v40, v96, v97
    v_cvt_pk_bf16_f32 v41, v98, v99
    v_cvt_pk_bf16_f32 v42, v100, v101
    v_cvt_pk_bf16_f32 v43, v102, v103
    buffer_store_dwordx4 v[40:43], v1, s[32:35], s48 offen offset:2048 sc1
    v_pk_mul_f32 v[104:105], v[104:105], v[120:121]
    v_pk_mul_f32 v[106:107], v[106:107], v[122:123]
    v_pk_mul_f32 v[108:109], v[108:109], v[124:125]
    v_pk_mul_f32 v[110:111], v[110:111], v[126:127]
    v_cvt_pk_bf16_f32 v44, v104, v105
    v_cvt_pk_bf16_f32 v45, v106, v107
    v_cvt_pk_bf16_f32 v46, v108, v109
    v_cvt_pk_bf16_f32 v47, v110, v111
    buffer_store_dwordx4 v[44:47], v1, s[32:35], s48 offen offset:3200 sc1
    s_waitcnt lgkmcnt(3)
    v_mfma_f32_32x32x16_bf16 v[112:127], v[48:51], v[128:131], 0
    ds_write_b128 v12, v[40:43] offset:2048
    ds_read_b128 v[32:35], v3 offset:4096
    s_lshr_b32 s92, s64, 1
    s_lshl_b32 s91, s92, 10
    v_add_u32 v17, s91, v1
    s_waitcnt lgkmcnt(4)
    v_mfma_f32_32x32x16_bf16 v[112:127], v[52:55], v[132:135], v[112:127]
    ds_read_b128 v[36:39], v3 offset:5120
    s_lshr_b32 s92, s64, 1
    s_lshl_b32 s91, s92, 8
    v_add_u32 v18, s91, v1
    s_waitcnt lgkmcnt(4)
    v_mfma_f32_32x32x16_bf16 v[112:127], v[56:59], v[136:139], v[112:127]
    ds_write_b128 v12, v[44:47] offset:3200
    ds_read_b128 v[40:43], v3 offset:6144
    v_and_b32 v16, 11, v0
    v_min_u32 v16, 1, v16
    v_or_b32 v16, 64, v16
    s_waitcnt lgkmcnt(5)
    v_mfma_f32_32x32x16_bf16 v[112:127], v[60:63], v[140:143], v[112:127]
    ds_read_b128 v[44:47], v3 offset:7168
    v_lshlrev_b32 v16, 4, v16
    v_cndmask_b32_e64 v18, v18, v16, s[96:97]
    s_waitcnt lgkmcnt(4)
    v_mfma_f32_32x32x16_bf16 v[112:127], v[32:35], v[144:147], v[112:127]
    ds_read_b128 v[48:51], v3 offset:8192
    v_add_u32 v14, 131072, v17
    v_add_u32 v15, 131072, v18
    ds_read_b128 a[96:99], v5 offset:0
    s_waitcnt lgkmcnt(5)
    v_mfma_f32_32x32x16_bf16 v[112:127], v[36:39], v[148:151], v[112:127]
    ds_read_b128 v[52:55], v3 offset:9216
    v_mul_f32 v8, 0x3eb8aa3b, v8
    v_mov_b32 v16, 0xff800000
    ds_read_b128 a[100:103], v5 offset:1024
    s_waitcnt lgkmcnt(5)
    v_mfma_f32_32x32x16_bf16 v[112:127], v[40:43], v[152:155], v[112:127]
    ds_read_b128 v[56:59], v3 offset:10240
    v_lshrrev_b32 v29, 5, v0
    v_mad_i32_i24 v29, v29, -16, v6
    v_mov_b32 v30, 0
    v_cmp_le_i32 vcc, 0, v29
    ds_read_b128 a[104:107], v5 offset:8192
    s_waitcnt lgkmcnt(6)
    v_mfma_f32_32x32x16_bf16 v[112:127], v[44:47], v[156:159], v[112:127]
    ds_read_b128 v[60:63], v3 offset:11264
    v_cndmask_b32 v80, v16, v30, vcc
    v_cndmask_b32 v96, 0, v16, vcc
    v_cmp_le_i32 vcc, 4, v29
    ds_read_b128 a[108:111], v5 offset:9216
    s_waitcnt lgkmcnt(7)
    v_mfma_f32_32x32x16_bf16 v[112:127], v[48:51], v[160:163], v[112:127]
    ds_read_b128 v[32:35], v3 offset:12288
    v_cndmask_b32 v81, v16, v30, vcc
    v_cndmask_b32 v97, 0, v16, vcc
    v_cmp_le_i32 vcc, 8, v29
    ds_read_b128 a[112:115], v5 offset:16384
    s_waitcnt lgkmcnt(7)
    v_mfma_f32_32x32x16_bf16 v[112:127], v[52:55], v[164:167], v[112:127]
    ds_read_b128 v[36:39], v3 offset:13312
    v_cndmask_b32 v82, v16, v30, vcc
    v_cndmask_b32 v98, 0, v16, vcc
    v_cmp_le_i32 vcc, 12, v29
    ds_read_b128 a[116:119], v5 offset:17408
    s_waitcnt lgkmcnt(7)
    v_mfma_f32_32x32x16_bf16 v[112:127], v[56:59], v[168:171], v[112:127]
    ds_read_b128 v[40:43], v3 offset:14336
    v_cndmask_b32 v83, v16, v30, vcc
    v_cndmask_b32 v99, 0, v16, vcc
    v_cmp_le_i32 vcc, 32, v29
    ds_read_b128 a[120:123], v5 offset:24576
    s_waitcnt lgkmcnt(7)
    v_mfma_f32_32x32x16_bf16 v[112:127], v[60:63], v[172:175], v[112:127]
    ds_read_b128 v[44:47], v3 offset:15360
    v_cndmask_b32 v84, v16, v30, vcc
    v_cndmask_b32 v100, 0, v16, vcc
    v_cmp_le_i32 vcc, 36, v29
    ds_read_b128 a[124:127], v5 offset:25600
    s_waitcnt lgkmcnt(7)
    v_mfma_f32_32x32x16_bf16 v[112:127], v[32:35], v[176:179], v[112:127]
    ds_read_b128 v[48:51], v3 offset:16384
    v_cndmask_b32 v85, v16, v30, vcc
    v_cndmask_b32 v101, 0, v16, vcc
    v_cmp_le_i32 vcc, 40, v29
    s_barrier
    s_waitcnt lgkmcnt(6)
    v_mfma_f32_32x32x16_bf16 v[112:127], v[36:39], v[180:183], v[112:127]
    ds_read_b128 v[52:55], v3 offset:17408
    v_cndmask_b32 v86, v16, v30, vcc
    v_cndmask_b32 v102, 0, v16, vcc
    v_cmp_le_i32 vcc, 44, v29
    s_waitcnt lgkmcnt(5)
    v_mfma_f32_32x32x16_bf16 v[112:127], v[40:43], v[184:187], v[112:127]
    ds_read_b128 v[56:59], v3 offset:18432
    v_cndmask_b32 v87, v16, v30, vcc
    v_cndmask_b32 v103, 0, v16, vcc
    v_cmp_le_i32 vcc, 64, v29
    s_waitcnt lgkmcnt(4)
    v_mfma_f32_32x32x16_bf16 v[112:127], v[44:47], v[188:191], v[112:127]
    ds_read_b128 v[60:63], v3 offset:19456
    v_cndmask_b32 v88, v16, v30, vcc
    v_cndmask_b32 v104, 0, v16, vcc
    v_cmp_le_i32 vcc, 68, v29
    s_waitcnt lgkmcnt(3)
    v_mfma_f32_32x32x16_bf16 v[112:127], v[48:51], v[192:195], v[112:127]
    ds_read_b128 v[32:35], v3 offset:20480
    v_cndmask_b32 v89, v16, v30, vcc
    v_cndmask_b32 v105, 0, v16, vcc
    v_cmp_le_i32 vcc, 72, v29
    s_waitcnt lgkmcnt(3)
    v_mfma_f32_32x32x16_bf16 v[112:127], v[52:55], v[196:199], v[112:127]
    ds_read_b128 v[36:39], v3 offset:21504
    v_cndmask_b32 v90, v16, v30, vcc
    v_cndmask_b32 v106, 0, v16, vcc
    v_cmp_le_i32 vcc, 76, v29
    ds_read_b128 v[128:131], v14 offset:0
    s_waitcnt lgkmcnt(4)
    v_mfma_f32_32x32x16_bf16 v[112:127], v[56:59], v[200:203], v[112:127]
    ds_read_b128 v[40:43], v3 offset:22528
    v_cndmask_b32 v91, v16, v30, vcc
    v_cndmask_b32 v107, 0, v16, vcc
    v_cmp_le_i32 vcc, 96, v29
    ds_read_b128 v[132:135], v15 offset:2048
    s_waitcnt vmcnt(0)
    buffer_store_dword v28, v6, s[32:35], s49 offen sc1
    s_waitcnt lgkmcnt(5)
    v_mfma_f32_32x32x16_bf16 v[112:127], v[60:63], v[204:207], v[112:127]
    ds_read_b128 v[44:47], v3 offset:23552
    v_cndmask_b32 v92, v16, v30, vcc
    v_cndmask_b32 v108, 0, v16, vcc
    v_cmp_le_i32 vcc, 100, v29
    ds_read_b128 v[136:139], v15 offset:3200
    s_waitcnt lgkmcnt(6)
    v_mfma_f32_32x32x16_bf16 v[112:127], v[32:35], v[208:211], v[112:127]
    ds_read_b128 v[48:51], v3 offset:24576
    v_cndmask_b32 v93, v16, v30, vcc
    v_cndmask_b32 v109, 0, v16, vcc
    v_cmp_le_i32 vcc, 104, v29
    ds_read_b128 v[140:143], v14 offset:4352
    s_waitcnt lgkmcnt(7)
    v_mfma_f32_32x32x16_bf16 v[112:127], v[36:39], v[212:215], v[112:127]
    ds_read_b128 v[52:55], v3 offset:25600
    v_cndmask_b32 v94, v16, v30, vcc
    v_cndmask_b32 v110, 0, v16, vcc
    v_cmp_le_i32 vcc, 108, v29
    ds_read_b128 v[144:147], v15 offset:6400
    s_waitcnt lgkmcnt(7)
    v_mfma_f32_32x32x16_bf16 v[112:127], v[40:43], v[216:219], v[112:127]
    ds_read_b128 v[56:59], v3 offset:26624
    v_cndmask_b32 v95, v16, v30, vcc
    v_cndmask_b32 v111, 0, v16, vcc
    ds_read_b128 v[148:151], v15 offset:7552
    s_waitcnt lgkmcnt(7)
    v_mfma_f32_32x32x16_bf16 v[112:127], v[44:47], v[220:223], v[112:127]
    ds_read_b128 v[60:63], v3 offset:27648
    ds_read_b128 v[152:155], v14 offset:8704
    s_waitcnt lgkmcnt(7)
    v_mfma_f32_32x32x16_bf16 v[112:127], v[48:51], v[224:227], v[112:127]
    ds_read_b128 v[32:35], v3 offset:28672
    ds_read_b128 v[156:159], v15 offset:10752
    s_waitcnt lgkmcnt(7)
    v_mfma_f32_32x32x16_bf16 v[112:127], v[52:55], v[228:231], v[112:127]
    ds_read_b128 v[36:39], v3 offset:29696
    ds_read_b128 v[160:163], v15 offset:11904
    s_waitcnt lgkmcnt(7)
    v_mfma_f32_32x32x16_bf16 v[112:127], v[56:59], v[232:235], v[112:127]
    ds_read_b128 v[40:43], v3 offset:30720
    ds_read_b128 v[164:167], v14 offset:13056
L_pad3:
    s_cbranch_execz L_pad4
    s_waitcnt lgkmcnt(7)
    v_mfma_f32_32x32x16_bf16 v[112:127], v[60:63], v[236:239], v[112:127]
    ds_read_b128 v[44:47], v3 offset:31744
    ds_read_b128 v[168:171], v15 offset:15104
    s_waitcnt lgkmcnt(7)
    v_mfma_f32_32x32x16_bf16 v[112:127], v[32:35], v[240:243], v[112:127]
    ds_read_b128 v[48:51], v11 offset:30720
    ds_read_b128 v[172:175], v15 offset:16256
    s_waitcnt lgkmcnt(7)
    v_mfma_f32_32x32x16_bf16 v[112:127], v[36:39], v[244:247], v[112:127]
    s_waitcnt lgkmcnt(5)
    v_mfma_f32_32x32x16_bf16 v[112:127], v[40:43], v[248:251], v[112:127]
    v_add_u32 v16, s51, v17
    v_add_u32 v12, s51, v18
    s_waitcnt lgkmcnt(3)
    v_mfma_f32_32x32x16_bf16 v[112:127], v[44:47], v[252:255], v[112:127]
    s_waitcnt lgkmcnt(1)
    v_mfma_f32_32x32x16_bf16 v[112:127], v[48:51], v[20:23], v[112:127]
    s_cmp_eq_u32 s64, 1
    s_cbranch_scc1 L_att1_45
    s_cmp_eq_u32 s64, 2
    s_cbranch_scc1 L_att2_46
    s_cmp_eq_u32 s64, 0
    s_cbranch_scc1 L_att0_44
L_att3_47:
    s_nop 5
    v_pk_mul_f32 v[112:113], v[112:113], v[8:9] op_sel_hi:[1,0]
    v_pk_mul_f32 v[114:115], v[114:115], v[8:9] op_sel_hi:[1,0]
    v_pk_mul_f32 v[116:117], v[116:117], v[8:9] op_sel_hi:[1,0]
    v_pk_mul_f32 v[118:119], v[118:119], v[8:9] op_sel_hi:[1,0]
    v_cvt_pk_bf16_f32 v24, v112, v113
    v_cvt_pk_bf16_f32 v25, v114, v115
    v_cvt_pk_bf16_f32 v26, v116, v117
    v_cvt_pk_bf16_f32 v27, v118, v119
    ds_write_b128 v11, v[24:27] offset:20480
    v_pk_mul_f32 v[120:121], v[120:121], v[8:9] op_sel_hi:[1,0]
    v_pk_mul_f32 v[122:123], v[122:123], v[8:9] op_sel_hi:[1,0]
    v_pk_mul_f32 v[124:125], v[124:125], v[8:9] op_sel_hi:[1,0]
    v_pk_mul_f32 v[126:127], v[126:127], v[8:9] op_sel_hi:[1,0]
    v_cvt_pk_bf16_f32 v28, v120, v121
    v_cvt_pk_bf16_f32 v29, v122, v123
    v_cvt_pk_bf16_f32 v30, v124, v125
    v_cvt_pk_bf16_f32 v31, v126, v127
    s_waitcnt lgkmcnt(0)
    s_nop 0
    v_mfma_f32_32x32x16_bf16 v[224:239], v[128:131], v[28:31], 0
    s_barrier
    ds_read_b128 v[24:27], v11 offset:17408
    s_mov_b64 exec, 0xff
    buffer_load_dword v13, v9, s[32:35], s50 offen sc1
    s_mov_b64 exec, -1
    s_nop 6
    v_exp_f32 v224, v224
    v_exp_f32 v225, v225
    v_exp_f32 v226, v226
    v_cvt_pk_bf16_f32 v112, v224, v225
    v_exp_f32 v227, v227
    v_exp_f32 v228, v228
    v_cvt_pk_bf16_f32 v113, v226, v227
    v_exp_f32 v229, v229
    v_exp_f32 v230, v230
    v_cvt_pk_bf16_f32 v114, v228, v229
    v_exp_f32 v231, v231
    s_waitcnt lgkmcnt(0)
    v_mfma_f32_32x32x16_bf16 v[240:255], v[128:131], v[24:27], v[80:95]
    v_exp_f32 v232, v232
    v_cvt_pk_bf16_f32 v115, v230, v231
    v_exp_f32 v233, v233
    v_exp_f32 v234, v234
    v_cvt_pk_bf16_f32 v116, v232, v233
    v_exp_f32 v235, v235
    v_mfma_f32_32x32x16_bf16 v[48:63], v[132:135], v[112:115], 0
    v_exp_f32 v236, v236
    v_cvt_pk_bf16_f32 v117, v234, v235
    v_exp_f32 v237, v237
    v_exp_f32 v238, v238
    v_cvt_pk_bf16_f32 v118, v236, v237
    v_exp_f32 v239, v239
    v_exp_f32 v240, v240
    v_cvt_pk_bf16_f32 v119, v238, v239
    v_exp_f32 v241, v241
    v_exp_f32 v242, v242
    v_cvt_pk_bf16_f32 v112, v240, v241
    v_mfma_f32_32x32x16_bf16 v[48:63], v[136:139], v[116:119], v[48:63]
    v_exp_f32 v243, v243
    v_exp_f32 v244, v244
    v_cvt_pk_bf16_f32 v113, v242, v243
    v_exp_f32 v245, v245
    v_mfma_f32_32x32x16_bf16 v[224:239], v[140:143], v[28:31], 0
    v_exp_f32 v246, v246
    v_cvt_pk_bf16_f32 v114, v244, v245
    v_exp_f32 v247, v247
    v_exp_f32 v248, v248
    v_cvt_pk_bf16_f32 v115, v246, v247
    v_exp_f32 v249, v249
    v_exp_f32 v250, v250
    v_cvt_pk_bf16_f32 v116, v248, v249
    v_exp_f32 v251, v251
    v_mfma_f32_32x32x16_bf16 v[32:47], v[132:135], v[112:115], 0
    v_exp_f32 v252, v252
    v_cvt_pk_bf16_f32 v117, v250, v251
    v_exp_f32 v253, v253
    v_exp_f32 v254, v254
    v_cvt_pk_bf16_f32 v118, v252, v253
    v_exp_f32 v255, v255
    s_waitcnt vmcnt(0)
L_ro_50:
    v_cmp_ne_u32 vcc, s68, v13
    s_nop 0
    s_and_b64 vcc, vcc, s[52:53]
    s_cbranch_vccz L_rb_51
    s_mov_b64 exec, 0xff
    buffer_load_dword v13, v9, s[32:35], s50 offen sc1
    s_mov_b64 exec, -1
    s_add_u32 s98, s98, 1
    s_cmp_lt_u32 s98, 400000
    s_waitcnt vmcnt(0)
    s_cbranch_scc1 L_ro_50
L_rb_51:
    v_exp_f32 v224, v224
    v_cvt_pk_bf16_f32 v119, v254, v255
    v_exp_f32 v225, v225
    v_exp_f32 v226, v226
    v_cvt_pk_bf16_f32 v112, v224, v225
    v_mfma_f32_32x32x16_bf16 v[32:47], v[136:139], v[116:119], v[32:47]
    s_branch L_attb_49
L_att0_44:
    s_nop 5
    v_pk_mul_f32 v[120:121], v[120:121], v[8:9] op_sel_hi:[1,0]
    v_pk_mul_f32 v[122:123], v[122:123], v[8:9] op_sel_hi:[1,0]
    v_pk_mul_f32 v[124:125], v[124:125], v[8:9] op_sel_hi:[1,0]
    v_pk_mul_f32 v[126:127], v[126:127], v[8:9] op_sel_hi:[1,0]
    v_cvt_pk_bf16_f32 v28, v120, v121
    v_cvt_pk_bf16_f32 v29, v122, v123
    v_cvt_pk_bf16_f32 v30, v124, v125
    v_cvt_pk_bf16_f32 v31, v126, v127
    ds_write_b128 v11, v[28:31] offset:17408
    v_pk_mul_f32 v[112:113], v[112:113], v[8:9] op_sel_hi:[1,0]
    v_pk_mul_f32 v[114:115], v[114:115], v[8:9] op_sel_hi:[1,0]
    v_pk_mul_f32 v[116:117], v[116:117], v[8:9] op_sel_hi:[1,0]
    v_pk_mul_f32 v[118:119], v[118:119], v[8:9] op_sel_hi:[1,0]
    v_cvt_pk_bf16_f32 v24, v112, v113
    v_cvt_pk_bf16_f32 v25, v114, v115
    v_cvt_pk_bf16_f32 v26, v116, v117
    v_cvt_pk_bf16_f32 v27, v118, v119
    s_waitcnt lgkmcnt(0)
    s_nop 0
    v_mfma_f32_32x32x16_bf16 v[224:239], v[128:131], v[24:27], v[80:95]
    s_barrier
    ds_read_b128 v[28:31], v11 offset:20480
    s_mov_b64 exec, 0xff
    buffer_load_dword v13, v9, s[32:35], s50 offen sc1
    s_mov_b64 exec, -1
    s_nop 6
    v_exp_f32 v224, v224
    v_exp_f32 v225, v225
    v_exp_f32 v226, v226
    v_cvt_pk_bf16_f32 v112, v224, v225
    v_exp_f32 v227, v227
    v_exp_f32 v228, v228
    v_cvt_pk_bf16_f32 v113, v226, v227
    v_exp_f32 v229, v229
    v_exp_f32 v230, v230
    v_cvt_pk_bf16_f32 v114, v228, v229
    v_exp_f32 v231, v231
    s_waitcnt lgkmcnt(0)
    v_mfma_f32_32x32x16_bf16 v[240:255], v[128:131], v[28:31], 0
    v_exp_f32 v232, v232
    v_cvt_pk_bf16_f32 v115, v230, v231
    v_exp_f32 v233, v233
    v_exp_f32 v234, v234
    v_cvt_pk_bf16_f32 v116, v232, v233
    v_exp_f32 v235, v235
    v_mfma_f32_32x32x16_bf16 v[32:47], v[132:135], v[112:115], 0
    v_exp_f32 v236, v236
    v_cvt_pk_bf16_f32 v117, v234, v235
    v_exp_f32 v237, v237
    v_exp_f32 v238, v238
    v_cvt_pk_bf16_f32 v118, v236, v237
    v_exp_f32 v239, v239
    v_exp_f32 v240, v240
    v_cvt_pk_bf16_f32 v119, v238, v239
    v_exp_f32 v241, v241
    v_exp_f32 v242, v242
    v_cvt_pk_bf16_f32 v112, v240, v241
    v_mfma_f32_32x32x16_bf16 v[32:47], v[136:139], v[116:119], v[32:47]
    v_exp_f32 v243, v243
    v_exp_f32 v244, v244
    v_cvt_pk_bf16_f32 v113, v242, v243
    v_exp_f32 v245, v245
    v_mfma_f32_32x32x16_bf16 v[224:239], v[140:143], v[28:31], 0
    v_exp_f32 v246, v246
    v_cvt_pk_bf16_f32 v114, v244, v245
    v_exp_f32 v247, v247
    v_exp_f32 v248, v248
    v_cvt_pk_bf16_f32 v115, v246, v247
    v_exp_f32 v249, v249
    v_exp_f32 v250, v250
    v_cvt_pk_bf16_f32 v116, v248, v249
    v_exp_f32 v251, v251
    v_mfma_f32_32x32x16_bf16 v[48:63], v[132:135], v[112:115], 0
    v_exp_f32 v252, v252
    v_cvt_pk_bf16_f32 v117, v250, v251
    v_exp_f32 v253, v253
    v_exp_f32 v254, v254
    v_cvt_pk_bf16_f32 v118, v252, v253
    v_exp_f32 v255, v255
    s_waitcnt vmcnt(0)
L_ro_52:
    v_cmp_ne_u32 vcc, s68, v13
    s_nop 0
    s_and_b64 vcc, vcc, s[52:53]
    s_cbranch_vccz L_rb_53
    s_mov_b64 exec, 0xff
    buffer_load_dword v13, v9, s[32:35], s50 offen sc1
    s_mov_b64 exec, -1
    s_add_u32 s98, s98, 1
    s_cmp_lt_u32 s98, 400000
    s_waitcnt vmcnt(0)
    s_cbranch_scc1 L_ro_52
L_rb_53:
    v_exp_f32 v224, v224
    v_cvt_pk_bf16_f32 v119, v254, v255
    v_exp_f32 v225, v225
    v_exp_f32 v226, v226
    v_cvt_pk_bf16_f32 v112, v224, v225
    v_mfma_f32_32x32x16_bf16 v[48:63], v[136:139], v[116:119], v[48:63]
L_attb_49:
    v_exp_f32 v227, v227
    buffer_load_dwordx4 v[176:179], v16, s[32:35], s12 offen sc1
    v_exp_f32 v228, v228
    v_cvt_pk_bf16_f32 v113, v226, v227
    v_exp_f32 v229, v229
    v_mfma_f32_32x32x16_bf16 v[240:255], v[152:155], v[28:31], 0
    v_exp_f32 v230, v230
    v_cvt_pk_bf16_f32 v114, v228, v229
    v_exp_f32 v231, v231
    v_exp_f32 v232, v232
    v_cvt_pk_bf16_f32 v115, v230, v231
    buffer_load_dwordx4 v[180:183], v12, s[32:35], s12 offen offset:2048 sc1
    v_exp_f32 v233, v233
    v_exp_f32 v234, v234
    v_cvt_pk_bf16_f32 v116, v232, v233
    v_exp_f32 v235, v235
    v_mfma_f32_32x32x16_bf16 v[48:63], v[144:147], v[112:115], v[48:63]
    v_exp_f32 v236, v236
    v_cvt_pk_bf16_f32 v117, v234, v235
    v_exp_f32 v237, v237
    buffer_load_dwordx4 v[184:187], v12, s[32:35], s12 offen offset:3200 sc1
    v_exp_f32 v238, v238
    v_cvt_pk_bf16_f32 v118, v236, v237
    v_exp_f32 v239, v239
    v_exp_f32 v240, v240
    v_cvt_pk_bf16_f32 v119, v238, v239
    v_exp_f32 v241, v241
    v_exp_f32 v242, v242
    v_cvt_pk_bf16_f32 v112, v240, v241
    v_mfma_f32_32x32x16_bf16 v[48:63], v[148:151], v[116:119], v[48:63]
    v_exp_f32 v243, v243
    buffer_load_dwordx4 v[188:191], v16, s[32:35], s13 offen sc1
    v_exp_f32 v244, v244
    v_cvt_pk_bf16_f32 v113, v242, v243
    v_exp_f32 v245, v245
    v_mfma_f32_32x32x16_bf16 v[224:239], v[164:167], v[28:31], v[80:95]
    v_exp_f32 v246, v246
    v_cvt_pk_bf16_f32 v114, v244, v245
    v_exp_f32 v247, v247
    v_exp_f32 v248, v248
    v_cvt_pk_bf16_f32 v115, v246, v247
    buffer_load_dwordx4 v[192:195], v12, s[32:35], s13 offen offset:2048 sc1
    v_exp_f32 v249, v249
    v_exp_f32 v250, v250
    v_cvt_pk_bf16_f32 v116, v248, v249
    v_exp_f32 v251, v251
    v_mfma_f32_32x32x16_bf16 v[48:63], v[156:159], v[112:115], v[48:63]
    v_exp_f32 v252, v252
    v_cvt_pk_bf16_f32 v117, v250, v251
    v_exp_f32 v253, v253
    buffer_load_dwordx4 v[196:199], v12, s[32:35], s13 offen offset:3200 sc1
    v_exp_f32 v254, v254
    v_cvt_pk_bf16_f32 v118, v252, v253
    v_exp_f32 v255, v255
    s_add_u32 s69, s68, 9
    v_mov_b32 v13, s69
    v_exp_f32 v224, v224
    v_cvt_pk_bf16_f32 v119, v254, v255
    v_exp_f32 v225, v225
    v_exp_f32 v226, v226
    v_cvt_pk_bf16_f32 v112, v224, v225
    v_mfma_f32_32x32x16_bf16 v[48:63], v[160:163], v[116:119], v[48:63]
    v_exp_f32 v227, v227
    buffer_load_dwordx4 v[200:203], v16, s[32:35], s14 offen sc1
    v_exp_f32 v228, v228
    v_cvt_pk_bf16_f32 v113, v226, v227
    v_exp_f32 v229, v229
    s_waitcnt vmcnt(6)
    v_mfma_f32_32x32x16_bf16 v[240:255], v[176:179], v[24:27], 0
    v_exp_f32 v230, v230
    v_cvt_pk_bf16_f32 v114, v228, v229
    v_exp_f32 v231, v231
    v_exp_f32 v232, v232
    v_cvt_pk_bf16_f32 v115, v230, v231
    buffer_load_dwordx4 v[204:207], v12, s[32:35], s14 offen offset:2048 sc1
    v_exp_f32 v233, v233
    v_exp_f32 v234, v234
    v_cvt_pk_bf16_f32 v116, v232, v233
    v_exp_f32 v235, v235
    v_mfma_f32_32x32x16_bf16 v[48:63], v[168:171], v[112:115], v[48:63]
    v_exp_f32 v236, v236
    v_cvt_pk_bf16_f32 v117, v234, v235
    v_exp_f32 v237, v237
    buffer_load_dwordx4 v[208:211], v12, s[32:35], s14 offen offset:3200 sc1
    v_exp_f32 v238, v238
    v_cvt_pk_bf16_f32 v118, v236, v237
    v_exp_f32 v239, v239
    v_exp_f32 v240, v240
    v_cvt_pk_bf16_f32 v119, v238, v239
    v_exp_f32 v241, v241
    v_exp_f32 v242, v242
    v_cvt_pk_bf16_f32 v112, v240, v241
    v_mfma_f32_32x32x16_bf16 v[48:63], v[172:175], v[116:119], v[48:63]
    v_exp_f32 v243, v243
    buffer_load_dwordx4 v[212:215], v16, s[32:35], s15 offen sc1
    v_exp_f32 v244, v244
    v_cvt_pk_bf16_f32 v113, v242, v243
    v_exp_f32 v245, v245
    v_mfma_f32_32x32x16_bf16 v[224:239], v[176:179], v[28:31], 0
    v_exp_f32 v246, v246
    v_cvt_pk_bf16_f32 v114, v244, v245
    v_exp_f32 v247, v247
    v_exp_f32 v248, v248
    v_cvt_pk_bf16_f32 v115, v246, v247
    buffer_load_dwordx4 v[216:219], v12, s[32:35], s15 offen offset:2048 sc1
    v_exp_f32 v249, v249
    v_exp_f32 v250, v250
    v_cvt_pk_bf16_f32 v116, v248, v249
    v_exp_f32 v251, v251
    s_waitcnt vmcnt(8)
    v_mfma_f32_32x32x16_bf16 v[32:47], v[180:183], v[112:115], v[32:47]
    v_exp_f32 v252, v252
    v_cvt_pk_bf16_f32 v117, v250, v251
    v_exp_f32 v253, v253
    buffer_load_dwordx4 v[220:223], v12, s[32:35], s15 offen offset:3200 sc1
    v_exp_f32 v254, v254
    v_cvt_pk_bf16_f32 v118, v252, v253
    v_exp_f32 v255, v255
    v_exp_f32 v224, v224
    v_cvt_pk_bf16_f32 v119, v254, v255
    v_exp_f32 v225, v225
    v_exp_f32 v226, v226
    v_cvt_pk_bf16_f32 v112, v224, v225
    v_mfma_f32_32x32x16_bf16 v[32:47], v[184:187], v[116:119], v[32:47]
    v_exp_f32 v227, v227
    v_add_u32 v16, s54, v17
    v_add_u32 v12, s54, v18
    buffer_load_dwordx4 v[128:131], v16, s[32:35], s16 offen sc1
    v_exp_f32 v228, v228
    v_cvt_pk_bf16_f32 v113, v226, v227
    v_exp_f32 v229, v229
    s_waitcnt vmcnt(9)
    v_mfma_f32_32x32x16_bf16 v[240:255], v[188:191], v[24:27], 0
    v_exp_f32 v230, v230
    v_cvt_pk_bf16_f32 v114, v228, v229
    v_exp_f32 v231, v231
    v_exp_f32 v232, v232
    v_cvt_pk_bf16_f32 v115, v230, v231
    buffer_load_dwordx4 v[132:135], v12, s[32:35], s16 offen offset:2048 sc1
    v_exp_f32 v233, v233
    v_exp_f32 v234, v234
    v_cvt_pk_bf16_f32 v116, v232, v233
    v_exp_f32 v235, v235
    v_mfma_f32_32x32x16_bf16 v[48:63], v[180:183], v[112:115], v[48:63]
    v_exp_f32 v236, v236
    v_cvt_pk_bf16_f32 v117, v234, v235
    v_exp_f32 v237, v237
    buffer_load_dwordx4 v[136:139], v12, s[32:35], s16 offen offset:3200 sc1
    v_exp_f32 v238, v238
    v_cvt_pk_bf16_f32 v118, v236, v237
    v_exp_f32 v239, v239
    v_exp_f32 v240, v240
    v_cvt_pk_bf16_f32 v119, v238, v239
    v_exp_f32 v241, v241
    v_exp_f32 v242, v242
    v_cvt_pk_bf16_f32 v112, v240, v241
    v_mfma_f32_32x32x16_bf16 v[48:63], v[184:187], v[116:119], v[48:63]
    v_exp_f32 v243, v243
    buffer_load_dwordx4 v[140:143], v16, s[32:35], s17 offen sc1
    v_exp_f32 v244, v244
    v_cvt_pk_bf16_f32 v113, v242, v243
    v_exp_f32 v245, v245
    v_mfma_f32_32x32x16_bf16 v[224:239], v[188:191], v[28:31], 0
    v_exp_f32 v246, v246
    v_cvt_pk_bf16_f32 v114, v244, v245
    v_exp_f32 v247, v247
    v_exp_f32 v248, v248
    v_cvt_pk_bf16_f32 v115, v246, v247
    buffer_load_dwordx4 v[144:147], v12, s[32:35], s17 offen offset:2048 sc1
    v_exp_f32 v249, v249
    v_exp_f32 v250, v250
    v_cvt_pk_bf16_f32 v116, v248, v249
    v_exp_f32 v251, v251
    s_waitcnt vmcnt(11)
    v_mfma_f32_32x32x16_bf16 v[32:47], v[192:195], v[112:115], v[32:47]
    v_exp_f32 v252, v252
    v_cvt_pk_bf16_f32 v117, v250, v251
    v_exp_f32 v253, v253
    buffer_load_dwordx4 v[148:151], v12, s[32:35], s17 offen offset:3200 sc1
    v_exp_f32 v254, v254
    v_cvt_pk_bf16_f32 v118, v252, v253
    v_exp_f32 v255, v255
    v_exp_f32 v224, v224
    v_cvt_pk_bf16_f32 v119, v254, v255
    v_exp_f32 v225, v225
    v_exp_f32 v226, v226
    v_cvt_pk_bf16_f32 v112, v224, v225
    v_mfma_f32_32x32x16_bf16 v[32:47], v[196:199], v[116:119], v[32:47]
    v_exp_f32 v227, v227
    buffer_load_dwordx4 v[152:155], v16, s[32:35], s18 offen sc1
    v_exp_f32 v228, v228
    v_cvt_pk_bf16_f32 v113, v226, v227
    v_exp_f32 v229, v229
    s_waitcnt vmcnt(12)
    v_mfma_f32_32x32x16_bf16 v[240:255], v[200:203], v[24:27], 0
    v_exp_f32 v230, v230
    v_cvt_pk_bf16_f32 v114, v228, v229
    v_exp_f32 v231, v231
    v_exp_f32 v232, v232
    v_cvt_pk_bf16_f32 v115, v230, v231
    buffer_load_dwordx4 v[156:159], v12, s[32:35], s18 offen offset:2048 sc1
    v_exp_f32 v233, v233
    v_exp_f32 v234, v234
    v_cvt_pk_bf16_f32 v116, v232, v233
    v_exp_f32 v235, v235
    v_mfma_f32_32x32x16_bf16 v[48:63], v[192:195], v[112:115], v[48:63]
    v_exp_f32 v236, v236
    v_cvt_pk_bf16_f32 v117, v234, v235
    v_exp_f32 v237, v237
    buffer_load_dwordx4 v[160:163], v12, s[32:35], s18 offen offset:3200 sc1
    v_exp_f32 v238, v238
    v_cvt_pk_bf16_f32 v118, v236, v237
    v_exp_f32 v239, v239
    v_exp_f32 v240, v240
    v_cvt_pk_bf16_f32 v119, v238, v239
    v_exp_f32 v241, v241
    v_exp_f32 v242, v242
    v_cvt_pk_bf16_f32 v112, v240, v241
    v_mfma_f32_32x32x16_bf16 v[48:63], v[196:199], v[116:119], v[48:63]
    v_exp_f32 v243, v243
    buffer_load_dwordx4 v[164:167], v16, s[32:35], s19 offen sc1
    v_exp_f32 v244, v244
    v_cvt_pk_bf16_f32 v113, v242, v243
    v_exp_f32 v245, v245
    v_mfma_f32_32x32x16_bf16 v[224:239], v[200:203], v[28:31], 0
    v_exp_f32 v246, v246
    v_cvt_pk_bf16_f32 v114, v244, v245
    v_exp_f32 v247, v247
    v_exp_f32 v248, v248
    v_cvt_pk_bf16_f32 v115, v246, v247
    buffer_load_dwordx4 v[168:171], v12, s[32:35], s19 offen offset:2048 sc1
    v_exp_f32 v249, v249
    v_exp_f32 v250, v250
    v_cvt_pk_bf16_f32 v116, v248, v249
    v_exp_f32 v251, v251
    s_waitcnt vmcnt(14)
    v_mfma_f32_32x32x16_bf16 v[32:47], v[204:207], v[112:115], v[32:47]
    v_exp_f32 v252, v252
    v_cvt_pk_bf16_f32 v117, v250, v251
    v_exp_f32 v253, v253
    buffer_load_dwordx4 v[172:175], v12, s[32:35], s19 offen offset:3200 sc1
    v_exp_f32 v254, v254
    v_cvt_pk_bf16_f32 v118, v252, v253
    v_exp_f32 v255, v255
    v_exp_f32 v224, v224
    v_cvt_pk_bf16_f32 v119, v254, v255
    v_exp_f32 v225, v225
    v_exp_f32 v226, v226
    v_cvt_pk_bf16_f32 v112, v224, v225
    v_mfma_f32_32x32x16_bf16 v[32:47], v[208:211], v[116:119], v[32:47]
    v_exp_f32 v227, v227
    s_add_u32 m0, s47, 98304
    s_lshl1_add_u32 s85, s0, s55
    buffer_load_dwordx4 v1, s[24:27], s85 offen offset:0 sc1 lds
    v_exp_f32 v228, v228
    v_cvt_pk_bf16_f32 v113, v226, v227
    v_exp_f32 v229, v229
    s_waitcnt vmcnt(15)
    v_mfma_f32_32x32x16_bf16 v[240:255], v[212:215], v[24:27], 0
    v_exp_f32 v230, v230
    v_cvt_pk_bf16_f32 v114, v228, v229
    v_exp_f32 v231, v231
    v_exp_f32 v232, v232
    v_cvt_pk_bf16_f32 v115, v230, v231
    buffer_load_dwordx4 v1, s[24:27], s85 offen offset:1024 sc1 lds
    v_exp_f32 v233, v233
    v_exp_f32 v234, v234
    v_cvt_pk_bf16_f32 v116, v232, v233
    v_exp_f32 v235, v235
    v_mfma_f32_32x32x16_bf16 v[48:63], v[204:207], v[112:115], v[48:63]
    v_exp_f32 v236, v236
    v_cvt_pk_bf16_f32 v117, v234, v235
    v_exp_f32 v237, v237
    buffer_load_dwordx4 v1, s[24:27], s85 offen offset:2048 sc1 lds
    v_exp_f32 v238, v238
    v_cvt_pk_bf16_f32 v118, v236, v237
    v_exp_f32 v239, v239
    v_exp_f32 v240, v240
    v_cvt_pk_bf16_f32 v119, v238, v239
    v_exp_f32 v241, v241
    v_exp_f32 v242, v242
    v_cvt_pk_bf16_f32 v112, v240, v241
    v_mfma_f32_32x32x16_bf16 v[48:63], v[208:211], v[116:119], v[48:63]
    v_exp_f32 v243, v243
    buffer_load_dwordx4 v1, s[24:27], s85 offen offset:3072 sc1 lds
    v_exp_f32 v244, v244
    v_cvt_pk_bf16_f32 v113, v242, v243
    v_exp_f32 v245, v245
    v_mfma_f32_32x32x16_bf16 v[224:239], v[212:215], v[28:31], 0
    v_exp_f32 v246, v246
    v_cvt_pk_bf16_f32 v114, v244, v245
    v_exp_f32 v247, v247
    v_exp_f32 v248, v248
    v_cvt_pk_bf16_f32 v115, v246, v247
    s_getpc_b64 s[92:93]
L_pc_54:
    s_sub_u32 s92, s92, L_pc_54-L_pc
    s_subb_u32 s93, s93, 0
    s_and_b32 s91, s65, 1
    s_lshl4_add_u32 s91, s91, s66
    s_lshl2_add_u32 s91, s91, s64
    s_lshl_b32 s91, s91, 9
    v_lshl_add_u32 v15, v0, 3, s91
    global_load_dword v8, v15, s[92:93]
    v_exp_f32 v249, v249
    v_exp_f32 v250, v250
    v_cvt_pk_bf16_f32 v116, v248, v249
    v_exp_f32 v251, v251
    s_waitcnt vmcnt(17)
    v_mfma_f32_32x32x16_bf16 v[32:47], v[216:219], v[112:115], v[32:47]
    v_exp_f32 v252, v252
    v_cvt_pk_bf16_f32 v117, v250, v251
    v_exp_f32 v253, v253
    v_exp_f32 v254, v254
    v_cvt_pk_bf16_f32 v118, v252, v253
    v_exp_f32 v255, v255
    v_exp_f32 v224, v224
    v_cvt_pk_bf16_f32 v119, v254, v255
    v_exp_f32 v225, v225
    v_exp_f32 v226, v226
    v_cvt_pk_bf16_f32 v112, v224, v225
    v_mfma_f32_32x32x16_bf16 v[32:47], v[220:223], v[116:119], v[32:47]
    v_exp_f32 v227, v227
    v_exp_f32 v228, v228
    v_cvt_pk_bf16_f32 v113, v226, v227
    v_exp_f32 v229, v229
    s_waitcnt vmcnt(16)
    v_mfma_f32_32x32x16_bf16 v[240:255], v[128:131], v[28:31], v[96:111]
    v_exp_f32 v230, v230
    v_cvt_pk_bf16_f32 v114, v228, v229
    v_exp_f32 v231, v231
    v_exp_f32 v232, v232
    v_cvt_pk_bf16_f32 v115, v230, v231
    v_exp_f32 v233, v233
    v_exp_f32 v234, v234
    v_cvt_pk_bf16_f32 v116, v232, v233
    v_exp_f32 v235, v235
    v_mfma_f32_32x32x16_bf16 v[48:63], v[216:219], v[112:115], v[48:63]
    v_exp_f32 v236, v236
    v_cvt_pk_bf16_f32 v117, v234, v235
    v_exp_f32 v237, v237
    v_exp_f32 v238, v238
    v_cvt_pk_bf16_f32 v118, v236, v237
    v_exp_f32 v239, v239
    v_exp_f32 v240, v240
    v_cvt_pk_bf16_f32 v119, v238, v239
    v_exp_f32 v241, v241
    v_exp_f32 v242, v242
    v_cvt_pk_bf16_f32 v112, v240, v241
    v_mfma_f32_32x32x16_bf16 v[48:63], v[220:223], v[116:119], v[48:63]
    v_exp_f32 v243, v243
    s_add_u32 m0, s47, 114688
    s_lshl1_add_u32 s85, s1, s55
    buffer_load_dwordx4 v1, s[24:27], s85 offen offset:0 sc1 lds
    v_exp_f32 v244, v244
    v_cvt_pk_bf16_f32 v113, v242, v243
    v_exp_f32 v245, v245
    v_mfma_f32_32x32x16_bf16 v[224:239], v[128:131], v[24:27], 0
    v_exp_f32 v246, v246
    v_cvt_pk_bf16_f32 v114, v244, v245
    v_exp_f32 v247, v247
    v_exp_f32 v248, v248
    v_cvt_pk_bf16_f32 v115, v246, v247
    buffer_load_dwordx4 v1, s[24:27], s85 offen offset:1024 sc1 lds
    v_exp_f32 v249, v249
    v_exp_f32 v250, v250
    v_cvt_pk_bf16_f32 v116, v248, v249
    v_exp_f32 v251, v251
    s_waitcnt vmcnt(16)
    v_mfma_f32_32x32x16_bf16 v[48:63], v[132:135], v[112:115], v[48:63]
    v_exp_f32 v252, v252
    v_cvt_pk_bf16_f32 v117, v250, v251
    v_exp_f32 v253, v253
    buffer_load_dwordx4 v1, s[24:27], s85 offen offset:2048 sc1 lds
    v_exp_f32 v254, v254
    v_cvt_pk_bf16_f32 v118, v252, v253
    v_exp_f32 v255, v255
    v_exp_f32 v224, v224
    v_cvt_pk_bf16_f32 v119, v254, v255
    v_exp_f32 v225, v225
    v_exp_f32 v226, v226
    v_cvt_pk_bf16_f32 v112, v224, v225
    v_mfma_f32_32x32x16_bf16 v[48:63], v[136:139], v[116:119], v[48:63]
    v_exp_f32 v227, v227
    buffer_load_dwordx4 v1, s[24:27], s85 offen offset:3072 sc1 lds
    v_exp_f32 v228, v228
    v_cvt_pk_bf16_f32 v113, v226, v227
    v_exp_f32 v229, v229
    s_waitcnt vmcnt(17)
    v_mfma_f32_32x32x16_bf16 v[240:255], v[140:143], v[24:27], 0
    v_exp_f32 v230, v230
    v_cvt_pk_bf16_f32 v114, v228, v229
    v_exp_f32 v231, v231
    v_exp_f32 v232, v232
    v_cvt_pk_bf16_f32 v115, v230, v231
    s_add_u32 m0, s47, 65536
    s_lshl1_add_u32 s85, s2, s55
    buffer_load_dwordx4 v1, s[24:27], s85 offen offset:0 sc1 lds
    v_exp_f32 v233, v233
    v_exp_f32 v234, v234
    v_cvt_pk_bf16_f32 v116, v232, v233
    v_exp_f32 v235, v235
    v_mfma_f32_32x32x16_bf16 v[32:47], v[132:135], v[112:115], v[32:47]
    v_exp_f32 v236, v236
    v_cvt_pk_bf16_f32 v117, v234, v235
    v_exp_f32 v237, v237
    buffer_load_dwordx4 v1, s[24:27], s85 offen offset:1024 sc1 lds
    v_exp_f32 v238, v238
    v_cvt_pk_bf16_f32 v118, v236, v237
    v_exp_f32 v239, v239
    v_exp_f32 v240, v240
    v_cvt_pk_bf16_f32 v119, v238, v239
    v_exp_f32 v241, v241
    v_exp_f32 v242, v242
    v_cvt_pk_bf16_f32 v112, v240, v241
    v_mfma_f32_32x32x16_bf16 v[32:47], v[136:139], v[116:119], v[32:47]
    v_exp_f32 v243, v243
    buffer_load_dwordx4 v1, s[24:27], s85 offen offset:2048 sc1 lds
    v_exp_f32 v244, v244
    v_cvt_pk_bf16_f32 v113, v242, v243
    v_exp_f32 v245, v245
    s_waitcnt vmcnt(17)
    v_mfma_f32_32x32x16_bf16 v[224:239], v[152:155], v[24:27], 0
    v_exp_f32 v246, v246
    v_cvt_pk_bf16_f32 v114, v244, v245
    v_exp_f32 v247, v247
    v_exp_f32 v248, v248
    v_cvt_pk_bf16_f32 v115, v246, v247
    buffer_load_dwordx4 v1, s[24:27], s85 offen offset:3072 sc1 lds
    v_exp_f32 v249, v249
    v_exp_f32 v250, v250
    v_cvt_pk_bf16_f32 v116, v248, v249
    v_exp_f32 v251, v251
    v_mfma_f32_32x32x16_bf16 v[32:47], v[144:147], v[112:115], v[32:47]
    v_exp_f32 v252, v252
    v_cvt_pk_bf16_f32 v117, v250, v251
    v_exp_f32 v253, v253
    s_add_u32 m0, s47, 81920
    s_lshl1_add_u32 s85, s3, s55
    buffer_load_dwordx4 v1, s[24:27], s85 offen offset:0 sc1 lds
    v_exp_f32 v254, v254
    v_cvt_pk_bf16_f32 v118, v252, v253
    v_exp_f32 v255, v255
    v_exp_f32 v224, v224
    v_cvt_pk_bf16_f32 v119, v254, v255
    v_exp_f32 v225, v225
    v_exp_f32 v226, v226
    v_cvt_pk_bf16_f32 v112, v224, v225
    v_mfma_f32_32x32x16_bf16 v[32:47], v[148:151], v[116:119], v[32:47]
    v_exp_f32 v227, v227
    buffer_load_dwordx4 v1, s[24:27], s85 offen offset:1024 sc1 lds
    v_exp_f32 v228, v228
    v_cvt_pk_bf16_f32 v113, v226, v227
    v_exp_f32 v229, v229
    s_waitcnt vmcnt(17)
    v_mfma_f32_32x32x16_bf16 v[240:255], v[164:167], v[24:27], v[96:111]
    v_exp_f32 v230, v230
    v_cvt_pk_bf16_f32 v114, v228, v229
    v_exp_f32 v231, v231
    v_exp_f32 v232, v232
    v_cvt_pk_bf16_f32 v115, v230, v231
    buffer_load_dwordx4 v1, s[24:27], s85 offen offset:2048 sc1 lds
    v_exp_f32 v233, v233
    v_exp_f32 v234, v234
    v_cvt_pk_bf16_f32 v116, v232, v233
    v_exp_f32 v235, v235
    v_mfma_f32_32x32x16_bf16 v[32:47], v[156:159], v[112:115], v[32:47]
    v_exp_f32 v236, v236
    v_cvt_pk_bf16_f32 v117, v234, v235
    v_exp_f32 v237, v237
    buffer_load_dwordx4 v1, s[24:27], s85 offen offset:3072 sc1 lds
    v_exp_f32 v238, v238
    v_cvt_pk_bf16_f32 v118, v236, v237
    v_exp_f32 v239, v239
    v_exp_f32 v240, v240
    v_cvt_pk_bf16_f32 v119, v238, v239
    v_exp_f32 v241, v241
    v_exp_f32 v242, v242
    v_cvt_pk_bf16_f32 v112, v240, v241
    v_mfma_f32_32x32x16_bf16 v[32:47], v[160:163], v[116:119], v[32:47]
    v_exp_f32 v243, v243
    v_exp_f32 v244, v244
    v_cvt_pk_bf16_f32 v113, v242, v243
    v_exp_f32 v245, v245
    v_exp_f32 v246, v246
    v_cvt_pk_bf16_f32 v114, v244, v245
L_pad4:
    s_cbranch_execz L_pad5
    v_exp_f32 v247, v247
    v_exp_f32 v248, v248
    v_cvt_pk_bf16_f32 v115, v246, v247
    v_exp_f32 v249, v249
    v_exp_f32 v250, v250
    v_cvt_pk_bf16_f32 v116, v248, v249
    v_exp_f32 v251, v251
    s_waitcnt vmcnt(17)
    v_mfma_f32_32x32x16_bf16 v[32:47], v[168:171], v[112:115], v[32:47]
    v_exp_f32 v252, v252
    v_cvt_pk_bf16_f32 v117, v250, v251
    v_exp_f32 v253, v253
    v_exp_f32 v254, v254
    v_cvt_pk_bf16_f32 v118, v252, v253
    v_exp_f32 v255, v255
    s_nop 0
    v_cvt_pk_bf16_f32 v119, v254, v255
    s_nop 1
    v_mfma_f32_32x32x16_bf16 v[32:47], v[172:175], v[116:119], v[32:47]
    s_branch L_attj_48
L_warm1:
    s_branch L_warmb1
L_att2_46:
    s_nop 7
    v_pk_mul_f32 v[112:113], v[112:113], v[8:9] op_sel_hi:[1,0]
    v_pk_mul_f32 v[114:115], v[114:115], v[8:9] op_sel_hi:[1,0]
    v_pk_mul_f32 v[116:117], v[116:117], v[8:9] op_sel_hi:[1,0]
    v_pk_mul_f32 v[118:119], v[118:119], v[8:9] op_sel_hi:[1,0]
    v_cvt_pk_bf16_f32 v24, v112, v113
    v_cvt_pk_bf16_f32 v25, v114, v115
    v_cvt_pk_bf16_f32 v26, v116, v117
    v_cvt_pk_bf16_f32 v27, v118, v119
    ds_write_b128 v11, v[24:27] offset:19456
    v_pk_mul_f32 v[120:121], v[120:121], v[8:9] op_sel_hi:[1,0]
    v_pk_mul_f32 v[122:123], v[122:123], v[8:9] op_sel_hi:[1,0]
    v_pk_mul_f32 v[124:125], v[124:125], v[8:9] op_sel_hi:[1,0]
    v_pk_mul_f32 v[126:127], v[126:127], v[8:9] op_sel_hi:[1,0]
    v_cvt_pk_bf16_f32 v28, v120, v121
    v_cvt_pk_bf16_f32 v29, v122, v123
    v_cvt_pk_bf16_f32 v30, v124, v125
    v_cvt_pk_bf16_f32 v31, v126, v127
    s_waitcnt lgkmcnt(0)
    s_nop 0
    v_mfma_f32_32x32x16_bf16 v[224:239], v[128:131], v[28:31], 0
    s_barrier
    ds_read_b128 v[24:27], v11 offset:18432
    s_mov_b64 exec, 0xff
    buffer_load_dword v13, v9, s[32:35], s50 offen sc1
    s_mov_b64 exec, -1
    s_nop 6
    v_exp_f32 v224, v224
    v_exp_f32 v225, v225
    v_exp_f32 v226, v226
    v_cvt_pk_bf16_f32 v112, v224, v225
    v_exp_f32 v227, v227
    v_exp_f32 v228, v228
    v_cvt_pk_bf16_f32 v113, v226, v227
    v_exp_f32 v229, v229
    v_exp_f32 v230, v230
    v_cvt_pk_bf16_f32 v114, v228, v229
    v_exp_f32 v231, v231
    s_waitcnt lgkmcnt(0)
    v_mfma_f32_32x32x16_bf16 v[240:255], v[128:131], v[24:27], 0
    v_exp_f32 v232, v232
    v_cvt_pk_bf16_f32 v115, v230, v231
    v_exp_f32 v233, v233
    v_exp_f32 v234, v234
    v_cvt_pk_bf16_f32 v116, v232, v233
    v_exp_f32 v235, v235
    v_mfma_f32_32x32x16_bf16 v[48:63], v[132:135], v[112:115], 0
    v_exp_f32 v236, v236
    v_cvt_pk_bf16_f32 v117, v234, v235
    v_exp_f32 v237, v237
    v_exp_f32 v238, v238
    v_cvt_pk_bf16_f32 v118, v236, v237
    v_exp_f32 v239, v239
    v_exp_f32 v240, v240
    v_cvt_pk_bf16_f32 v119, v238, v239
    v_exp_f32 v241, v241
    v_exp_f32 v242, v242
    v_cvt_pk_bf16_f32 v112, v240, v241
    v_mfma_f32_32x32x16_bf16 v[48:63], v[136:139], v[116:119], v[48:63]
    v_exp_f32 v243, v243
    v_exp_f32 v244, v244
    v_cvt_pk_bf16_f32 v113, v242, v243
    v_exp_f32 v245, v245
    v_mfma_f32_32x32x16_bf16 v[224:239], v[140:143], v[24:27], v[80:95]
    v_exp_f32 v246, v246
    v_cvt_pk_bf16_f32 v114, v244, v245
    v_exp_f32 v247, v247
    v_exp_f32 v248, v248
    v_cvt_pk_bf16_f32 v115, v246, v247
    v_exp_f32 v249, v249
    v_exp_f32 v250, v250
    v_cvt_pk_bf16_f32 v116, v248, v249
    v_exp_f32 v251, v251
    v_mfma_f32_32x32x16_bf16 v[32:47], v[132:135], v[112:115], 0
    v_exp_f32 v252, v252
    v_cvt_pk_bf16_f32 v117, v250, v251
    v_exp_f32 v253, v253
    v_exp_f32 v254, v254
    v_cvt_pk_bf16_f32 v118, v252, v253
    v_exp_f32 v255, v255
    s_waitcnt vmcnt(0)
L_ro_56:
    v_cmp_ne_u32 vcc, s68, v13
    s_nop 0
    s_and_b64 vcc, vcc, s[52:53]
    s_cbranch_vccz L_rb_57
    s_mov_b64 exec, 0xff
    buffer_load_dword v13, v9, s[32:35], s50 offen sc1
    s_mov_b64 exec, -1
    s_add_u32 s98, s98, 1
    s_cmp_lt_u32 s98, 400000
    s_waitcnt vmcnt(0)
    s_cbranch_scc1 L_ro_56
L_rb_57:
    v_exp_f32 v224, v224
    v_cvt_pk_bf16_f32 v119, v254, v255
    v_exp_f32 v225, v225
    v_exp_f32 v226, v226
    v_cvt_pk_bf16_f32 v112, v224, v225
    v_mfma_f32_32x32x16_bf16 v[32:47], v[136:139], v[116:119], v[32:47]
    s_branch L_attb_55
L_att1_45:
    s_nop 9
    v_pk_mul_f32 v[120:121], v[120:121], v[8:9] op_sel_hi:[1,0]
    v_pk_mul_f32 v[122:123], v[122:123], v[8:9] op_sel_hi:[1,0]
    v_pk_mul_f32 v[124:125], v[124:125], v[8:9] op_sel_hi:[1,0]
    v_pk_mul_f32 v[126:127], v[126:127], v[8:9] op_sel_hi:[1,0]
    v_cvt_pk_bf16_f32 v28, v120, v121
    v_cvt_pk_bf16_f32 v29, v122, v123
    v_cvt_pk_bf16_f32 v30, v124, v125
    v_cvt_pk_bf16_f32 v31, v126, v127
    ds_write_b128 v11, v[28:31] offset:18432
    v_pk_mul_f32 v[112:113], v[112:113], v[8:9] op_sel_hi:[1,0]
    v_pk_mul_f32 v[114:115], v[114:115], v[8:9] op_sel_hi:[1,0]
    v_pk_mul_f32 v[116:117], v[116:117], v[8:9] op_sel_hi:[1,0]
    v_pk_mul_f32 v[118:119], v[118:119], v[8:9] op_sel_hi:[1,0]
    v_cvt_pk_bf16_f32 v24, v112, v113
    v_cvt_pk_bf16_f32 v25, v114, v115
    v_cvt_pk_bf16_f32 v26, v116, v117
    v_cvt_pk_bf16_f32 v27, v118, v119
    s_waitcnt lgkmcnt(0)
    s_nop 0
    v_mfma_f32_32x32x16_bf16 v[224:239], v[128:131], v[24:27], 0
    s_barrier
    ds_read_b128 v[28:31], v11 offset:19456
    s_mov_b64 exec, 0xff
    buffer_load_dword v13, v9, s[32:35], s50 offen sc1
    s_mov_b64 exec, -1
    s_nop 6
    v_exp_f32 v224, v224
    v_exp_f32 v225, v225
    v_exp_f32 v226, v226
    v_cvt_pk_bf16_f32 v112, v224, v225
    v_exp_f32 v227, v227
    v_exp_f32 v228, v228
    v_cvt_pk_bf16_f32 v113, v226, v227
    v_exp_f32 v229, v229
    v_exp_f32 v230, v230
    v_cvt_pk_bf16_f32 v114, v228, v229
    v_exp_f32 v231, v231
    s_waitcnt lgkmcnt(0)
    v_mfma_f32_32x32x16_bf16 v[240:255], v[128:131], v[28:31], 0
    v_exp_f32 v232, v232
    v_cvt_pk_bf16_f32 v115, v230, v231
    v_exp_f32 v233, v233
    v_exp_f32 v234, v234
    v_cvt_pk_bf16_f32 v116, v232, v233
    v_exp_f32 v235, v235
    v_mfma_f32_32x32x16_bf16 v[32:47], v[132:135], v[112:115], 0
    v_exp_f32 v236, v236
    v_cvt_pk_bf16_f32 v117, v234, v235
    v_exp_f32 v237, v237
    v_exp_f32 v238, v238
    v_cvt_pk_bf16_f32 v118, v236, v237
    v_exp_f32 v239, v239
    v_exp_f32 v240, v240
    v_cvt_pk_bf16_f32 v119, v238, v239
    v_exp_f32 v241, v241
    v_exp_f32 v242, v242
    v_cvt_pk_bf16_f32 v112, v240, v241
    v_mfma_f32_32x32x16_bf16 v[32:47], v[136:139], v[116:119], v[32:47]
    v_exp_f32 v243, v243
    v_exp_f32 v244, v244
    v_cvt_pk_bf16_f32 v113, v242, v243
    v_exp_f32 v245, v245
    v_mfma_f32_32x32x16_bf16 v[224:239], v[140:143], v[24:27], v[80:95]
    v_exp_f32 v246, v246
    v_cvt_pk_bf16_f32 v114, v244, v245
    v_exp_f32 v247, v247
    v_exp_f32 v248, v248
    v_cvt_pk_bf16_f32 v115, v246, v247
    v_exp_f32 v249, v249
    v_exp_f32 v250, v250
    v_cvt_pk_bf16_f32 v116, v248, v249
    v_exp_f32 v251, v251
    v_mfma_f32_32x32x16_bf16 v[48:63], v[132:135], v[112:115], 0
    v_exp_f32 v252, v252
    v_cvt_pk_bf16_f32 v117, v250, v251
    v_exp_f32 v253, v253
    v_exp_f32 v254, v254
    v_cvt_pk_bf16_f32 v118, v252, v253
    v_exp_f32 v255, v255
    s_waitcnt vmcnt(0)
L_ro_58:
    v_cmp_ne_u32 vcc, s68, v13
    s_nop 0
    s_and_b64 vcc, vcc, s[52:53]
    s_cbranch_vccz L_rb_59
    s_mov_b64 exec, 0xff
    buffer_load_dword v13, v9, s[32:35], s50 offen sc1
    s_mov_b64 exec, -1
    s_add_u32 s98, s98, 1
    s_cmp_lt_u32 s98, 400000
    s_waitcnt vmcnt(0)
    s_cbranch_scc1 L_ro_58
L_rb_59:
    v_exp_f32 v224, v224
    v_cvt_pk_bf16_f32 v119, v254, v255
    v_exp_f32 v225, v225
    v_exp_f32 v226, v226
    v_cvt_pk_bf16_f32 v112, v224, v225
    v_mfma_f32_32x32x16_bf16 v[48:63], v[136:139], v[116:119], v[48:63]
L_attb_55:
    v_exp_f32 v227, v227
    buffer_load_dwordx4 v[176:179], v16, s[32:35], s12 offen sc1
    v_exp_f32 v228, v228
    v_cvt_pk_bf16_f32 v113, v226, v227
    v_exp_f32 v229, v229
    v_mfma_f32_32x32x16_bf16 v[240:255], v[140:143], v[28:31], 0
    v_exp_f32 v230, v230
    v_cvt_pk_bf16_f32 v114, v228, v229
    v_exp_f32 v231, v231
    v_exp_f32 v232, v232
    v_cvt_pk_bf16_f32 v115, v230, v231
    buffer_load_dwordx4 v[180:183], v12, s[32:35], s12 offen offset:2048 sc1
    v_exp_f32 v233, v233
    v_exp_f32 v234, v234
    v_cvt_pk_bf16_f32 v116, v232, v233
    v_exp_f32 v235, v235
    v_mfma_f32_32x32x16_bf16 v[32:47], v[144:147], v[112:115], v[32:47]
    v_exp_f32 v236, v236
    v_cvt_pk_bf16_f32 v117, v234, v235
    v_exp_f32 v237, v237
    buffer_load_dwordx4 v[184:187], v12, s[32:35], s12 offen offset:3200 sc1
    v_exp_f32 v238, v238
    v_cvt_pk_bf16_f32 v118, v236, v237
    v_exp_f32 v239, v239
    v_exp_f32 v240, v240
    v_cvt_pk_bf16_f32 v119, v238, v239
    v_exp_f32 v241, v241
    v_exp_f32 v242, v242
    v_cvt_pk_bf16_f32 v112, v240, v241
    v_mfma_f32_32x32x16_bf16 v[32:47], v[148:151], v[116:119], v[32:47]
    v_exp_f32 v243, v243
    buffer_load_dwordx4 v[188:191], v16, s[32:35], s13 offen sc1
    v_exp_f32 v244, v244
    v_cvt_pk_bf16_f32 v113, v242, v243
    v_exp_f32 v245, v245
    v_mfma_f32_32x32x16_bf16 v[224:239], v[152:155], v[28:31], v[80:95]
    v_exp_f32 v246, v246
    v_cvt_pk_bf16_f32 v114, v244, v245
    v_exp_f32 v247, v247
    v_exp_f32 v248, v248
    v_cvt_pk_bf16_f32 v115, v246, v247
    buffer_load_dwordx4 v[192:195], v12, s[32:35], s13 offen offset:2048 sc1
    v_exp_f32 v249, v249
    v_exp_f32 v250, v250
    v_cvt_pk_bf16_f32 v116, v248, v249
    v_exp_f32 v251, v251
    v_mfma_f32_32x32x16_bf16 v[48:63], v[144:147], v[112:115], v[48:63]
    v_exp_f32 v252, v252
    v_cvt_pk_bf16_f32 v117, v250, v251
    v_exp_f32 v253, v253
    buffer_load_dwordx4 v[196:199], v12, s[32:35], s13 offen offset:3200 sc1
    v_exp_f32 v254, v254
    v_cvt_pk_bf16_f32 v118, v252, v253
    v_exp_f32 v255, v255
    s_add_u32 s69, s68, 9
    v_mov_b32 v13, s69
    v_exp_f32 v224, v224
    v_cvt_pk_bf16_f32 v119, v254, v255
    v_exp_f32 v225, v225
    v_exp_f32 v226, v226
    v_cvt_pk_bf16_f32 v112, v224, v225
    v_mfma_f32_32x32x16_bf16 v[48:63], v[148:151], v[116:119], v[48:63]
    v_exp_f32 v227, v227
    buffer_load_dwordx4 v[200:203], v16, s[32:35], s14 offen sc1
    v_exp_f32 v228, v228
    v_cvt_pk_bf16_f32 v113, v226, v227
    v_exp_f32 v229, v229
    s_waitcnt vmcnt(6)
    v_mfma_f32_32x32x16_bf16 v[240:255], v[176:179], v[24:27], 0
    v_exp_f32 v230, v230
    v_cvt_pk_bf16_f32 v114, v228, v229
    v_exp_f32 v231, v231
    v_exp_f32 v232, v232
    v_cvt_pk_bf16_f32 v115, v230, v231
    buffer_load_dwordx4 v[204:207], v12, s[32:35], s14 offen offset:2048 sc1
    v_exp_f32 v233, v233
    v_exp_f32 v234, v234
    v_cvt_pk_bf16_f32 v116, v232, v233
    v_exp_f32 v235, v235
    v_mfma_f32_32x32x16_bf16 v[48:63], v[156:159], v[112:115], v[48:63]
    v_exp_f32 v236, v236
    v_cvt_pk_bf16_f32 v117, v234, v235
    v_exp_f32 v237, v237
    buffer_load_dwordx4 v[208:211], v12, s[32:35], s14 offen offset:3200 sc1
    v_exp_f32 v238, v238
    v_cvt_pk_bf16_f32 v118, v236, v237
    v_exp_f32 v239, v239
    v_exp_f32 v240, v240
    v_cvt_pk_bf16_f32 v119, v238, v239
    v_exp_f32 v241, v241
    v_exp_f32 v242, v242
    v_cvt_pk_bf16_f32 v112, v240, v241
    v_mfma_f32_32x32x16_bf16 v[48:63], v[160:163], v[116:119], v[48:63]
    v_exp_f32 v243, v243
    buffer_load_dwordx4 v[212:215], v16, s[32:35], s15 offen sc1
    v_exp_f32 v244, v244
    v_cvt_pk_bf16_f32 v113, v242, v243
    v_exp_f32 v245, v245
    v_mfma_f32_32x32x16_bf16 v[224:239], v[176:179], v[28:31], 0
    v_exp_f32 v246, v246
    v_cvt_pk_bf16_f32 v114, v244, v245
    v_exp_f32 v247, v247
    v_exp_f32 v248, v248
    v_cvt_pk_bf16_f32 v115, v246, v247
    buffer_load_dwordx4 v[216:219], v12, s[32:35], s15 offen offset:2048 sc1
    v_exp_f32 v249, v249
    v_exp_f32 v250, v250
    v_cvt_pk_bf16_f32 v116, v248, v249
    v_exp_f32 v251, v251
    s_waitcnt vmcnt(8)
    v_mfma_f32_32x32x16_bf16 v[32:47], v[180:183], v[112:115], v[32:47]
    v_exp_f32 v252, v252
    v_cvt_pk_bf16_f32 v117, v250, v251
    v_exp_f32 v253, v253
    buffer_load_dwordx4 v[220:223], v12, s[32:35], s15 offen offset:3200 sc1
    v_exp_f32 v254, v254
    v_cvt_pk_bf16_f32 v118, v252, v253
    v_exp_f32 v255, v255
    v_exp_f32 v224, v224
    v_cvt_pk_bf16_f32 v119, v254, v255
    v_exp_f32 v225, v225
    v_exp_f32 v226, v226
    v_cvt_pk_bf16_f32 v112, v224, v225
    v_mfma_f32_32x32x16_bf16 v[32:47], v[184:187], v[116:119], v[32:47]
    v_exp_f32 v227, v227
    v_add_u32 v16, s54, v17
    v_add_u32 v12, s54, v18
    buffer_load_dwordx4 v[128:131], v16, s[32:35], s16 offen sc1
    v_exp_f32 v228, v228
    v_cvt_pk_bf16_f32 v113, v226, v227
    v_exp_f32 v229, v229
    s_waitcnt vmcnt(9)
    v_mfma_f32_32x32x16_bf16 v[240:255], v[188:191], v[24:27], 0
    v_exp_f32 v230, v230
    v_cvt_pk_bf16_f32 v114, v228, v229
    v_exp_f32 v231, v231
    v_exp_f32 v232, v232
    v_cvt_pk_bf16_f32 v115, v230, v231
    buffer_load_dwordx4 v[132:135], v12, s[32:35], s16 offen offset:2048 sc1
    v_exp_f32 v233, v233
    v_exp_f32 v234, v234
    v_cvt_pk_bf16_f32 v116, v232, v233
    v_exp_f32 v235, v235
    v_mfma_f32_32x32x16_bf16 v[48:63], v[180:183], v[112:115], v[48:63]
    v_exp_f32 v236, v236
    v_cvt_pk_bf16_f32 v117, v234, v235
    v_exp_f32 v237, v237
    buffer_load_dwordx4 v[136:139], v12, s[32:35], s16 offen offset:3200 sc1
    v_exp_f32 v238, v238
    v_cvt_pk_bf16_f32 v118, v236, v237
    v_exp_f32 v239, v239
    v_exp_f32 v240, v240
    v_cvt_pk_bf16_f32 v119, v238, v239
    v_exp_f32 v241, v241
    v_exp_f32 v242, v242
    v_cvt_pk_bf16_f32 v112, v240, v241
    v_mfma_f32_32x32x16_bf16 v[48:63], v[184:187], v[116:119], v[48:63]
    v_exp_f32 v243, v243
    buffer_load_dwordx4 v[140:143], v16, s[32:35], s17 offen sc1
    v_exp_f32 v244, v244
    v_cvt_pk_bf16_f32 v113, v242, v243
    v_exp_f32 v245, v245
    v_mfma_f32_32x32x16_bf16 v[224:239], v[188:191], v[28:31], 0
    v_exp_f32 v246, v246
    v_cvt_pk_bf16_f32 v114, v244, v245
    v_exp_f32 v247, v247
    v_exp_f32 v248, v248
    v_cvt_pk_bf16_f32 v115, v246, v247
    buffer_load_dwordx4 v[144:147], v12, s[32:35], s17 offen offset:2048 sc1
    v_exp_f32 v249, v249
    v_exp_f32 v250, v250
    v_cvt_pk_bf16_f32 v116, v248, v249
    v_exp_f32 v251, v251
    s_waitcnt vmcnt(11)
    v_mfma_f32_32x32x16_bf16 v[32:47], v[192:195], v[112:115], v[32:47]
    v_exp_f32 v252, v252
    v_cvt_pk_bf16_f32 v117, v250, v251
    v_exp_f32 v253, v253
    buffer_load_dwordx4 v[148:151], v12, s[32:35], s17 offen offset:3200 sc1
    v_exp_f32 v254, v254
    v_cvt_pk_bf16_f32 v118, v252, v253
    v_exp_f32 v255, v255
    v_exp_f32 v224, v224
    v_cvt_pk_bf16_f32 v119, v254, v255
    v_exp_f32 v225, v225
    v_exp_f32 v226, v226
    v_cvt_pk_bf16_f32 v112, v224, v225
    v_mfma_f32_32x32x16_bf16 v[32:47], v[196:199], v[116:119], v[32:47]
    v_exp_f32 v227, v227
    buffer_load_dwordx4 v[152:155], v16, s[32:35], s18 offen sc1
    v_exp_f32 v228, v228
    v_cvt_pk_bf16_f32 v113, v226, v227
    v_exp_f32 v229, v229
    s_waitcnt vmcnt(12)
    v_mfma_f32_32x32x16_bf16 v[240:255], v[200:203], v[24:27], 0
    v_exp_f32 v230, v230
    v_cvt_pk_bf16_f32 v114, v228, v229
    v_exp_f32 v231, v231
    v_exp_f32 v232, v232
    v_cvt_pk_bf16_f32 v115, v230, v231
    buffer_load_dwordx4 v[156:159], v12, s[32:35], s18 offen offset:2048 sc1
    v_exp_f32 v233, v233
    v_exp_f32 v234, v234
    v_cvt_pk_bf16_f32 v116, v232, v233
    v_exp_f32 v235, v235
    v_mfma_f32_32x32x16_bf16 v[48:63], v[192:195], v[112:115], v[48:63]
    v_exp_f32 v236, v236
    v_cvt_pk_bf16_f32 v117, v234, v235
    v_exp_f32 v237, v237
    buffer_load_dwordx4 v[160:163], v12, s[32:35], s18 offen offset:3200 sc1
    v_exp_f32 v238, v238
    v_cvt_pk_bf16_f32 v118, v236, v237
    v_exp_f32 v239, v239
    v_exp_f32 v240, v240
    v_cvt_pk_bf16_f32 v119, v238, v239
    v_exp_f32 v241, v241
    v_exp_f32 v242, v242
    v_cvt_pk_bf16_f32 v112, v240, v241
    v_mfma_f32_32x32x16_bf16 v[48:63], v[196:199], v[116:119], v[48:63]
    v_exp_f32 v243, v243
    v_exp_f32 v244, v244
    v_cvt_pk_bf16_f32 v113, v242, v243
    v_exp_f32 v245, v245
    v_mfma_f32_32x32x16_bf16 v[224:239], v[200:203], v[28:31], 0
    v_exp_f32 v246, v246
    v_cvt_pk_bf16_f32 v114, v244, v245
    v_exp_f32 v247, v247
    v_exp_f32 v248, v248
    v_cvt_pk_bf16_f32 v115, v246, v247
    v_exp_f32 v249, v249
    v_exp_f32 v250, v250
    v_cvt_pk_bf16_f32 v116, v248, v249
    v_exp_f32 v251, v251
    s_waitcnt vmcnt(12)
    v_mfma_f32_32x32x16_bf16 v[32:47], v[204:207], v[112:115], v[32:47]
    v_exp_f32 v252, v252
    v_cvt_pk_bf16_f32 v117, v250, v251
    v_exp_f32 v253, v253
    v_exp_f32 v254, v254
    v_cvt_pk_bf16_f32 v118, v252, v253
    v_exp_f32 v255, v255
    v_exp_f32 v224, v224
    v_cvt_pk_bf16_f32 v119, v254, v255
    v_exp_f32 v225, v225
    v_exp_f32 v226, v226
    v_cvt_pk_bf16_f32 v112, v224, v225
    v_mfma_f32_32x32x16_bf16 v[32:47], v[208:211], v[116:119], v[32:47]
    v_exp_f32 v227, v227
    s_add_u32 m0, s47, 98304
    s_lshl1_add_u32 s85, s0, s55
    buffer_load_dwordx4 v1, s[24:27], s85 offen offset:0 sc1 lds
    v_exp_f32 v228, v228
    v_cvt_pk_bf16_f32 v113, v226, v227
    v_exp_f32 v229, v229
    s_waitcnt vmcnt(12)
    v_mfma_f32_32x32x16_bf16 v[240:255], v[212:215], v[24:27], 0
    v_exp_f32 v230, v230
    v_cvt_pk_bf16_f32 v114, v228, v229
    v_exp_f32 v231, v231
    v_exp_f32 v232, v232
    v_cvt_pk_bf16_f32 v115, v230, v231
    buffer_load_dwordx4 v1, s[24:27], s85 offen offset:1024 sc1 lds
    v_exp_f32 v233, v233
    v_exp_f32 v234, v234
    v_cvt_pk_bf16_f32 v116, v232, v233
    v_exp_f32 v235, v235
    v_mfma_f32_32x32x16_bf16 v[48:63], v[204:207], v[112:115], v[48:63]
    v_exp_f32 v236, v236
    v_cvt_pk_bf16_f32 v117, v234, v235
    v_exp_f32 v237, v237
    buffer_load_dwordx4 v1, s[24:27], s85 offen offset:2048 sc1 lds
    v_exp_f32 v238, v238
    v_cvt_pk_bf16_f32 v118, v236, v237
    v_exp_f32 v239, v239
    v_exp_f32 v240, v240
    v_cvt_pk_bf16_f32 v119, v238, v239
    v_exp_f32 v241, v241
    v_exp_f32 v242, v242
    v_cvt_pk_bf16_f32 v112, v240, v241
    v_mfma_f32_32x32x16_bf16 v[48:63], v[208:211], v[116:119], v[48:63]
    v_exp_f32 v243, v243
    buffer_load_dwordx4 v1, s[24:27], s85 offen offset:3072 sc1 lds
    v_exp_f32 v244, v244
    v_cvt_pk_bf16_f32 v113, v242, v243
    v_exp_f32 v245, v245
    v_mfma_f32_32x32x16_bf16 v[224:239], v[212:215], v[28:31], 0
    v_exp_f32 v246, v246
    v_cvt_pk_bf16_f32 v114, v244, v245
    v_exp_f32 v247, v247
    v_exp_f32 v248, v248
    v_cvt_pk_bf16_f32 v115, v246, v247
    s_getpc_b64 s[92:93]
L_pc_60:
    s_sub_u32 s92, s92, L_pc_60-L_pc
    s_subb_u32 s93, s93, 0
    s_and_b32 s91, s65, 1
    s_lshl4_add_u32 s91, s91, s66
    s_lshl2_add_u32 s91, s91, s64
    s_lshl_b32 s91, s91, 9
    v_lshl_add_u32 v15, v0, 3, s91
    global_load_dword v8, v15, s[92:93]
    v_exp_f32 v249, v249
    v_exp_f32 v250, v250
    v_cvt_pk_bf16_f32 v116, v248, v249
    v_exp_f32 v251, v251
    s_waitcnt vmcnt(14)
    v_mfma_f32_32x32x16_bf16 v[32:47], v[216:219], v[112:115], v[32:47]
    v_exp_f32 v252, v252
    v_cvt_pk_bf16_f32 v117, v250, v251
    v_exp_f32 v253, v253
    v_exp_f32 v254, v254
    v_cvt_pk_bf16_f32 v118, v252, v253
    v_exp_f32 v255, v255
    v_exp_f32 v224, v224
    v_cvt_pk_bf16_f32 v119, v254, v255
    v_exp_f32 v225, v225
    v_exp_f32 v226, v226
    v_cvt_pk_bf16_f32 v112, v224, v225
    v_mfma_f32_32x32x16_bf16 v[32:47], v[220:223], v[116:119], v[32:47]
    v_exp_f32 v227, v227
    v_exp_f32 v228, v228
    v_cvt_pk_bf16_f32 v113, v226, v227
    v_exp_f32 v229, v229
    s_waitcnt vmcnt(13)
    v_mfma_f32_32x32x16_bf16 v[240:255], v[128:131], v[28:31], 0
    v_exp_f32 v230, v230
    v_cvt_pk_bf16_f32 v114, v228, v229
    v_exp_f32 v231, v231
    v_exp_f32 v232, v232
    v_cvt_pk_bf16_f32 v115, v230, v231
    v_exp_f32 v233, v233
    v_exp_f32 v234, v234
    v_cvt_pk_bf16_f32 v116, v232, v233
    v_exp_f32 v235, v235
    v_mfma_f32_32x32x16_bf16 v[48:63], v[216:219], v[112:115], v[48:63]
    v_exp_f32 v236, v236
    v_cvt_pk_bf16_f32 v117, v234, v235
    v_exp_f32 v237, v237
    v_exp_f32 v238, v238
    v_cvt_pk_bf16_f32 v118, v236, v237
    v_exp_f32 v239, v239
    v_exp_f32 v240, v240
    v_cvt_pk_bf16_f32 v119, v238, v239
    v_exp_f32 v241, v241
    v_exp_f32 v242, v242
    v_cvt_pk_bf16_f32 v112, v240, v241
    v_mfma_f32_32x32x16_bf16 v[48:63], v[220:223], v[116:119], v[48:63]
    v_exp_f32 v243, v243
    s_add_u32 m0, s47, 114688
    s_lshl1_add_u32 s85, s1, s55
    buffer_load_dwordx4 v1, s[24:27], s85 offen offset:0 sc1 lds
    v_exp_f32 v244, v244
    v_cvt_pk_bf16_f32 v113, v242, v243
    v_exp_f32 v245, v245
    s_waitcnt vmcnt(11)
    v_mfma_f32_32x32x16_bf16 v[224:239], v[140:143], v[28:31], v[96:111]
    v_exp_f32 v246, v246
    v_cvt_pk_bf16_f32 v114, v244, v245
    v_exp_f32 v247, v247
    v_exp_f32 v248, v248
    v_cvt_pk_bf16_f32 v115, v246, v247
    buffer_load_dwordx4 v1, s[24:27], s85 offen offset:1024 sc1 lds
    v_exp_f32 v249, v249
    v_exp_f32 v250, v250
    v_cvt_pk_bf16_f32 v116, v248, v249
    v_exp_f32 v251, v251
    v_mfma_f32_32x32x16_bf16 v[48:63], v[132:135], v[112:115], v[48:63]
    v_exp_f32 v252, v252
    v_cvt_pk_bf16_f32 v117, v250, v251
    v_exp_f32 v253, v253
    buffer_load_dwordx4 v1, s[24:27], s85 offen offset:2048 sc1 lds
    v_exp_f32 v254, v254
    v_cvt_pk_bf16_f32 v118, v252, v253
    v_exp_f32 v255, v255
    v_exp_f32 v224, v224
    v_cvt_pk_bf16_f32 v119, v254, v255
    v_exp_f32 v225, v225
    v_exp_f32 v226, v226
    v_cvt_pk_bf16_f32 v112, v224, v225
    v_mfma_f32_32x32x16_bf16 v[48:63], v[136:139], v[116:119], v[48:63]
    v_exp_f32 v227, v227
    buffer_load_dwordx4 v1, s[24:27], s85 offen offset:3072 sc1 lds
    v_exp_f32 v228, v228
    v_cvt_pk_bf16_f32 v113, v226, v227
    v_exp_f32 v229, v229
    v_mfma_f32_32x32x16_bf16 v[240:255], v[128:131], v[24:27], 0
    v_exp_f32 v230, v230
    v_cvt_pk_bf16_f32 v114, v228, v229
    v_exp_f32 v231, v231
    v_exp_f32 v232, v232
    v_cvt_pk_bf16_f32 v115, v230, v231
    s_add_u32 m0, s47, 65536
    s_lshl1_add_u32 s85, s2, s55
    buffer_load_dwordx4 v1, s[24:27], s85 offen offset:0 sc1 lds
    v_exp_f32 v233, v233
    v_exp_f32 v234, v234
    v_cvt_pk_bf16_f32 v116, v232, v233
    v_exp_f32 v235, v235
    s_waitcnt vmcnt(13)
    v_mfma_f32_32x32x16_bf16 v[48:63], v[144:147], v[112:115], v[48:63]
    v_exp_f32 v236, v236
    v_cvt_pk_bf16_f32 v117, v234, v235
    v_exp_f32 v237, v237
    buffer_load_dwordx4 v1, s[24:27], s85 offen offset:1024 sc1 lds
    v_exp_f32 v238, v238
    v_cvt_pk_bf16_f32 v118, v236, v237
    v_exp_f32 v239, v239
    v_exp_f32 v240, v240
    v_cvt_pk_bf16_f32 v119, v238, v239
    v_exp_f32 v241, v241
    v_exp_f32 v242, v242
    v_cvt_pk_bf16_f32 v112, v240, v241
    v_mfma_f32_32x32x16_bf16 v[48:63], v[148:151], v[116:119], v[48:63]
    v_exp_f32 v243, v243
    buffer_load_dwordx4 v1, s[24:27], s85 offen offset:2048 sc1 lds
    v_exp_f32 v244, v244
    v_cvt_pk_bf16_f32 v113, v242, v243
    v_exp_f32 v245, v245
    v_mfma_f32_32x32x16_bf16 v[224:239], v[140:143], v[24:27], 0
    v_exp_f32 v246, v246
    v_cvt_pk_bf16_f32 v114, v244, v245
    v_exp_f32 v247, v247
    v_exp_f32 v248, v248
    v_cvt_pk_bf16_f32 v115, v246, v247
    buffer_load_dwordx4 v1, s[24:27], s85 offen offset:3072 sc1 lds
    v_exp_f32 v249, v249
    v_exp_f32 v250, v250
    v_cvt_pk_bf16_f32 v116, v248, v249
    v_exp_f32 v251, v251
    v_mfma_f32_32x32x16_bf16 v[32:47], v[132:135], v[112:115], v[32:47]
    v_exp_f32 v252, v252
    v_cvt_pk_bf16_f32 v117, v250, v251
    v_exp_f32 v253, v253
    s_add_u32 m0, s47, 81920
    s_lshl1_add_u32 s85, s3, s55
    buffer_load_dwordx4 v1, s[24:27], s85 offen offset:0 sc1 lds
    v_exp_f32 v254, v254
    v_cvt_pk_bf16_f32 v118, v252, v253
    v_exp_f32 v255, v255
    v_exp_f32 v224, v224
    v_cvt_pk_bf16_f32 v119, v254, v255
    v_exp_f32 v225, v225
    v_exp_f32 v226, v226
    v_cvt_pk_bf16_f32 v112, v224, v225
    v_mfma_f32_32x32x16_bf16 v[32:47], v[136:139], v[116:119], v[32:47]
    v_exp_f32 v227, v227
    buffer_load_dwordx4 v1, s[24:27], s85 offen offset:1024 sc1 lds
    v_exp_f32 v228, v228
    v_cvt_pk_bf16_f32 v113, v226, v227
    v_exp_f32 v229, v229
    s_waitcnt vmcnt(17)
    v_mfma_f32_32x32x16_bf16 v[240:255], v[152:155], v[24:27], v[96:111]
    v_exp_f32 v230, v230
    v_cvt_pk_bf16_f32 v114, v228, v229
    v_exp_f32 v231, v231
    v_exp_f32 v232, v232
    v_cvt_pk_bf16_f32 v115, v230, v231
    buffer_load_dwordx4 v1, s[24:27], s85 offen offset:2048 sc1 lds
    v_exp_f32 v233, v233
    v_exp_f32 v234, v234
    v_cvt_pk_bf16_f32 v116, v232, v233
    v_exp_f32 v235, v235
    v_mfma_f32_32x32x16_bf16 v[32:47], v[144:147], v[112:115], v[32:47]
    v_exp_f32 v236, v236
    v_cvt_pk_bf16_f32 v117, v234, v235
    v_exp_f32 v237, v237
    buffer_load_dwordx4 v1, s[24:27], s85 offen offset:3072 sc1 lds
    v_exp_f32 v238, v238
    v_cvt_pk_bf16_f32 v118, v236, v237
    v_exp_f32 v239, v239
    v_exp_f32 v240, v240
    v_cvt_pk_bf16_f32 v119, v238, v239
    v_exp_f32 v241, v241
    v_exp_f32 v242, v242
    v_cvt_pk_bf16_f32 v112, v240, v241
    v_mfma_f32_32x32x16_bf16 v[32:47], v[148:151], v[116:119], v[32:47]
    v_exp_f32 v243, v243
    v_exp_f32 v244, v244
    v_cvt_pk_bf16_f32 v113, v242, v243
    v_exp_f32 v245, v245
    v_exp_f32 v246, v246
    v_cvt_pk_bf16_f32 v114, v244, v245
    v_exp_f32 v247, v247
    v_exp_f32 v248, v248
    v_cvt_pk_bf16_f32 v115, v246, v247
    v_exp_f32 v249, v249
    v_exp_f32 v250, v250
    v_cvt_pk_bf16_f32 v116, v248, v249
    v_exp_f32 v251, v251
    s_waitcnt vmcnt(17)
    v_mfma_f32_32x32x16_bf16 v[32:47], v[156:159], v[112:115], v[32:47]
L_pad5:
    s_cbranch_execz L_wback
    v_exp_f32 v252, v252
    v_cvt_pk_bf16_f32 v117, v250, v251
    v_exp_f32 v253, v253
    v_exp_f32 v254, v254
    v_cvt_pk_bf16_f32 v118, v252, v253
    v_exp_f32 v255, v255
    s_nop 0
    v_cvt_pk_bf16_f32 v119, v254, v255
    s_nop 1
    v_mfma_f32_32x32x16_bf16 v[32:47], v[160:163], v[116:119], v[32:47]
L_attj_48:
    v_subrev_u32 v57, 0x1f800000, v56
    v_cmp_le_u32 vcc, 0x40000000, v57
    s_cbranch_vccnz L_fb_61
L_fbr_62:
    v_rcp_f32 v56, v56
    s_nop 0
    v_pk_mul_f32 v[48:49], v[48:49], v[56:57] op_sel_hi:[1,0]
    v_pk_mul_f32 v[50:51], v[50:51], v[56:57] op_sel_hi:[1,0]
    v_pk_mul_f32 v[52:53], v[52:53], v[56:57] op_sel_hi:[1,0]
    v_pk_mul_f32 v[54:55], v[54:55], v[56:57] op_sel_hi:[1,0]
    v_cvt_pk_bf16_f32 v124, v48, v49
    v_cvt_pk_bf16_f32 v125, v50, v51
    v_cvt_pk_bf16_f32 v126, v52, v53
    v_cvt_pk_bf16_f32 v127, v54, v55
    s_cmp_lg_u32 s76, 0
    s_cbranch_scc1 L_slow_63
    buffer_store_dwordx4 v[124:127], v1, s[24:27], s9 offen
L_back_64:
    v_subrev_u32 v41, 0x1f800000, v40
    v_cmp_le_u32 vcc, 0x40000000, v41
    s_cbranch_vccnz L_fb_65
L_fbr_66:
    v_rcp_f32 v40, v40
    s_nop 0
    v_pk_mul_f32 v[32:33], v[32:33], v[40:41] op_sel_hi:[1,0]
    v_pk_mul_f32 v[34:35], v[34:35], v[40:41] op_sel_hi:[1,0]
    v_pk_mul_f32 v[36:37], v[36:37], v[40:41] op_sel_hi:[1,0]
    v_pk_mul_f32 v[38:39], v[38:39], v[40:41] op_sel_hi:[1,0]
    v_cvt_pk_bf16_f32 v120, v32, v33
    v_cvt_pk_bf16_f32 v121, v34, v35
    v_cvt_pk_bf16_f32 v122, v36, v37
    v_cvt_pk_bf16_f32 v123, v38, v39
    s_cmp_lg_u32 s76, 0
    s_cbranch_scc1 L_slow_67
    buffer_store_dwordx4 v[120:123], v1, s[24:27], s8 offen
L_back_68:
    v_and_b32 v16, 48, v0
    v_lshl_add_u32 v15, v16, 4, v1
    v_and_b32 v16, 16, v0
    v_mad_u32_u24 v16, v16, 48, v1
    v_add_u32 v20, 0x10000, v1
    s_add_u32 s75, s75, s76
    ds_write_b128 v4, a[0:3] offset:0
    ds_write_b128 v4, a[4:7] offset:1024
    ds_write_b128 v4, a[8:11] offset:8192
    ds_write_b128 v4, a[12:15] offset:9216
    ds_write_b128 v4, a[16:19] offset:16384
    ds_write_b128 v4, a[20:23] offset:17408
    s_mov_b64 exec, 1
    s_cmp_lg_u32 s76, 0
    s_cbranch_scc1 L_slow_69
    s_waitcnt vmcnt(0)
    buffer_store_dword v13, v6, s[24:27], s10 offen
    buffer_store_dword v13, v6, s[24:27], s11 offen
L_back_70:
    s_mov_b64 exec, -1
    buffer_load_dword v12, v6, s[24:27], s83 offen sc1
    s_waitcnt lgkmcnt(0)
    s_barrier
    ds_read_b128 v[192:195], v20 offset:32768
    ds_read_b128 v[196:199], v20 offset:33792
    ds_read_b128 v[200:203], v20 offset:34816
    ds_read_b128 v[204:207], v20 offset:35840
    ds_read_b128 v[208:211], v20 offset:36864
    ds_read_b128 v[212:215], v20 offset:37888
    ds_read_b128 v[216:219], v20 offset:38912
    ds_read_b128 v[220:223], v20 offset:39936
    ds_read_b128 v[224:227], v20 offset:40960
    ds_read_b128 v[228:231], v20 offset:41984
L_poll_71:
    s_add_u32 s98, s98, 1
    s_cmp_lt_u32 s98, 400000
    s_cselect_b64 s[94:95], -1, 0
    s_waitcnt vmcnt(0)
    v_cmp_ne_u32 vcc, s69, v12
    buffer_load_dword v12, v6, s[24:27], s83 offen sc1
    s_and_b64 vcc, vcc, s[94:95]
    s_cbranch_scc1 L_poll_71
    s_add_u32 s90, s75, s0
    buffer_load_dwordx4 v[128:131], v15, s[24:27], s90 offen offset:0 sc1
    buffer_load_dwordx4 v[132:135], v15, s[24:27], s90 offen offset:2048 sc1
    ds_read_b128 v[232:235], v20 offset:43008
    ds_read_b128 v[236:239], v20 offset:44032
    ds_read_b128 v[240:243], v20 offset:45056
    s_add_u32 s90, s90, 4096
    buffer_load_dwordx4 v[136:139], v15, s[24:27], s90 offen offset:0 sc1
    ds_read_b128 v[244:247], v20 offset:46080
    ds_read_b128 v[248:251], v20 offset:47104
    ds_read_b128 v[252:255], v20 offset:48128
    buffer_load_dwordx4 v[140:143], v15, s[24:27], s90 offen offset:2048 sc1
    ds_read_b128 v[32:35], v20 offset:49152
    ds_read_b128 v[36:39], v20 offset:50176
    ds_read_b128 v[40:43], v20 offset:51200
    s_add_u32 s90, s75, s1
    buffer_load_dwordx4 v[144:147], v15, s[24:27], s90 offen offset:0 sc1
    ds_read_b128 v[44:47], v20 offset:52224
    ds_read_b128 v[48:51], v20 offset:53248
    ds_read_b128 v[52:55], v20 offset:54272
    buffer_load_dwordx4 v[148:151], v15, s[24:27], s90 offen offset:2048 sc1
    ds_read_b128 v[56:59], v20 offset:55296
    ds_read_b128 v[60:63], v20 offset:56320
    ds_read_b128 v[80:83], v20 offset:57344
    s_add_u32 s90, s90, 4096
    buffer_load_dwordx4 v[152:155], v15, s[24:27], s90 offen offset:0 sc1
    ds_read_b128 v[84:87], v20 offset:58368
    ds_read_b128 v[88:91], v20 offset:59392
    ds_read_b128 v[92:95], v20 offset:60416
    buffer_load_dwordx4 v[156:159], v15, s[24:27], s90 offen offset:2048 sc1
    ds_read_b128 v[96:99], v20 offset:61440
    ds_read_b128 v[100:103], v20 offset:62464
    ds_read_b128 v[104:107], v20 offset:63488
    s_waitcnt vmcnt(7) lgkmcnt(15)
    v_mfma_f32_16x16x32_bf16 v[64:67], v[192:195], v[128:131], v[64:67]
    ds_read_b128 v[108:111], v20 offset:64512
    v_mfma_f32_16x16x32_bf16 v[68:71], v[196:199], v[128:131], v[68:71]
    s_add_u32 s90, s75, s2
    buffer_load_dwordx4 v[160:163], v15, s[24:27], s90 offen offset:0 sc1
    v_mfma_f32_16x16x32_bf16 v[72:75], v[200:203], v[128:131], v[72:75]
    ds_read_b128 v[192:195], v20 offset:0
    v_mfma_f32_16x16x32_bf16 v[76:79], v[204:207], v[128:131], v[76:79]
    s_waitcnt vmcnt(7) lgkmcnt(15)
    v_mfma_f32_16x16x32_bf16 v[64:67], v[208:211], v[132:135], v[64:67]
    ds_read_b128 v[196:199], v20 offset:1024
    v_mfma_f32_16x16x32_bf16 v[68:71], v[212:215], v[132:135], v[68:71]
    buffer_load_dwordx4 v[164:167], v15, s[24:27], s90 offen offset:2048 sc1
    v_mfma_f32_16x16x32_bf16 v[72:75], v[216:219], v[132:135], v[72:75]
    ds_read_b128 v[200:203], v20 offset:2048
    v_mfma_f32_16x16x32_bf16 v[76:79], v[220:223], v[132:135], v[76:79]
    s_waitcnt vmcnt(7) lgkmcnt(15)
    v_mfma_f32_16x16x32_bf16 v[64:67], v[224:227], v[136:139], v[64:67]
    ds_read_b128 v[204:207], v20 offset:3072
    v_mfma_f32_16x16x32_bf16 v[68:71], v[228:231], v[136:139], v[68:71]
    s_add_u32 s90, s90, 4096
    buffer_load_dwordx4 v[168:171], v15, s[24:27], s90 offen offset:0 sc1
    v_mfma_f32_16x16x32_bf16 v[72:75], v[232:235], v[136:139], v[72:75]
    ds_read_b128 v[208:211], v20 offset:4096
    v_mfma_f32_16x16x32_bf16 v[76:79], v[236:239], v[136:139], v[76:79]
    s_waitcnt vmcnt(7) lgkmcnt(15)
    v_mfma_f32_16x16x32_bf16 v[64:67], v[240:243], v[140:143], v[64:67]
    ds_read_b128 v[212:215], v20 offset:5120
    v_mfma_f32_16x16x32_bf16 v[68:71], v[244:247], v[140:143], v[68:71]
    buffer_load_dwordx4 v[172:175], v15, s[24:27], s90 offen offset:2048 sc1
    v_mfma_f32_16x16x32_bf16 v[72:75], v[248:251], v[140:143], v[72:75]
    ds_read_b128 v[216:219], v20 offset:6144
    v_mfma_f32_16x16x32_bf16 v[76:79], v[252:255], v[140:143], v[76:79]
    s_waitcnt vmcnt(7) lgkmcnt(15)
    v_mfma_f32_16x16x32_bf16 v[64:67], v[32:35], v[144:147], v[64:67]
    ds_read_b128 v[220:223], v20 offset:7168
    v_mfma_f32_16x16x32_bf16 v[68:71], v[36:39], v[144:147], v[68:71]
    s_add_u32 s90, s75, s3
    buffer_load_dwordx4 v[176:179], v15, s[24:27], s90 offen offset:0 sc1
    v_mfma_f32_16x16x32_bf16 v[72:75], v[40:43], v[144:147], v[72:75]
    ds_read_b128 v[224:227], v20 offset:8192
    v_mfma_f32_16x16x32_bf16 v[76:79], v[44:47], v[144:147], v[76:79]
    s_waitcnt vmcnt(7) lgkmcnt(15)
    v_mfma_f32_16x16x32_bf16 v[64:67], v[48:51], v[148:151], v[64:67]
    ds_read_b128 v[228:231], v20 offset:9216
    v_mfma_f32_16x16x32_bf16 v[68:71], v[52:55], v[148:151], v[68:71]
    buffer_load_dwordx4 v[180:183], v15, s[24:27], s90 offen offset:2048 sc1
    v_mfma_f32_16x16x32_bf16 v[72:75], v[56:59], v[148:151], v[72:75]
    ds_read_b128 v[232:235], v20 offset:10240
    v_mfma_f32_16x16x32_bf16 v[76:79], v[60:63], v[148:151], v[76:79]
    s_waitcnt vmcnt(7) lgkmcnt(15)
    v_mfma_f32_16x16x32_bf16 v[64:67], v[80:83], v[152:155], v[64:67]
    ds_read_b128 v[236:239], v20 offset:11264
    v_mfma_f32_16x16x32_bf16 v[68:71], v[84:87], v[152:155], v[68:71]
    s_add_u32 s90, s90, 4096
    buffer_load_dwordx4 v[184:187], v15, s[24:27], s90 offen offset:0 sc1
    v_mfma_f32_16x16x32_bf16 v[72:75], v[88:91], v[152:155], v[72:75]
    ds_read_b128 v[240:243], v20 offset:12288
    v_mfma_f32_16x16x32_bf16 v[76:79], v[92:95], v[152:155], v[76:79]
    s_waitcnt vmcnt(7) lgkmcnt(13)
    v_mfma_f32_16x16x32_bf16 v[64:67], v[96:99], v[156:159], v[64:67]
    ds_read_b128 v[244:247], v20 offset:13312
    v_mfma_f32_16x16x32_bf16 v[68:71], v[100:103], v[156:159], v[68:71]
    buffer_load_dwordx4 v[188:191], v15, s[24:27], s90 offen offset:2048 sc1
    v_mfma_f32_16x16x32_bf16 v[72:75], v[104:107], v[156:159], v[72:75]
    ds_read_b128 v[248:251], v20 offset:14336
    v_mfma_f32_16x16x32_bf16 v[76:79], v[108:111], v[156:159], v[76:79]
    s_waitcnt vmcnt(7) lgkmcnt(11)
    v_mfma_f32_16x16x32_bf16 v[64:67], v[192:195], v[160:163], v[64:67]
    ds_read_b128 v[252:255], v20 offset:15360
    v_mfma_f32_16x16x32_bf16 v[68:71], v[196:199], v[160:163], v[68:71]
    ds_read_b128 v[32:35], v20 offset:16384
    v_mfma_f32_16x16x32_bf16 v[72:75], v[200:203], v[160:163], v[72:75]
    ds_read_b128 v[36:39], v20 offset:17408
    ds_write_b128 v4, a[24:27] offset:24576
    v_mfma_f32_16x16x32_bf16 v[76:79], v[204:207], v[160:163], v[76:79]
    ds_read_b128 v[40:43], v20 offset:18432
    s_waitcnt vmcnt(6) lgkmcnt(12)
    v_mfma_f32_16x16x32_bf16 v[64:67], v[208:211], v[164:167], v[64:67]
    ds_read_b128 v[44:47], v20 offset:19456
    v_mfma_f32_16x16x32_bf16 v[68:71], v[212:215], v[164:167], v[68:71]
    ds_read_b128 v[48:51], v20 offset:20480
    v_mfma_f32_16x16x32_bf16 v[72:75], v[216:219], v[164:167], v[72:75]
    ds_read_b128 v[52:55], v20 offset:21504
    ds_write_b128 v4, a[28:31] offset:25600
    v_mfma_f32_16x16x32_bf16 v[76:79], v[220:223], v[164:167], v[76:79]
    ds_read_b128 v[56:59], v20 offset:22528
    s_waitcnt vmcnt(5) lgkmcnt(13)
    v_mfma_f32_16x16x32_bf16 v[64:67], v[224:227], v[168:171], v[64:67]
    ds_read_b128 v[60:63], v20 offset:23552
    v_mfma_f32_16x16x32_bf16 v[68:71], v[228:231], v[168:171], v[68:71]
    ds_read_b128 v[80:83], v20 offset:24576
    v_mfma_f32_16x16x32_bf16 v[72:75], v[232:235], v[168:171], v[72:75]
    ds_read_b128 v[84:87], v20 offset:25600
    ds_write_b128 v4, a[32:35] offset:32768
    v_mfma_f32_16x16x32_bf16 v[76:79], v[236:239], v[168:171], v[76:79]
    ds_read_b128 v[88:91], v20 offset:26624
    s_waitcnt vmcnt(4) lgkmcnt(14)
    v_mfma_f32_16x16x32_bf16 v[64:67], v[240:243], v[172:175], v[64:67]
    ds_read_b128 v[92:95], v20 offset:27648
    v_mfma_f32_16x16x32_bf16 v[68:71], v[244:247], v[172:175], v[68:71]
    ds_read_b128 v[96:99], v20 offset:28672
    v_mfma_f32_16x16x32_bf16 v[72:75], v[248:251], v[172:175], v[72:75]
    ds_read_b128 v[100:103], v20 offset:29696
    ds_write_b128 v4, a[36:39] offset:33792
    v_mfma_f32_16x16x32_bf16 v[76:79], v[252:255], v[172:175], v[76:79]
    ds_read_b128 v[104:107], v20 offset:30720
    s_waitcnt vmcnt(3) lgkmcnt(14)
    v_mfma_f32_16x16x32_bf16 v[64:67], v[32:35], v[176:179], v[64:67]
    ds_read_b128 v[108:111], v20 offset:31744
    v_mfma_f32_16x16x32_bf16 v[68:71], v[36:39], v[176:179], v[68:71]
    v_mfma_f32_16x16x32_bf16 v[72:75], v[40:43], v[176:179], v[72:75]
    ds_write_b128 v4, a[40:43] offset:40960
    v_mfma_f32_16x16x32_bf16 v[76:79], v[44:47], v[176:179], v[76:79]
    s_add_u32 s70, s70, s76
    s_add_u32 s72, s72, s76
    s_add_u32 s80, s80, s76
    s_add_u32 s81, s81, s76
    s_waitcnt vmcnt(2) lgkmcnt(11)
    v_mfma_f32_16x16x32_bf16 v[64:67], v[48:51], v[180:183], v[64:67]
    v_mfma_f32_16x16x32_bf16 v[68:71], v[52:55], v[180:183], v[68:71]
    v_mfma_f32_16x16x32_bf16 v[72:75], v[56:59], v[180:183], v[72:75]
    ds_write_b128 v4, a[44:47] offset:41984
    v_mfma_f32_16x16x32_bf16 v[76:79], v[60:63], v[180:183], v[76:79]
    s_add_u32 s69, s68, 2
    v_mov_b32 v28, s69
    v_mov_b32 v29, s69
    s_waitcnt vmcnt(1) lgkmcnt(7)
    v_mfma_f32_16x16x32_bf16 v[64:67], v[80:83], v[184:187], v[64:67]
    v_mfma_f32_16x16x32_bf16 v[68:71], v[84:87], v[184:187], v[68:71]
    v_mfma_f32_16x16x32_bf16 v[72:75], v[88:91], v[184:187], v[72:75]
    ds_write_b128 v4, a[48:51] offset:49152
    v_mfma_f32_16x16x32_bf16 v[76:79], v[92:95], v[184:187], v[76:79]
    s_not_b64 s[86:87], s[96:97]
    s_bitcmp1_b32 s64, 0
    s_cselect_b64 s[86:87], s[96:97], s[86:87]
    s_waitcnt vmcnt(0) lgkmcnt(3)
    v_mfma_f32_16x16x32_bf16 v[64:67], v[96:99], v[188:191], v[64:67]
    v_mfma_f32_16x16x32_bf16 v[68:71], v[100:103], v[188:191], v[68:71]
    v_mfma_f32_16x16x32_bf16 v[72:75], v[104:107], v[188:191], v[72:75]
    v_mfma_f32_16x16x32_bf16 v[76:79], v[108:111], v[188:191], v[76:79]
    s_nop 4
    v_cvt_pk_bf16_f32 v112, v64, v65
    v_cvt_pk_bf16_f32 v114, v68, v69
    v_cvt_pk_bf16_f32 v113, v66, v67
    v_cvt_pk_bf16_f32 v115, v70, v71
    v_cvt_pk_bf16_f32 v116, v72, v73
    v_cvt_pk_bf16_f32 v118, v76, v77
    v_cvt_pk_bf16_f32 v117, v74, v75
    v_cvt_pk_bf16_f32 v119, v78, v79
    v_permlane16_swap_b32 v112, v114
    v_permlane16_swap_b32 v113, v115
    s_cmp_lg_u32 s76, 0
    s_cbranch_scc1 L_slow_72
    buffer_store_dwordx4 v[112:115], v16, s[4:7], s80 offen offset:0
L_back_73:
    v_permlane16_swap_b32 v116, v118
    v_permlane16_swap_b32 v117, v119
    s_cmp_lg_u32 s76, 0
    s_cbranch_scc1 L_slow_74
    buffer_store_dwordx4 v[116:119], v16, s[4:7], s80 offen offset:2048
L_back_75:
    v_pk_add_f32 v[12:13], v[64:65], v[66:67]
    v_pk_mul_f32 v[14:15], v[64:65], v[64:65]
    v_pk_fma_f32 v[14:15], v[66:67], v[66:67], v[14:15]
    v_pk_add_f32 v[12:13], v[12:13], v[68:69]
    v_pk_fma_f32 v[14:15], v[68:69], v[68:69], v[14:15]
    v_pk_add_f32 v[12:13], v[12:13], v[70:71]
    v_pk_fma_f32 v[14:15], v[70:71], v[70:71], v[14:15]
    ds_write_b128 v4, a[52:55] offset:50176
    v_pk_add_f32 v[12:13], v[12:13], v[72:73]
    v_pk_fma_f32 v[14:15], v[72:73], v[72:73], v[14:15]
    v_pk_add_f32 v[12:13], v[12:13], v[74:75]
    v_pk_fma_f32 v[14:15], v[74:75], v[74:75], v[14:15]
    v_pk_add_f32 v[12:13], v[12:13], v[76:77]
    v_pk_fma_f32 v[14:15], v[76:77], v[76:77], v[14:15]
    ds_write_b128 v4, a[56:59] offset:57344
    v_pk_add_f32 v[12:13], v[12:13], v[78:79]
    v_pk_fma_f32 v[14:15], v[78:79], v[78:79], v[14:15]
    v_add_f32 v12, v12, v13
    v_add_f32 v14, v14, v15
    s_nop 1
    v_permlane32_swap_b32 v12, v14
    v_add_f32 v12, v12, v14
    v_mov_b32 v13, v12
    s_nop 1
    v_permlane16_swap_b32 v12, v13
    v_add_f32 v12, v12, v13
    v_and_b32 v12, -2, v12
    s_cmp_lg_u32 s76, 0
    s_cbranch_scc1 L_slow_76
    s_mov_b64 exec, s[86:87]
    buffer_store_dword v12, v1, s[24:27], s81 offen
L_back_77:
    s_mov_b64 exec, -1
    ds_write_b128 v4, a[60:63] offset:58368
    ds_read_b128 a[0:3], v19 offset:32768
    ds_read_b128 a[4:7], v19 offset:33792
    ds_read_b128 a[8:11], v19 offset:34816
    s_mov_b64 exec, 1
    s_cmp_lg_u32 s76, 0
    s_cbranch_scc1 L_slow_78
    s_waitcnt vmcnt(1)
    buffer_store_dwordx2 v[28:29], v6, s[24:27], s82 offen
L_back_79:
    s_mov_b64 exec, -1
    buffer_load_dword v16, v6, s[24:27], s73 offen sc1
    ds_read_b128 a[12:15], v19 offset:35840
    ds_read_b128 a[16:19], v19 offset:49152
    ds_read_b128 a[20:23], v19 offset:50176
    ds_read_b128 a[24:27], v19 offset:51200
    ds_read_b128 a[28:31], v19 offset:52224
    ds_read_b128 a[32:35], v19 offset:0
    ds_read_b128 a[36:39], v19 offset:1024
    ds_read_b128 a[40:43], v19 offset:2048
    ds_read_b128 a[44:47], v19 offset:3072
    ds_read_b128 a[48:51], v19 offset:16384
    ds_read_b128 a[52:55], v19 offset:17408
    ds_read_b128 a[56:59], v19 offset:18432
    ds_read_b128 a[60:63], v19 offset:19456
    s_waitcnt lgkmcnt(0)
    s_barrier
    ds_read_b128 v[32:35], v2 offset:0
    ds_read_b128 v[48:51], v2 offset:32768
    ds_read_b128 v[36:39], v2 offset:1024
    ds_read_b128 v[52:55], v2 offset:33792
    ds_write_b128 v5, a[64:67] offset:0
    ds_write_b128 v5, a[68:71] offset:1024
L_poll_80:
    s_add_u32 s98, s98, 1
    s_cmp_lt_u32 s98, 400000
    s_cselect_b64 s[94:95], -1, 0
    s_waitcnt vmcnt(0)
    v_cmp_ne_u32 vcc, s69, v16
    buffer_load_dword v16, v6, s[24:27], s73 offen sc1
    s_and_b64 vcc, vcc, s[94:95]
    s_cbranch_scc1 L_poll_80
    s_add_u32 s90, s70, s0
    buffer_load_dwordx4 v[128:131], v1, s[4:7], s90 offen offset:0 sc1
    buffer_load_dwordx4 v[132:135], v1, s[4:7], s90 offen offset:1024 sc1
    ds_write_b128 v5, a[72:75] offset:8192
    buffer_load_dwordx4 v[136:139], v1, s[4:7], s90 offen offset:2048 sc1
    ds_write_b128 v5, a[76:79] offset:9216
    buffer_load_dwordx4 v[140:143], v1, s[4:7], s90 offen offset:3072 sc1
    ds_write_b128 v5, a[80:83] offset:16384
    s_add_u32 s90, s90, 4096
    buffer_load_dwordx4 v[144:147], v1, s[4:7], s90 offen offset:0 sc1
    ds_write_b128 v5, a[84:87] offset:17408
    buffer_load_dwordx4 v[148:151], v1, s[4:7], s90 offen offset:1024 sc1
    ds_write_b128 v5, a[88:91] offset:24576
    buffer_load_dwordx4 v[152:155], v1, s[4:7], s90 offen offset:2048 sc1
    ds_write_b128 v5, a[92:95] offset:25600
    buffer_load_dwordx4 v[156:159], v1, s[4:7], s90 offen offset:3072 sc1
    ds_write_b128 v19, a[128:131] offset:32768
    s_waitcnt vmcnt(7) lgkmcnt(11)
    v_mfma_f32_32x32x16_bf16 v[80:95], v[128:131], v[32:35], 0
    ds_read_b128 v[40:43], v2 offset:2048
    ds_read_b128 v[56:59], v2 offset:34816
    v_mfma_f32_32x32x16_bf16 v[96:111], v[128:131], v[48:51], 0
    buffer_load_dwordx4 v[112:115], v1, s[24:27], s72 offen offset:0 sc1
    s_waitcnt vmcnt(7) lgkmcnt(11)
    v_mfma_f32_32x32x16_bf16 v[80:95], v[132:135], v[36:39], v[80:95]
    ds_read_b128 v[44:47], v2 offset:3072
    ds_read_b128 v[60:63], v2 offset:35840
    v_mfma_f32_32x32x16_bf16 v[96:111], v[132:135], v[52:55], v[96:111]
    buffer_load_dwordx4 v[116:119], v1, s[24:27], s72 offen offset:1024 sc1
    ds_write_b128 v19, a[132:135] offset:33792
    s_waitcnt vmcnt(7) lgkmcnt(3)
    v_mfma_f32_32x32x16_bf16 v[80:95], v[136:139], v[40:43], v[80:95]
    ds_read_b128 v[32:35], v2 offset:4096
    ds_read_b128 v[48:51], v2 offset:36864
    v_mfma_f32_32x32x16_bf16 v[96:111], v[136:139], v[56:59], v[96:111]
    s_add_u32 s90, s70, s1
    buffer_load_dwordx4 v[160:163], v1, s[4:7], s90 offen offset:0 sc1
    s_waitcnt vmcnt(7) lgkmcnt(3)
    v_mfma_f32_32x32x16_bf16 v[80:95], v[140:143], v[44:47], v[80:95]
    ds_read_b128 v[36:39], v2 offset:5120
    ds_read_b128 v[52:55], v2 offset:37888
    v_mfma_f32_32x32x16_bf16 v[96:111], v[140:143], v[60:63], v[96:111]
    buffer_load_dwordx4 v[164:167], v1, s[4:7], s90 offen offset:1024 sc1
    ds_write_b128 v19, a[136:139] offset:34816
    s_waitcnt vmcnt(7) lgkmcnt(3)
    v_mfma_f32_32x32x16_bf16 v[80:95], v[144:147], v[32:35], v[80:95]
    ds_read_b128 v[40:43], v2 offset:6144
    ds_read_b128 v[56:59], v2 offset:38912
    v_mfma_f32_32x32x16_bf16 v[96:111], v[144:147], v[48:51], v[96:111]
    buffer_load_dwordx4 v[168:171], v1, s[4:7], s90 offen offset:2048 sc1
    s_waitcnt vmcnt(7) lgkmcnt(3)
    v_mfma_f32_32x32x16_bf16 v[80:95], v[148:151], v[36:39], v[80:95]
    ds_read_b128 v[44:47], v2 offset:7168
    ds_read_b128 v[60:63], v2 offset:39936
    v_mfma_f32_32x32x16_bf16 v[96:111], v[148:151], v[52:55], v[96:111]
    buffer_load_dwordx4 v[172:175], v1, s[4:7], s90 offen offset:3072 sc1
    ds_write_b128 v19, a[140:143] offset:35840
    s_waitcnt vmcnt(7) lgkmcnt(3)
    v_mfma_f32_32x32x16_bf16 v[80:95], v[152:155], v[40:43], v[80:95]
    ds_read_b128 v[32:35], v2 offset:8192
    ds_read_b128 v[48:51], v2 offset:40960
    v_mfma_f32_32x32x16_bf16 v[96:111], v[152:155], v[56:59], v[96:111]
    s_add_u32 s90, s90, 4096
    buffer_load_dwordx4 v[176:179], v1, s[4:7], s90 offen offset:0 sc1
    s_waitcnt vmcnt(7) lgkmcnt(3)
    v_mfma_f32_32x32x16_bf16 v[80:95], v[156:159], v[44:47], v[80:95]
    ds_read_b128 v[36:39], v2 offset:9216
    ds_read_b128 v[52:55], v2 offset:41984
    v_mfma_f32_32x32x16_bf16 v[96:111], v[156:159], v[60:63], v[96:111]
    buffer_load_dwordx4 v[180:183], v1, s[4:7], s90 offen offset:1024 sc1
    ds_write_b128 v19, a[144:147] offset:49152
    s_waitcnt vmcnt(5) lgkmcnt(3)
    v_mfma_f32_32x32x16_bf16 v[80:95], v[160:163], v[32:35], v[80:95]
    ds_read_b128 v[40:43], v2 offset:10240
    ds_read_b128 v[56:59], v2 offset:43008
    v_mfma_f32_32x32x16_bf16 v[96:111], v[160:163], v[48:51], v[96:111]
    buffer_load_dwordx4 v[184:187], v1, s[4:7], s90 offen offset:2048 sc1
    v_bitop3_b32 v14, v112, v113, v114 bitop3:0xfe
    v_bitop3_b32 v14, v14, v115, v116 bitop3:0xfe
    v_bitop3_b32 v14, v14, v117, v118 bitop3:0xfe
    s_waitcnt vmcnt(5) lgkmcnt(3)
    v_mfma_f32_32x32x16_bf16 v[80:95], v[164:167], v[36:39], v[80:95]
    ds_read_b128 v[44:47], v2 offset:11264
    ds_read_b128 v[60:63], v2 offset:44032
    v_mfma_f32_32x32x16_bf16 v[96:111], v[164:167], v[52:55], v[96:111]
    buffer_load_dwordx4 v[188:191], v1, s[4:7], s90 offen offset:3072 sc1
    ds_write_b128 v19, a[148:151] offset:50176
    v_bitop3_b32 v14, v14, v119, v119 bitop3:0xfe
    v_and_b32 v14, 1, v14
    v_cmp_ne_u32 vcc, 0, v14
    s_cbranch_vccnz L_ro_81
L_rb_82:
    s_waitcnt vmcnt(5) lgkmcnt(3)
    v_mfma_f32_32x32x16_bf16 v[80:95], v[168:171], v[40:43], v[80:95]
    ds_read_b128 v[32:35], v2 offset:12288
    ds_read_b128 v[48:51], v2 offset:45056
    v_mfma_f32_32x32x16_bf16 v[96:111], v[168:171], v[56:59], v[96:111]
    s_add_u32 s90, s70, s2
    buffer_load_dwordx4 v[192:195], v1, s[4:7], s90 offen offset:0 sc1
    v_pk_add_f32 v[112:113], v[112:113], v[116:117]
    s_waitcnt vmcnt(5) lgkmcnt(3)
    v_mfma_f32_32x32x16_bf16 v[80:95], v[172:175], v[44:47], v[80:95]
    ds_read_b128 v[36:39], v2 offset:13312
    ds_read_b128 v[52:55], v2 offset:46080
    v_mfma_f32_32x32x16_bf16 v[96:111], v[172:175], v[60:63], v[96:111]
    buffer_load_dwordx4 v[196:199], v1, s[4:7], s90 offen offset:1024 sc1
    ds_write_b128 v19, a[152:155] offset:51200
    v_pk_add_f32 v[114:115], v[114:115], v[118:119]
    v_pk_add_f32 v[112:113], v[112:113], v[114:115]
    v_add_f32 v14, v112, v113
    s_waitcnt vmcnt(5) lgkmcnt(3)
    v_mfma_f32_32x32x16_bf16 v[80:95], v[176:179], v[32:35], v[80:95]
    ds_read_b128 v[40:43], v2 offset:14336
    ds_read_b128 v[56:59], v2 offset:47104
    v_mfma_f32_32x32x16_bf16 v[96:111], v[176:179], v[48:51], v[96:111]
    buffer_load_dwordx4 v[200:203], v1, s[4:7], s90 offen offset:2048 sc1
    buffer_load_dwordx4 v[204:207], v1, s[4:7], s90 offen offset:3072 sc1
    v_mov_b32 v15, v14
    s_nop 1
    v_permlane32_swap_b32 v14, v15
    v_mul_f32 v14, 0xbb000000, v14
    s_waitcnt vmcnt(6) lgkmcnt(3)
    v_mfma_f32_32x32x16_bf16 v[80:95], v[180:183], v[36:39], v[80:95]
    ds_read_b128 v[44:47], v2 offset:15360
    ds_read_b128 v[60:63], v2 offset:48128
    v_mfma_f32_32x32x16_bf16 v[96:111], v[180:183], v[52:55], v[96:111]
    s_add_u32 s90, s90, 4096
    buffer_load_dwordx4 v[208:211], v1, s[4:7], s90 offen offset:0 sc1
    ds_write_b128 v19, a[156:159] offset:52224
    v_mul_f32 v15, 0x3b000000, v15
    v_fma_f32 v15, -v14, v14, v15
    v_max_f32 v15, 0, v15
    s_waitcnt vmcnt(6) lgkmcnt(3)
    v_mfma_f32_32x32x16_bf16 v[80:95], v[184:187], v[40:43], v[80:95]
    ds_read_b128 v[32:35], v2 offset:16384
    ds_read_b128 v[48:51], v2 offset:49152
    v_mfma_f32_32x32x16_bf16 v[96:111], v[184:187], v[56:59], v[96:111]
    buffer_load_dwordx4 v[212:215], v1, s[4:7], s90 offen offset:1024 sc1
    v_add_f32 v15, 0x3727c5ac, v15
    v_rsq_f32 v8, v15
    v_cvt_pk_bf16_f32 v15, v14, v14
    s_waitcnt vmcnt(6) lgkmcnt(3)
    v_mfma_f32_32x32x16_bf16 v[80:95], v[188:191], v[44:47], v[80:95]
    ds_read_b128 v[36:39], v2 offset:17408
    ds_read_b128 v[52:55], v2 offset:50176
    v_mfma_f32_32x32x16_bf16 v[96:111], v[188:191], v[60:63], v[96:111]
    buffer_load_dwordx4 v[216:219], v1, s[4:7], s90 offen offset:2048 sc1
    buffer_load_dwordx4 v[220:223], v1, s[4:7], s90 offen offset:3072 sc1
    v_mul_f32 v8, 0x3fb8aa3b, v8
    v_lshlrev_b32 v15, 16, v15
    s_lshl_b32 s91, s64, 7
    s_add_u32 s91, s91, 162816
    v_add_u32 v20, s91, v6
    s_waitcnt vmcnt(7) lgkmcnt(2)
    v_mfma_f32_32x32x16_bf16 v[80:95], v[192:195], v[32:35], v[80:95]
    ds_read_b128 v[40:43], v2 offset:18432
    ds_read_b128 v[56:59], v2 offset:51200
    v_mfma_f32_32x32x16_bf16 v[96:111], v[192:195], v[48:51], v[96:111]
    s_add_u32 s90, s70, s3
    buffer_load_dwordx4 v[224:227], v1, s[4:7], s90 offen offset:0 sc1
    ds_write_b32 v20, v8
    s_waitcnt vmcnt(7) lgkmcnt(3)
    v_mfma_f32_32x32x16_bf16 v[80:95], v[196:199], v[36:39], v[80:95]
    ds_read_b128 v[44:47], v2 offset:19456
    ds_read_b128 v[60:63], v2 offset:52224
    v_mfma_f32_32x32x16_bf16 v[96:111], v[196:199], v[52:55], v[96:111]
    buffer_load_dwordx4 v[228:231], v1, s[4:7], s90 offen offset:1024 sc1
    v_sub_f32 v15, v14, v15
    v_cvt_pk_bf16_f32 v20, v14, v15
    v_cvt_pk_bf16_f32 v21, v14, v15
    s_waitcnt vmcnt(7) lgkmcnt(3)
    v_mfma_f32_32x32x16_bf16 v[80:95], v[200:203], v[40:43], v[80:95]
    ds_read_b128 v[32:35], v2 offset:20480
    ds_read_b128 v[48:51], v2 offset:53248
    v_mfma_f32_32x32x16_bf16 v[96:111], v[200:203], v[56:59], v[96:111]
    buffer_load_dwordx4 v[232:235], v1, s[4:7], s90 offen offset:2048 sc1
    buffer_load_dwordx4 v[236:239], v1, s[4:7], s90 offen offset:3072 sc1
    v_cvt_pk_bf16_f32 v22, v14, v15
    v_cvt_pk_bf16_f32 v23, v14, v15
    ds_read_b128 v[112:115], v10 offset:0
    s_waitcnt vmcnt(8) lgkmcnt(3)
    v_mfma_f32_32x32x16_bf16 v[80:95], v[204:207], v[44:47], v[80:95]
    ds_read_b128 v[36:39], v2 offset:21504
    ds_read_b128 v[52:55], v2 offset:54272
    v_mfma_f32_32x32x16_bf16 v[96:111], v[204:207], v[60:63], v[96:111]
    s_add_u32 s90, s90, 4096
    buffer_load_dwordx4 v[240:243], v1, s[4:7], s90 offen offset:0 sc1
    ds_read_b128 v[116:119], v10 offset:32
    ds_read_b128 v[120:123], v10 offset:64
    ds_read_b128 v[124:127], v10 offset:96
    s_waitcnt vmcnt(8) lgkmcnt(6)
    v_mfma_f32_32x32x16_bf16 v[80:95], v[208:211], v[32:35], v[80:95]
    ds_read_b128 v[40:43], v2 offset:22528
    ds_read_b128 v[56:59], v2 offset:55296
    v_mfma_f32_32x32x16_bf16 v[96:111], v[208:211], v[48:51], v[96:111]
    buffer_load_dwordx4 v[244:247], v1, s[4:7], s90 offen offset:1024 sc1
    buffer_load_dwordx4 v[248:251], v1, s[4:7], s90 offen offset:2048 sc1
    s_mul_i32 s91, s64, 3072
    v_add_u32 v14, s91, v11
    s_lshl_b32 s91, s64, 10
    v_add_u32 v13, s91, v11
    s_waitcnt vmcnt(9) lgkmcnt(5)
    v_mfma_f32_32x32x16_bf16 v[80:95], v[212:215], v[36:39], v[80:95]
    ds_read_b128 v[44:47], v2 offset:23552
    ds_read_b128 v[60:63], v2 offset:56320
    v_mfma_f32_32x32x16_bf16 v[96:111], v[212:215], v[52:55], v[96:111]
    buffer_load_dwordx4 v[252:255], v1, s[4:7], s90 offen offset:3072 sc1
    s_add_u32 s88, s68, 18
    s_add_u32 s32, s32, 20971520
    s_addc_u32 s33, s33, 0
    s_mov_b32 s86, 0x3f317218
    s_mov_b32 s87, 0x358637bd
    s_waitcnt vmcnt(9) lgkmcnt(2)
    v_mfma_f32_32x32x16_bf16 v[80:95], v[216:219], v[40:43], v[80:95]
    ds_read_b128 v[32:35], v2 offset:24576
    ds_read_b128 v[48:51], v2 offset:57344
    v_mfma_f32_32x32x16_bf16 v[96:111], v[216:219], v[56:59], v[96:111]
    s_cmp_eq_u32 s64, 3
    s_cselect_b32 s91, 0x40000000, 0
    v_add_u32 v15, s91, v1
    s_mov_b32 s92, 0xf0f00f0f
    s_mov_b32 s93, s92
    v_mov_b32 v25, 0x3f803f80
    v_cndmask_b32_e64 v24, 0, v25, s[92:93]
    s_waitcnt vmcnt(8) lgkmcnt(2)
    v_mfma_f32_32x32x16_bf16 v[80:95], v[220:223], v[44:47], v[80:95]
    ds_read_b128 v[36:39], v2 offset:25600
    ds_read_b128 v[52:55], v2 offset:58368
    v_mfma_f32_32x32x16_bf16 v[96:111], v[220:223], v[60:63], v[96:111]
    v_mov_b32 v25, v24
    v_mov_b32 v26, v24
    v_mov_b32 v27, v24
    s_waitcnt vmcnt(7) lgkmcnt(2)
    v_mfma_f32_32x32x16_bf16 v[80:95], v[224:227], v[32:35], v[80:95]
    s_barrier
    ds_read_b128 v[40:43], v2 offset:26624
    ds_read_b128 v[56:59], v2 offset:59392
    v_mfma_f32_32x32x16_bf16 v[96:111], v[224:227], v[48:51], v[96:111]
    s_waitcnt vmcnt(6) lgkmcnt(2)
    v_mfma_f32_32x32x16_bf16 v[80:95], v[228:231], v[36:39], v[80:95]
    ds_read_b128 v[44:47], v2 offset:27648
    ds_read_b128 v[60:63], v2 offset:60416
L_pad6:
    s_cbranch_execz L_pad7
    v_mfma_f32_32x32x16_bf16 v[96:111], v[228:231], v[52:55], v[96:111]
    s_waitcnt vmcnt(5) lgkmcnt(3)
    v_mfma_f32_32x32x16_bf16 v[80:95], v[232:235], v[40:43], v[80:95]
    ds_read_b128 v[32:35], v2 offset:28672
    ds_read_b128 v[36:39], v2 offset:29696
    s_waitcnt vmcnt(4) lgkmcnt(3)
    v_mfma_f32_32x32x16_bf16 v[80:95], v[236:239], v[44:47], v[80:95]
    ds_read_b128 v[40:43], v2 offset:30720
    ds_read_b128 v[48:51], v2 offset:61440
    s_waitcnt vmcnt(3) lgkmcnt(3)
    v_mfma_f32_32x32x16_bf16 v[80:95], v[240:243], v[32:35], v[80:95]
    ds_read_b128 v[44:47], v2 offset:31744
    ds_read_b128 v[52:55], v2 offset:62464
    s_waitcnt vmcnt(2) lgkmcnt(4)
    v_mfma_f32_32x32x16_bf16 v[80:95], v[244:247], v[36:39], v[80:95]
    ds_read_b128 v[32:35], v11 offset:25600
    s_waitcnt vmcnt(1) lgkmcnt(4)
    v_mfma_f32_32x32x16_bf16 v[80:95], v[248:251], v[40:43], v[80:95]
    s_waitcnt vmcnt(0) lgkmcnt(2)
    v_mfma_f32_32x32x16_bf16 v[80:95], v[252:255], v[44:47], v[80:95]
    s_waitcnt lgkmcnt(0)
    v_mfma_f32_32x32x16_bf16 v[80:95], v[20:23], v[32:35], v[80:95]
    v_mfma_f32_32x32x16_bf16 v[96:111], v[232:235], v[56:59], v[96:111]
    ds_read_b128 v[56:59], v2 offset:63488
    v_mfma_f32_32x32x16_bf16 v[96:111], v[236:239], v[60:63], v[96:111]
    ds_read_b128 v[60:63], v2 offset:64512
    s_nop 7
    v_pk_mul_f32 v[80:81], v[80:81], v[112:113]
    v_pk_mul_f32 v[82:83], v[82:83], v[114:115]
    v_pk_mul_f32 v[84:85], v[84:85], v[116:117]
    v_pk_mul_f32 v[86:87], v[86:87], v[118:119]
    v_mfma_f32_32x32x16_bf16 v[96:111], v[240:243], v[48:51], v[96:111]
    ds_read_b128 v[48:51], v11 offset:26624
    v_exp_f32_e64 v40, v80 clamp
    v_exp_f32_e64 v41, v81 clamp
    v_exp_f32_e64 v42, v82 clamp
    v_exp_f32_e64 v43, v83 clamp
    v_mfma_f32_32x32x16_bf16 v[96:111], v[244:247], v[52:55], v[96:111]
    v_exp_f32_e64 v44, v84 clamp
    v_exp_f32_e64 v45, v85 clamp
    v_exp_f32_e64 v46, v86 clamp
    v_exp_f32_e64 v47, v87 clamp
    s_waitcnt lgkmcnt(2)
    v_mfma_f32_32x32x16_bf16 v[96:111], v[248:251], v[56:59], v[96:111]
    v_pk_fma_f32 v[80:81], v[80:81], s[86:87], s[86:87] op_sel:[0,0,1] op_sel_hi:[1,0,1]
    v_pk_fma_f32 v[82:83], v[82:83], s[86:87], s[86:87] op_sel:[0,0,1] op_sel_hi:[1,0,1]
    v_pk_fma_f32 v[84:85], v[84:85], s[86:87], s[86:87] op_sel:[0,0,1] op_sel_hi:[1,0,1]
    v_pk_fma_f32 v[86:87], v[86:87], s[86:87], s[86:87] op_sel:[0,0,1] op_sel_hi:[1,0,1]
    s_waitcnt lgkmcnt(1)
    v_mfma_f32_32x32x16_bf16 v[96:111], v[252:255], v[60:63], v[96:111]
    v_max_f32 v80, s87, v80
    v_max_f32 v81, s87, v81
    v_max_f32 v82, s87, v82
    v_max_f32 v83, s87, v83
    s_waitcnt lgkmcnt(0)
    v_mfma_f32_32x32x16_bf16 v[96:111], v[20:23], v[48:51], v[96:111]
    v_max_f32 v84, s87, v84
    v_max_f32 v85, s87, v85
    v_max_f32 v86, s87, v86
    v_max_f32 v87, s87, v87
    ds_read_b128 v[48:51], v3 offset:0
    ds_read_b128 v[52:55], v3 offset:1024
    ds_read_b128 v[56:59], v3 offset:2048
    ds_read_b128 v[60:63], v3 offset:3072
    v_pk_add_f32 v[80:81], v[80:81], v[40:41]
    v_pk_add_f32 v[82:83], v[82:83], v[42:43]
    v_pk_add_f32 v[84:85], v[84:85], v[44:45]
    v_pk_add_f32 v[86:87], v[86:87], v[46:47]
    v_cvt_pk_bf16_f32 v32, v80, v81
    v_cvt_pk_bf16_f32 v33, v82, v83
    v_cvt_pk_bf16_f32 v34, v84, v85
    v_cvt_pk_bf16_f32 v35, v86, v87
    v_pk_mul_f32 v[88:89], v[88:89], v[120:121]
    v_pk_mul_f32 v[90:91], v[90:91], v[122:123]
    v_pk_mul_f32 v[92:93], v[92:93], v[124:125]
    v_pk_mul_f32 v[94:95], v[94:95], v[126:127]
    v_mfma_f32_16x16x32_bf16 v[28:31], v[24:27], v[32:35], 0
    v_exp_f32_e64 v40, v88 clamp
    v_exp_f32_e64 v41, v89 clamp
    v_exp_f32_e64 v42, v90 clamp
    v_exp_f32_e64 v43, v91 clamp
    v_exp_f32_e64 v44, v92 clamp
    v_exp_f32_e64 v45, v93 clamp
    v_exp_f32_e64 v46, v94 clamp
    v_exp_f32_e64 v47, v95 clamp
    v_pk_fma_f32 v[88:89], v[88:89], s[86:87], s[86:87] op_sel:[0,0,1] op_sel_hi:[1,0,1]
    v_pk_fma_f32 v[90:91], v[90:91], s[86:87], s[86:87] op_sel:[0,0,1] op_sel_hi:[1,0,1]
    v_pk_fma_f32 v[92:93], v[92:93], s[86:87], s[86:87] op_sel:[0,0,1] op_sel_hi:[1,0,1]
    v_pk_fma_f32 v[94:95], v[94:95], s[86:87], s[86:87] op_sel:[0,0,1] op_sel_hi:[1,0,1]
    v_max_f32 v88, s87, v88
    v_max_f32 v89, s87, v89
    v_max_f32 v90, s87, v90
    v_max_f32 v91, s87, v91
    v_max_f32 v92, s87, v92
    v_max_f32 v93, s87, v93
    v_max_f32 v94, s87, v94
    v_max_f32 v95, s87, v95
    v_pk_add_f32 v[88:89], v[88:89], v[40:41]
    v_pk_add_f32 v[90:91], v[90:91], v[42:43]
    v_pk_add_f32 v[92:93], v[92:93], v[44:45]
    v_pk_add_f32 v[94:95], v[94:95], v[46:47]
    v_cvt_pk_bf16_f32 v36, v88, v89
    v_cvt_pk_bf16_f32 v37, v90, v91
    v_cvt_pk_bf16_f32 v38, v92, v93
    v_cvt_pk_bf16_f32 v39, v94, v95
    v_pk_mul_f32 v[96:97], v[96:97], v[112:113]
    v_pk_mul_f32 v[98:99], v[98:99], v[114:115]
    v_pk_mul_f32 v[100:101], v[100:101], v[116:117]
    v_pk_mul_f32 v[102:103], v[102:103], v[118:119]
    v_pk_mul_f32 v[104:105], v[104:105], v[120:121]
    v_pk_mul_f32 v[106:107], v[106:107], v[122:123]
    v_pk_mul_f32 v[108:109], v[108:109], v[124:125]
    v_pk_mul_f32 v[110:111], v[110:111], v[126:127]
    v_mfma_f32_16x16x32_bf16 v[28:31], v[24:27], v[36:39], v[28:31]
    v_cvt_pk_bf16_f32 v40, v96, v97
    v_cvt_pk_bf16_f32 v41, v98, v99
    v_cvt_pk_bf16_f32 v42, v100, v101
    v_cvt_pk_bf16_f32 v43, v102, v103
    v_cvt_pk_bf16_f32 v44, v104, v105
    v_cvt_pk_bf16_f32 v45, v106, v107
    v_mfma_f32_32x32x16_bf16 v[80:95], v[32:35], v[40:43], 0
    v_cvt_pk_bf16_f32 v46, v108, v109
    v_cvt_pk_bf16_f32 v47, v110, v111
    v_mov_b32 v106, v28
    s_nop 0
    v_mfma_f32_32x32x16_bf16 v[80:95], v[36:39], v[44:47], v[80:95]
    s_waitcnt lgkmcnt(3)
    v_mfma_f32_32x32x16_bf16 v[112:127], v[48:51], v[128:131], 0
    ds_read_b128 v[32:35], v3 offset:4096
    s_waitcnt lgkmcnt(3)
    v_mfma_f32_32x32x16_bf16 v[112:127], v[52:55], v[132:135], v[112:127]
    ds_read_b128 v[36:39], v3 offset:5120
    s_nop 5
    v_cndmask_b32_e64 v96, v80, v88, s[96:97]
    v_cndmask_b32_e64 v97, v81, v89, s[96:97]
    v_cndmask_b32_e64 v98, v82, v90, s[96:97]
    ds_write_b96 v14, v[96:98] offset:0
    s_waitcnt lgkmcnt(4)
    v_mfma_f32_32x32x16_bf16 v[112:127], v[56:59], v[136:139], v[112:127]
    ds_read_b128 v[40:43], v3 offset:6144
    v_cndmask_b32_e64 v100, v83, v91, s[96:97]
    v_cndmask_b32_e64 v101, v84, v92, s[96:97]
    v_cndmask_b32_e64 v102, v85, v93, s[96:97]
    ds_write_b96 v14, v[100:102] offset:1024
    v_cndmask_b32_e64 v104, v86, v94, s[96:97]
    v_cndmask_b32_e64 v105, v87, v95, s[96:97]
    ds_write_b96 v14, v[104:106] offset:2048
    v_mov_b32 v83, s88
    s_waitcnt lgkmcnt(6)
    v_mfma_f32_32x32x16_bf16 v[112:127], v[60:63], v[140:143], v[112:127]
    ds_read_b128 v[44:47], v3 offset:7168
    s_waitcnt lgkmcnt(6)
    v_mfma_f32_32x32x16_bf16 v[112:127], v[32:35], v[144:147], v[112:127]
    ds_read_b128 v[48:51], v3 offset:8192
    s_waitcnt lgkmcnt(2)
    s_barrier
    ds_read_b96 v[80:82], v13 offset:0
    ds_read_b96 v[84:86], v13 offset:3072
    ds_read_b96 v[88:90], v13 offset:6144
    ds_read_b96 v[92:94], v13 offset:9216
    v_mfma_f32_32x32x16_bf16 v[112:127], v[36:39], v[148:151], v[112:127]
    ds_read_b128 v[52:55], v3 offset:9216
    v_mfma_f32_32x32x16_bf16 v[112:127], v[40:43], v[152:155], v[112:127]
    ds_read_b128 v[56:59], v3 offset:10240
    s_waitcnt lgkmcnt(7)
    v_mfma_f32_32x32x16_bf16 v[112:127], v[44:47], v[156:159], v[112:127]
    ds_read_b128 v[60:63], v3 offset:11264
    s_waitcnt lgkmcnt(5)
    v_pk_add_f32 v[80:81], v[80:81], v[84:85]
    v_add_f32 v82, v82, v86
    s_waitcnt lgkmcnt(4)
    v_pk_add_f32 v[80:81], v[80:81], v[88:89]
    v_add_f32 v82, v82, v90
    s_waitcnt lgkmcnt(3)
    v_pk_add_f32 v[80:81], v[80:81], v[92:93]
    v_add_f32 v82, v82, v94
    v_cvt_pk_bf16_f32 v80, v80, v81
    v_mfma_f32_32x32x16_bf16 v[112:127], v[48:51], v[160:163], v[112:127]
    ds_read_b128 v[32:35], v3 offset:12288
    v_permlane32_swap_b32 v82, v84
    v_permlane32_swap_b32 v80, v81
    v_cvt_pk_bf16_f32 v82, v82, v84
    s_mov_b32 exec_hi, 0
    buffer_store_dwordx4 v[80:83], v15, s[32:35], s44 offen sc1
    s_mov_b32 exec_hi, -1
    s_waitcnt lgkmcnt(3)
    v_mfma_f32_32x32x16_bf16 v[112:127], v[52:55], v[164:167], v[112:127]
    ds_read_b128 v[36:39], v3 offset:13312
    s_mul_i32 s91, s64, 12
    s_add_u32 s91, s91, 143360
    v_lshl_add_u32 v14, v0, 5, s91
    s_waitcnt lgkmcnt(3)
    v_mfma_f32_32x32x16_bf16 v[112:127], v[56:59], v[168:171], v[112:127]
    ds_read_b128 v[40:43], v3 offset:14336
    v_and_b32 v15, 3, v0
    v_bfe_u32 v16, v0, 2, 1
    ds_write_b128 v4, a[192:195] offset:0
    s_waitcnt lgkmcnt(4)
    v_mfma_f32_32x32x16_bf16 v[112:127], v[60:63], v[172:175], v[112:127]
    ds_read_b128 v[44:47], v3 offset:15360
    v_lshl_add_u32 v15, v16, 3, v15
    v_bfe_u32 v16, v0, 3, 1
    s_waitcnt lgkmcnt(4)
    v_mfma_f32_32x32x16_bf16 v[112:127], v[32:35], v[176:179], v[112:127]
    ds_read_b128 v[48:51], v3 offset:16384
    v_lshl_add_u32 v15, v16, 2, v15
    v_bfe_u32 v16, v0, 4, 1
    ds_write_b128 v4, a[196:199] offset:1024
    s_waitcnt lgkmcnt(5)
    v_mfma_f32_32x32x16_bf16 v[112:127], v[36:39], v[180:183], v[112:127]
    ds_read_b128 v[52:55], v3 offset:17408
    v_lshl_add_u32 v15, v16, 7, v15
    v_lshlrev_b32 v15, 2, v15
    s_waitcnt lgkmcnt(5)
    v_mfma_f32_32x32x16_bf16 v[112:127], v[40:43], v[184:187], v[112:127]
    ds_read_b128 v[56:59], v3 offset:18432
    v_add_u32 v15, 145408, v15
    v_add_u32 v16, 8, v14
    ds_write_b128 v4, a[200:203] offset:8192
    s_waitcnt lgkmcnt(5)
    v_mfma_f32_32x32x16_bf16 v[112:127], v[44:47], v[188:191], v[112:127]
    ds_read_b128 v[60:63], v3 offset:19456
    s_cmp_eq_u32 s64, 2
    s_cselect_b64 vcc, -1, 0
    v_cndmask_b32 v15, v16, v15, vcc
    v_lshrrev_b32 v16, 5, v0
    s_waitcnt lgkmcnt(5)
    v_mfma_f32_32x32x16_bf16 v[112:127], v[48:51], v[192:195], v[112:127]
    ds_read_b128 v[32:35], v3 offset:20480
    v_lshlrev_b32 v16, 5, v16
    v_add_u32 v16, 145408, v16
    ds_write_b128 v4, a[204:207] offset:9216
    s_waitcnt lgkmcnt(5)
    v_mfma_f32_32x32x16_bf16 v[112:127], v[52:55], v[196:199], v[112:127]
    ds_read_b128 v[36:39], v3 offset:21504
    v_lshlrev_b32 v13, 5, v0
    v_add_u32 v13, 143360, v13
    s_waitcnt lgkmcnt(5)
    v_mfma_f32_32x32x16_bf16 v[112:127], v[56:59], v[200:203], v[112:127]
    ds_read_b128 v[40:43], v3 offset:22528
    v_cndmask_b32_e64 v16, v13, v16, s[96:97]
    s_cmp_eq_u32 s64, 3
    s_cselect_b64 vcc, 0, -1
    ds_write_b128 v4, a[208:211] offset:16384
    s_waitcnt lgkmcnt(5)
    v_mfma_f32_32x32x16_bf16 v[112:127], v[60:63], v[204:207], v[112:127]
    ds_read_b128 v[44:47], v3 offset:23552
    s_mul_i32 s89, s76, 3
    s_add_u32 s89, s89, s45
    s_add_u32 s69, s68, 10
    s_waitcnt lgkmcnt(5)
    v_mfma_f32_32x32x16_bf16 v[112:127], v[32:35], v[208:211], v[112:127]
    ds_read_b128 v[48:51], v3 offset:24576
    s_mov_b32 s92, 0x66226622
    s_mov_b32 s93, s92
    v_mov_b32 v103, 0x3f80
    v_cndmask_b32_e64 v103, v103, 1.0, s[92:93]
    ds_write_b128 v4, a[212:215] offset:17408
    s_waitcnt lgkmcnt(5)
    v_mfma_f32_32x32x16_bf16 v[112:127], v[36:39], v[212:215], v[112:127]
    ds_read_b128 v[52:55], v3 offset:25600
    s_mov_b32 s92, 0x300003
    s_mov_b32 s93, s92
    v_cndmask_b32_e64 v100, 0, v103, s[92:93]
    s_waitcnt lgkmcnt(5)
    v_mfma_f32_32x32x16_bf16 v[112:127], v[40:43], v[216:219], v[112:127]
    ds_read_b128 v[56:59], v3 offset:26624
    s_mov_b32 s92, 0x30000300
    s_mov_b32 s93, s92
    v_cndmask_b32_e64 v101, 0, v103, s[92:93]
    ds_write_b128 v4, a[216:219] offset:24576
    s_waitcnt lgkmcnt(5)
    v_mfma_f32_32x32x16_bf16 v[112:127], v[44:47], v[220:223], v[112:127]
    ds_read_b128 v[60:63], v3 offset:27648
    s_mov_b32 s92, 0x40400404
    s_mov_b32 s93, s92
    v_cndmask_b32_e64 v102, 0, v103, s[92:93]
    s_waitcnt lgkmcnt(5)
    v_mfma_f32_32x32x16_bf16 v[112:127], v[48:51], v[224:227], v[112:127]
    ds_read_b128 v[32:35], v3 offset:28672
    v_mov_b32 v103, 0
    ds_write_b128 v4, a[220:223] offset:25600
    s_waitcnt lgkmcnt(5)
    v_mfma_f32_32x32x16_bf16 v[112:127], v[52:55], v[228:231], v[112:127]
    ds_read_b128 v[36:39], v3 offset:29696
    s_waitcnt lgkmcnt(5)
    v_mfma_f32_32x32x16_bf16 v[112:127], v[56:59], v[232:235], v[112:127]
    ds_read_b128 v[40:43], v3 offset:30720
    ds_write_b128 v4, a[224:227] offset:32768
    s_cbranch_vccz L_g3_83
    buffer_load_dwordx4 v[128:131], v1, s[32:35], s36 offen sc1
L_g3_83:
    s_waitcnt lgkmcnt(5)
    v_mfma_f32_32x32x16_bf16 v[112:127], v[60:63], v[236:239], v[112:127]
    ds_read_b128 v[44:47], v3 offset:31744
    s_waitcnt lgkmcnt(5)
    v_mfma_f32_32x32x16_bf16 v[112:127], v[32:35], v[240:243], v[112:127]
    ds_read_b128 v[48:51], v11 offset:27648
    ds_write_b128 v4, a[228:231] offset:33792
    s_cbranch_vccz L_g3_84
    buffer_load_dwordx4 v[132:135], v1, s[32:35], s37 offen sc1
L_g3_84:
    s_waitcnt lgkmcnt(5)
    v_mfma_f32_32x32x16_bf16 v[112:127], v[36:39], v[244:247], v[112:127]
    s_waitcnt lgkmcnt(4)
    v_mfma_f32_32x32x16_bf16 v[112:127], v[40:43], v[248:251], v[112:127]
    ds_write_b128 v4, a[232:235] offset:40960
    s_cbranch_vccz L_g3_85
    buffer_load_dwordx4 v[136:139], v1, s[32:35], s38 offen sc1
L_g3_85:
    s_waitcnt lgkmcnt(3)
    v_mfma_f32_32x32x16_bf16 v[112:127], v[44:47], v[252:255], v[112:127]
    s_waitcnt lgkmcnt(2)
    v_mfma_f32_32x32x16_bf16 v[112:127], v[48:51], v[20:23], v[112:127]
    ds_write_b128 v4, a[236:239] offset:41984
    s_cbranch_vccz L_g3_86
    buffer_load_dwordx4 v[140:143], v1, s[32:35], s39 offen sc1
L_g3_86:
    s_cbranch_vccz L_g3_87
    buffer_load_dwordx4 v[144:147], v1, s[32:35], s40 offen sc1
L_g3_87:
    s_nop 8
    v_pk_mul_f32 v[112:113], v[112:113], v[8:9] op_sel_hi:[1,0]
    v_pk_mul_f32 v[114:115], v[114:115], v[8:9] op_sel_hi:[1,0]
    v_pk_mul_f32 v[116:117], v[116:117], v[8:9] op_sel_hi:[1,0]
    v_pk_mul_f32 v[118:119], v[118:119], v[8:9] op_sel_hi:[1,0]
    v_pk_mul_f32 v[120:121], v[120:121], v[8:9] op_sel_hi:[1,0]
    v_pk_mul_f32 v[122:123], v[122:123], v[8:9] op_sel_hi:[1,0]
    v_pk_mul_f32 v[124:125], v[124:125], v[8:9] op_sel_hi:[1,0]
    v_pk_mul_f32 v[126:127], v[126:127], v[8:9] op_sel_hi:[1,0]
    v_exp_f32_e64 v48, v112 clamp
    v_exp_f32_e64 v49, v113 clamp
    v_exp_f32_e64 v50, v114 clamp
    v_exp_f32_e64 v51, v115 clamp
    v_exp_f32_e64 v52, v116 clamp
    v_exp_f32_e64 v53, v117 clamp
    s_cbranch_vccz L_g3_88
    buffer_load_dwordx4 v[148:151], v1, s[32:35], s41 offen sc1
L_g3_88:
    v_exp_f32_e64 v54, v118 clamp
    v_exp_f32_e64 v55, v119 clamp
    v_exp_f32_e64 v56, v120 clamp
    v_exp_f32_e64 v57, v121 clamp
    v_exp_f32_e64 v58, v122 clamp
    v_exp_f32_e64 v59, v123 clamp
    s_cbranch_vccz L_g3_89
    buffer_load_dwordx4 v[152:155], v1, s[32:35], s42 offen sc1
L_g3_89:
    v_exp_f32_e64 v60, v124 clamp
    v_exp_f32_e64 v61, v125 clamp
    v_exp_f32_e64 v62, v126 clamp
    v_exp_f32_e64 v63, v127 clamp
    v_pk_fma_f32 v[112:113], v[112:113], s[86:87], s[86:87] op_sel:[0,0,1] op_sel_hi:[1,0,1]
    v_pk_fma_f32 v[114:115], v[114:115], s[86:87], s[86:87] op_sel:[0,0,1] op_sel_hi:[1,0,1]
    s_cbranch_vccz L_g3_90
    buffer_load_dwordx4 v[156:159], v1, s[32:35], s43 offen sc1
L_g3_90:
    v_pk_fma_f32 v[116:117], v[116:117], s[86:87], s[86:87] op_sel:[0,0,1] op_sel_hi:[1,0,1]
    v_pk_fma_f32 v[118:119], v[118:119], s[86:87], s[86:87] op_sel:[0,0,1] op_sel_hi:[1,0,1]
    v_pk_fma_f32 v[120:121], v[120:121], s[86:87], s[86:87] op_sel:[0,0,1] op_sel_hi:[1,0,1]
    v_pk_fma_f32 v[122:123], v[122:123], s[86:87], s[86:87] op_sel:[0,0,1] op_sel_hi:[1,0,1]
    v_pk_fma_f32 v[124:125], v[124:125], s[86:87], s[86:87] op_sel:[0,0,1] op_sel_hi:[1,0,1]
    v_pk_fma_f32 v[126:127], v[126:127], s[86:87], s[86:87] op_sel:[0,0,1] op_sel_hi:[1,0,1]
    v_max_f32 v112, s87, v112
    v_max_f32 v113, s87, v113
    v_max_f32 v114, s87, v114
    v_max_f32 v115, s87, v115
    v_max_f32 v116, s87, v116
    v_max_f32 v117, s87, v117
    v_max_f32 v118, s87, v118
    v_max_f32 v119, s87, v119
    v_max_f32 v120, s87, v120
    v_max_f32 v121, s87, v121
    v_max_f32 v122, s87, v122
    v_max_f32 v123, s87, v123
    v_max_f32 v124, s87, v124
    v_max_f32 v125, s87, v125
    v_max_f32 v126, s87, v126
    v_max_f32 v127, s87, v127
    v_pk_add_f32 v[112:113], v[112:113], v[48:49]
    v_pk_add_f32 v[114:115], v[114:115], v[50:51]
    v_pk_add_f32 v[116:117], v[116:117], v[52:53]
    v_pk_add_f32 v[118:119], v[118:119], v[54:55]
    v_pk_add_f32 v[120:121], v[120:121], v[56:57]
    v_pk_add_f32 v[122:123], v[122:123], v[58:59]
    v_pk_add_f32 v[124:125], v[124:125], v[60:61]
    v_pk_add_f32 v[126:127], v[126:127], v[62:63]
    v_cvt_pk_bf16_f32 v24, v112, v113
    v_cvt_pk_bf16_f32 v25, v114, v115
    v_cvt_pk_bf16_f32 v26, v116, v117
    v_cvt_pk_bf16_f32 v27, v118, v119
    v_cvt_pk_bf16_f32 v28, v120, v121
    v_cvt_pk_bf16_f32 v29, v122, v123
    v_cvt_pk_bf16_f32 v30, v124, v125
    v_cvt_pk_bf16_f32 v31, v126, v127
    ds_write_b128 v4, a[240:243] offset:49152
    ds_write_b128 v4, a[244:247] offset:50176
    ds_write_b128 v4, a[248:251] offset:57344
    ds_write_b128 v4, a[252:255] offset:58368
    s_cbranch_vccz L_gather3_93
    s_waitcnt vmcnt(6)
    v_xor_b32 v131, s88, v131
    v_xor_b32 v135, s88, v135
    s_waitcnt vmcnt(5)
    v_xor_b32 v139, s88, v139
    v_mfma_f32_16x16x32_bf16 v[168:171], v[100:103], v[128:131], 0
    s_waitcnt vmcnt(4)
    v_xor_b32 v143, s88, v143
    v_mfma_f32_16x16x32_bf16 v[168:171], v[100:103], v[132:135], v[168:171]
    s_waitcnt vmcnt(3)
    v_xor_b32 v147, s88, v147
    v_mfma_f32_16x16x32_bf16 v[168:171], v[100:103], v[136:139], v[168:171]
    s_waitcnt vmcnt(2)
    v_xor_b32 v151, s88, v151
    v_mfma_f32_16x16x32_bf16 v[168:171], v[100:103], v[140:143], v[168:171]
    s_waitcnt vmcnt(1)
    v_xor_b32 v155, s88, v155
    v_mfma_f32_16x16x32_bf16 v[168:171], v[100:103], v[144:147], v[168:171]
    s_waitcnt vmcnt(0)
    v_xor_b32 v159, s88, v159
    v_mfma_f32_16x16x32_bf16 v[168:171], v[100:103], v[148:151], v[168:171]
    v_mfma_f32_16x16x32_bf16 v[168:171], v[100:103], v[152:155], v[168:171]
    v_mfma_f32_16x16x32_bf16 v[168:171], v[100:103], v[156:159], v[168:171]
L_gatherj_92:
    v_or3_b32 v160, v131, v135, v139
    v_or3_b32 v160, v160, v143, v147
    v_or3_b32 v160, v160, v151, v155
    v_or_b32 v160, v160, v159
    v_cmp_ne_u32 vcc, 0, v160
    s_cbranch_vccz L_gok_94
L_gather_91:
    s_add_u32 s98, s98, 1
    s_cmp_lt_u32 s98, 400000
    s_cbranch_scc0 L_gok_94
    v_cmp_ne_u32 vcc, 0, v131
    v_xor_b32 v131, s88, v131
    s_cbranch_vccz L_gs_95
    buffer_load_dwordx4 v[128:131], v1, s[32:35], s36 offen sc1
L_gs_95:
    v_cmp_ne_u32 vcc, 0, v135
    v_xor_b32 v135, s88, v135
    s_cbranch_vccz L_gs_96
    buffer_load_dwordx4 v[132:135], v1, s[32:35], s37 offen sc1
L_gs_96:
    v_cmp_ne_u32 vcc, 0, v139
    v_xor_b32 v139, s88, v139
    s_cbranch_vccz L_gs_97
    buffer_load_dwordx4 v[136:139], v1, s[32:35], s38 offen sc1
L_gs_97:
    v_cmp_ne_u32 vcc, 0, v143
    v_xor_b32 v143, s88, v143
    s_cbranch_vccz L_gs_98
    buffer_load_dwordx4 v[140:143], v1, s[32:35], s39 offen sc1
L_gs_98:
    v_cmp_ne_u32 vcc, 0, v147
    v_xor_b32 v147, s88, v147
    s_cbranch_vccz L_gs_99
    buffer_load_dwordx4 v[144:147], v1, s[32:35], s40 offen sc1
L_gs_99:
    v_cmp_ne_u32 vcc, 0, v151
    v_xor_b32 v151, s88, v151
    s_cbranch_vccz L_gs_100
    buffer_load_dwordx4 v[148:151], v1, s[32:35], s41 offen sc1
L_gs_100:
    v_cmp_ne_u32 vcc, 0, v155
    v_xor_b32 v155, s88, v155
    s_cbranch_vccz L_gs_101
    buffer_load_dwordx4 v[152:155], v1, s[32:35], s42 offen sc1
L_gs_101:
    v_cmp_ne_u32 vcc, 0, v159
    v_xor_b32 v159, s88, v159
    s_cbranch_vccz L_gs_102
    buffer_load_dwordx4 v[156:159], v1, s[32:35], s43 offen sc1
L_gs_102:
    s_waitcnt vmcnt(0)
    v_xor_b32 v131, s88, v131
    v_xor_b32 v135, s88, v135
    v_xor_b32 v139, s88, v139
    v_xor_b32 v143, s88, v143
    v_xor_b32 v147, s88, v147
    v_xor_b32 v151, s88, v151
    v_xor_b32 v155, s88, v155
    v_xor_b32 v159, s88, v159
    v_mfma_f32_16x16x32_bf16 v[168:171], v[100:103], v[128:131], 0
    v_mfma_f32_16x16x32_bf16 v[168:171], v[100:103], v[132:135], v[168:171]
    v_mfma_f32_16x16x32_bf16 v[168:171], v[100:103], v[136:139], v[168:171]
    v_mfma_f32_16x16x32_bf16 v[168:171], v[100:103], v[140:143], v[168:171]
    v_mfma_f32_16x16x32_bf16 v[168:171], v[100:103], v[144:147], v[168:171]
    v_mfma_f32_16x16x32_bf16 v[168:171], v[100:103], v[148:151], v[168:171]
    v_mfma_f32_16x16x32_bf16 v[168:171], v[100:103], v[152:155], v[168:171]
    v_mfma_f32_16x16x32_bf16 v[168:171], v[100:103], v[156:159], v[168:171]
    s_branch L_gatherj_92
L_gok_94:
    s_nop 1
    ds_write2_b32 v14, v168, v169 offset0:0 offset1:1
    ds_write_b32 v15, v170
L_gather3_93:
    s_waitcnt lgkmcnt(0)
    s_barrier
    ds_read_b128 v[32:35], v16 offset:0
    ds_read_b128 v[36:39], v16 offset:16
    ds_read_b128 v[40:43], v16 offset:512
    ds_read_b128 v[44:47], v16 offset:528
    v_mov_b32 v12, s69
    v_mov_b32 v13, s69
    v_mov_b32 v14, 0x3fb8aa3b
    v_and_b32 v16, 48, v0
    v_lshl_add_u32 v15, v16, 4, v1
    v_and_b32 v16, 16, v0
    v_mad_u32_u24 v16, v16, 48, v1
    v_add_u32 v20, 0x10000, v1
    s_add_u32 s75, s75, s76
    s_waitcnt lgkmcnt(2)
    v_cvt_pk_bf16_f32 v48, v32, v33
    v_cvt_pk_bf16_f32 v49, v34, v35
    v_cvt_pk_bf16_f32 v50, v36, v37
    v_cvt_pk_bf16_f32 v51, v38, v39
    s_nop 1
    v_mfma_f32_32x32x16_bf16 v[80:95], v[48:51], v[24:27], 0
    s_waitcnt lgkmcnt(0)
    v_cvt_pk_bf16_f32 v52, v40, v41
    v_cvt_pk_bf16_f32 v53, v42, v43
    v_cvt_pk_bf16_f32 v54, v44, v45
    v_cvt_pk_bf16_f32 v55, v46, v47
    s_nop 1
    v_mfma_f32_32x32x16_bf16 v[96:111], v[52:55], v[28:31], 0
    s_nop 3
    v_fmaak_f32 v88, v88, v14, 0x35c1a2a0
    v_rcp_f32 v88, v88
    s_nop 0
    v_pk_mul_f32 v[80:81], v[80:81], v[88:89] op_sel_hi:[1,0]
    v_pk_mul_f32 v[82:83], v[82:83], v[88:89] op_sel_hi:[1,0]
    v_pk_mul_f32 v[84:85], v[84:85], v[88:89] op_sel_hi:[1,0]
    v_pk_mul_f32 v[86:87], v[86:87], v[88:89] op_sel_hi:[1,0]
    v_cvt_pk_bf16_f32 v112, v80, v81
    v_cvt_pk_bf16_f32 v113, v82, v83
    v_cvt_pk_bf16_f32 v114, v84, v85
    v_cvt_pk_bf16_f32 v115, v86, v87
    s_cmp_lg_u32 s76, 0
    s_cbranch_scc1 L_slow_103
    buffer_store_dwordx4 v[112:115], v1, s[24:27], s89 offen offset:0
L_back_104:
    v_fmaak_f32 v104, v104, v14, 0x35c1a2a0
    v_rcp_f32 v104, v104
    s_nop 0
    v_pk_mul_f32 v[96:97], v[96:97], v[104:105] op_sel_hi:[1,0]
    v_pk_mul_f32 v[98:99], v[98:99], v[104:105] op_sel_hi:[1,0]
    v_pk_mul_f32 v[100:101], v[100:101], v[104:105] op_sel_hi:[1,0]
    v_pk_mul_f32 v[102:103], v[102:103], v[104:105] op_sel_hi:[1,0]
    v_cvt_pk_bf16_f32 v116, v96, v97
    v_cvt_pk_bf16_f32 v117, v98, v99
    v_cvt_pk_bf16_f32 v118, v100, v101
    v_cvt_pk_bf16_f32 v119, v102, v103
    s_cmp_lg_u32 s76, 0
    s_cbranch_scc1 L_slow_105
    buffer_store_dwordx4 v[116:119], v1, s[24:27], s89 offen offset:1024
L_back_106:
    ds_write_b128 v19, a[160:163] offset:0
    ds_write_b128 v19, a[164:167] offset:1024
    ds_write_b128 v19, a[168:171] offset:2048
    ds_write_b128 v19, a[172:175] offset:3072
    ds_write_b128 v19, a[176:179] offset:16384
    s_mov_b64 exec, 1
    s_cmp_lg_u32 s76, 0
    s_cbranch_scc1 L_slow_107
    s_waitcnt vmcnt(0)
    buffer_store_dwordx2 v[12:13], v6, s[24:27], s46 offen
L_back_108:
    s_mov_b64 exec, -1
    buffer_load_dword v12, v6, s[24:27], s83 offen sc1
    ds_write_b128 v19, a[180:183] offset:17408
    ds_write_b128 v19, a[184:187] offset:18432
    ds_write_b128 v19, a[188:191] offset:19456
    ds_read_b128 v[192:195], v20 offset:32768
    ds_read_b128 v[196:199], v20 offset:33792
    ds_read_b128 v[200:203], v20 offset:34816
    ds_read_b128 v[204:207], v20 offset:35840
    ds_read_b128 v[208:211], v20 offset:36864
    ds_read_b128 v[212:215], v20 offset:37888
    ds_read_b128 v[216:219], v20 offset:38912
    ds_read_b128 v[220:223], v20 offset:39936
    ds_read_b128 v[224:227], v20 offset:40960
    ds_read_b128 v[228:231], v20 offset:41984
L_poll_109:
    s_add_u32 s98, s98, 1
    s_cmp_lt_u32 s98, 400000
    s_cselect_b64 s[94:95], -1, 0
    s_waitcnt vmcnt(0)
    v_cmp_ne_u32 vcc, s69, v12
    buffer_load_dword v12, v6, s[24:27], s83 offen sc1
    s_and_b64 vcc, vcc, s[94:95]
    s_cbranch_scc1 L_poll_109
    s_add_u32 s90, s75, s0
    buffer_load_dwordx4 v[128:131], v15, s[24:27], s90 offen offset:0 sc1
    buffer_load_dwordx4 v[132:135], v15, s[24:27], s90 offen offset:2048 sc1
    ds_read_b128 v[232:235], v20 offset:43008
    ds_read_b128 v[236:239], v20 offset:44032
    ds_read_b128 v[240:243], v20 offset:45056
    s_add_u32 s90, s90, 4096
    buffer_load_dwordx4 v[136:139], v15, s[24:27], s90 offen offset:0 sc1
    ds_read_b128 v[244:247], v20 offset:46080
    ds_read_b128 v[248:251], v20 offset:47104
    ds_read_b128 v[252:255], v20 offset:48128
    buffer_load_dwordx4 v[140:143], v15, s[24:27], s90 offen offset:2048 sc1
    ds_read_b128 v[32:35], v20 offset:49152
    ds_read_b128 v[36:39], v20 offset:50176
    ds_read_b128 v[40:43], v20 offset:51200
    s_add_u32 s90, s75, s1
    buffer_load_dwordx4 v[144:147], v15, s[24:27], s90 offen offset:0 sc1
    ds_read_b128 v[44:47], v20 offset:52224
    ds_read_b128 v[48:51], v20 offset:53248
    ds_read_b128 v[52:55], v20 offset:54272
    buffer_load_dwordx4 v[148:151], v15, s[24:27], s90 offen offset:2048 sc1
    ds_read_b128 v[56:59], v20 offset:55296
    ds_read_b128 v[60:63], v20 offset:56320
    ds_read_b128 v[80:83], v20 offset:57344
    s_add_u32 s90, s90, 4096
    buffer_load_dwordx4 v[152:155], v15, s[24:27], s90 offen offset:0 sc1
    ds_read_b128 v[84:87], v20 offset:58368
    ds_read_b128 v[88:91], v20 offset:59392
    ds_read_b128 v[92:95], v20 offset:60416
    buffer_load_dwordx4 v[156:159], v15, s[24:27], s90 offen offset:2048 sc1
    ds_read_b128 v[96:99], v20 offset:61440
    ds_read_b128 v[100:103], v20 offset:62464
    ds_read_b128 v[104:107], v20 offset:63488
    s_waitcnt vmcnt(7) lgkmcnt(15)
    v_mfma_f32_16x16x32_bf16 v[64:67], v[192:195], v[128:131], v[64:67]
    ds_read_b128 v[108:111], v20 offset:64512
    v_mfma_f32_16x16x32_bf16 v[68:71], v[196:199], v[128:131], v[68:71]
    s_barrier
    s_add_u32 s90, s75, s2
    buffer_load_dwordx4 v[160:163], v15, s[24:27], s90 offen offset:0 sc1
    v_mfma_f32_16x16x32_bf16 v[72:75], v[200:203], v[128:131], v[72:75]
    ds_read_b128 v[192:195], v20 offset:0
    v_mfma_f32_16x16x32_bf16 v[76:79], v[204:207], v[128:131], v[76:79]
    s_waitcnt vmcnt(7) lgkmcnt(15)
    v_mfma_f32_16x16x32_bf16 v[64:67], v[208:211], v[132:135], v[64:67]
    ds_read_b128 v[196:199], v20 offset:1024
    v_mfma_f32_16x16x32_bf16 v[68:71], v[212:215], v[132:135], v[68:71]
    buffer_load_dwordx4 v[164:167], v15, s[24:27], s90 offen offset:2048 sc1
    v_mfma_f32_16x16x32_bf16 v[72:75], v[216:219], v[132:135], v[72:75]
L_pad7:
    s_cbranch_execz L_pad8
    ds_read_b128 v[200:203], v20 offset:2048
    v_mfma_f32_16x16x32_bf16 v[76:79], v[220:223], v[132:135], v[76:79]
    s_waitcnt vmcnt(7) lgkmcnt(15)
    v_mfma_f32_16x16x32_bf16 v[64:67], v[224:227], v[136:139], v[64:67]
    ds_read_b128 v[204:207], v20 offset:3072
    v_mfma_f32_16x16x32_bf16 v[68:71], v[228:231], v[136:139], v[68:71]
    s_add_u32 s90, s90, 4096
    buffer_load_dwordx4 v[168:171], v15, s[24:27], s90 offen offset:0 sc1
    v_mfma_f32_16x16x32_bf16 v[72:75], v[232:235], v[136:139], v[72:75]
    ds_read_b128 v[208:211], v20 offset:4096
    v_mfma_f32_16x16x32_bf16 v[76:79], v[236:239], v[136:139], v[76:79]
    s_waitcnt vmcnt(7) lgkmcnt(15)
    v_mfma_f32_16x16x32_bf16 v[64:67], v[240:243], v[140:143], v[64:67]
    ds_read_b128 v[212:215], v20 offset:5120
    v_mfma_f32_16x16x32_bf16 v[68:71], v[244:247], v[140:143], v[68:71]
    buffer_load_dwordx4 v[172:175], v15, s[24:27], s90 offen offset:2048 sc1
    v_mfma_f32_16x16x32_bf16 v[72:75], v[248:251], v[140:143], v[72:75]
    ds_read_b128 v[216:219], v20 offset:6144
    v_mfma_f32_16x16x32_bf16 v[76:79], v[252:255], v[140:143], v[76:79]
    s_waitcnt vmcnt(7) lgkmcnt(15)
    v_mfma_f32_16x16x32_bf16 v[64:67], v[32:35], v[144:147], v[64:67]
    ds_read_b128 v[220:223], v20 offset:7168
    v_mfma_f32_16x16x32_bf16 v[68:71], v[36:39], v[144:147], v[68:71]
    s_add_u32 s90, s75, s3
    buffer_load_dwordx4 v[176:179], v15, s[24:27], s90 offen offset:0 sc1
    v_mfma_f32_16x16x32_bf16 v[72:75], v[40:43], v[144:147], v[72:75]
    ds_read_b128 v[224:227], v20 offset:8192
    v_mfma_f32_16x16x32_bf16 v[76:79], v[44:47], v[144:147], v[76:79]
    s_waitcnt vmcnt(7) lgkmcnt(15)
    v_mfma_f32_16x16x32_bf16 v[64:67], v[48:51], v[148:151], v[64:67]
    ds_read_b128 v[228:231], v20 offset:9216
    v_mfma_f32_16x16x32_bf16 v[68:71], v[52:55], v[148:151], v[68:71]
    buffer_load_dwordx4 v[180:183], v15, s[24:27], s90 offen offset:2048 sc1
    v_mfma_f32_16x16x32_bf16 v[72:75], v[56:59], v[148:151], v[72:75]
    ds_read_b128 v[232:235], v20 offset:10240
    v_mfma_f32_16x16x32_bf16 v[76:79], v[60:63], v[148:151], v[76:79]
    s_waitcnt vmcnt(7) lgkmcnt(15)
    v_mfma_f32_16x16x32_bf16 v[64:67], v[80:83], v[152:155], v[64:67]
    ds_read_b128 v[236:239], v20 offset:11264
    v_mfma_f32_16x16x32_bf16 v[68:71], v[84:87], v[152:155], v[68:71]
    s_add_u32 s90, s90, 4096
    buffer_load_dwordx4 v[184:187], v15, s[24:27], s90 offen offset:0 sc1
    v_mfma_f32_16x16x32_bf16 v[72:75], v[88:91], v[152:155], v[72:75]
    ds_read_b128 v[240:243], v20 offset:12288
    v_mfma_f32_16x16x32_bf16 v[76:79], v[92:95], v[152:155], v[76:79]
    s_waitcnt vmcnt(7) lgkmcnt(13)
    v_mfma_f32_16x16x32_bf16 v[64:67], v[96:99], v[156:159], v[64:67]
    ds_read_b128 v[244:247], v20 offset:13312
    v_mfma_f32_16x16x32_bf16 v[68:71], v[100:103], v[156:159], v[68:71]
    buffer_load_dwordx4 v[188:191], v15, s[24:27], s90 offen offset:2048 sc1
    v_mfma_f32_16x16x32_bf16 v[72:75], v[104:107], v[156:159], v[72:75]
    ds_read_b128 v[248:251], v20 offset:14336
    v_mfma_f32_16x16x32_bf16 v[76:79], v[108:111], v[156:159], v[76:79]
    s_waitcnt vmcnt(7) lgkmcnt(11)
    v_mfma_f32_16x16x32_bf16 v[64:67], v[192:195], v[160:163], v[64:67]
    ds_read_b128 v[252:255], v20 offset:15360
    v_mfma_f32_16x16x32_bf16 v[68:71], v[196:199], v[160:163], v[68:71]
    ds_read_b128 v[32:35], v20 offset:16384
    v_mfma_f32_16x16x32_bf16 v[72:75], v[200:203], v[160:163], v[72:75]
    ds_read_b128 v[36:39], v20 offset:17408
    v_mfma_f32_16x16x32_bf16 v[76:79], v[204:207], v[160:163], v[76:79]
    ds_read_b128 v[40:43], v20 offset:18432
    s_waitcnt vmcnt(6) lgkmcnt(11)
    v_mfma_f32_16x16x32_bf16 v[64:67], v[208:211], v[164:167], v[64:67]
    ds_read_b128 v[44:47], v20 offset:19456
    v_mfma_f32_16x16x32_bf16 v[68:71], v[212:215], v[164:167], v[68:71]
    ds_read_b128 v[48:51], v20 offset:20480
    v_mfma_f32_16x16x32_bf16 v[72:75], v[216:219], v[164:167], v[72:75]
    ds_read_b128 v[52:55], v20 offset:21504
    v_mfma_f32_16x16x32_bf16 v[76:79], v[220:223], v[164:167], v[76:79]
    ds_read_b128 v[56:59], v20 offset:22528
    s_waitcnt vmcnt(5) lgkmcnt(11)
    v_mfma_f32_16x16x32_bf16 v[64:67], v[224:227], v[168:171], v[64:67]
    ds_read_b128 v[60:63], v20 offset:23552
    v_mfma_f32_16x16x32_bf16 v[68:71], v[228:231], v[168:171], v[68:71]
    ds_read_b128 v[80:83], v20 offset:24576
    v_mfma_f32_16x16x32_bf16 v[72:75], v[232:235], v[168:171], v[72:75]
    ds_read_b128 v[84:87], v20 offset:25600
    v_mfma_f32_16x16x32_bf16 v[76:79], v[236:239], v[168:171], v[76:79]
    ds_read_b128 v[88:91], v20 offset:26624
    s_waitcnt vmcnt(4) lgkmcnt(11)
    v_mfma_f32_16x16x32_bf16 v[64:67], v[240:243], v[172:175], v[64:67]
    ds_read_b128 v[92:95], v20 offset:27648
    v_mfma_f32_16x16x32_bf16 v[68:71], v[244:247], v[172:175], v[68:71]
    ds_read_b128 v[96:99], v20 offset:28672
    v_mfma_f32_16x16x32_bf16 v[72:75], v[248:251], v[172:175], v[72:75]
    ds_read_b128 v[100:103], v20 offset:29696
    v_mfma_f32_16x16x32_bf16 v[76:79], v[252:255], v[172:175], v[76:79]
    ds_read_b128 v[104:107], v20 offset:30720
    s_waitcnt vmcnt(3) lgkmcnt(11)
    v_mfma_f32_16x16x32_bf16 v[64:67], v[32:35], v[176:179], v[64:67]
    ds_read_b128 v[108:111], v20 offset:31744
    v_mfma_f32_16x16x32_bf16 v[68:71], v[36:39], v[176:179], v[68:71]
    v_mfma_f32_16x16x32_bf16 v[72:75], v[40:43], v[176:179], v[72:75]
    v_mfma_f32_16x16x32_bf16 v[76:79], v[44:47], v[176:179], v[76:79]
    s_add_u32 s70, s70, s76
    s_add_u32 s72, s72, s76
    s_add_u32 s80, s80, s76
    s_add_u32 s81, s81, s76
    s_waitcnt vmcnt(2) lgkmcnt(8)
    v_mfma_f32_16x16x32_bf16 v[64:67], v[48:51], v[180:183], v[64:67]
    v_mfma_f32_16x16x32_bf16 v[68:71], v[52:55], v[180:183], v[68:71]
    v_mfma_f32_16x16x32_bf16 v[72:75], v[56:59], v[180:183], v[72:75]
    v_mfma_f32_16x16x32_bf16 v[76:79], v[60:63], v[180:183], v[76:79]
    s_add_u32 s69, s68, 3
    v_mov_b32 v28, s69
    v_mov_b32 v29, s69
    s_waitcnt vmcnt(1) lgkmcnt(4)
    v_mfma_f32_16x16x32_bf16 v[64:67], v[80:83], v[184:187], v[64:67]
    v_mfma_f32_16x16x32_bf16 v[68:71], v[84:87], v[184:187], v[68:71]
    v_mfma_f32_16x16x32_bf16 v[72:75], v[88:91], v[184:187], v[72:75]
    v_mfma_f32_16x16x32_bf16 v[76:79], v[92:95], v[184:187], v[76:79]
    s_not_b64 s[86:87], s[96:97]
    s_bitcmp1_b32 s64, 0
    s_cselect_b64 s[86:87], s[96:97], s[86:87]
    s_waitcnt vmcnt(0) lgkmcnt(0)
    v_mfma_f32_16x16x32_bf16 v[64:67], v[96:99], v[188:191], v[64:67]
    v_mfma_f32_16x16x32_bf16 v[68:71], v[100:103], v[188:191], v[68:71]
    v_mfma_f32_16x16x32_bf16 v[72:75], v[104:107], v[188:191], v[72:75]
    v_mfma_f32_16x16x32_bf16 v[76:79], v[108:111], v[188:191], v[76:79]
    s_nop 4
    v_cvt_pk_bf16_f32 v112, v64, v65
    v_cvt_pk_bf16_f32 v114, v68, v69
    v_cvt_pk_bf16_f32 v113, v66, v67
    v_cvt_pk_bf16_f32 v115, v70, v71
    v_cvt_pk_bf16_f32 v116, v72, v73
    v_cvt_pk_bf16_f32 v118, v76, v77
    v_cvt_pk_bf16_f32 v117, v74, v75
    v_cvt_pk_bf16_f32 v119, v78, v79
    v_permlane16_swap_b32 v112, v114
    v_permlane16_swap_b32 v113, v115
    s_cmp_lg_u32 s76, 0
    s_cbranch_scc1 L_slow_110
    buffer_store_dwordx4 v[112:115], v16, s[4:7], s80 offen offset:0
L_back_111:
    v_permlane16_swap_b32 v116, v118
    v_permlane16_swap_b32 v117, v119
    s_cmp_lg_u32 s76, 0
    s_cbranch_scc1 L_slow_112
    buffer_store_dwordx4 v[116:119], v16, s[4:7], s80 offen offset:2048
L_back_113:
    v_pk_add_f32 v[12:13], v[64:65], v[66:67]
    v_pk_mul_f32 v[14:15], v[64:65], v[64:65]
    v_pk_fma_f32 v[14:15], v[66:67], v[66:67], v[14:15]
    v_pk_add_f32 v[12:13], v[12:13], v[68:69]
    v_pk_fma_f32 v[14:15], v[68:69], v[68:69], v[14:15]
    v_pk_add_f32 v[12:13], v[12:13], v[70:71]
    v_pk_fma_f32 v[14:15], v[70:71], v[70:71], v[14:15]
    v_pk_add_f32 v[12:13], v[12:13], v[72:73]
    v_pk_fma_f32 v[14:15], v[72:73], v[72:73], v[14:15]
    v_pk_add_f32 v[12:13], v[12:13], v[74:75]
    v_pk_fma_f32 v[14:15], v[74:75], v[74:75], v[14:15]
    v_pk_add_f32 v[12:13], v[12:13], v[76:77]
    v_pk_fma_f32 v[14:15], v[76:77], v[76:77], v[14:15]
    v_pk_add_f32 v[12:13], v[12:13], v[78:79]
    v_pk_fma_f32 v[14:15], v[78:79], v[78:79], v[14:15]
    v_add_f32 v12, v12, v13
    v_add_f32 v14, v14, v15
    s_nop 1
    v_permlane32_swap_b32 v12, v14
    v_add_f32 v12, v12, v14
    v_mov_b32 v13, v12
    s_nop 1
    v_permlane16_swap_b32 v12, v13
    v_add_f32 v12, v12, v13
    v_or_b32 v12, 1, v12
    s_cmp_lg_u32 s76, 0
    s_cbranch_scc1 L_slow_114
    s_mov_b64 exec, s[86:87]
    buffer_store_dword v12, v1, s[24:27], s81 offen
L_back_115:
    s_mov_b64 exec, -1
    s_mov_b64 exec, 1
    s_cmp_lg_u32 s76, 0
    s_cbranch_scc1 L_slow_116
    s_waitcnt vmcnt(1)
    buffer_store_dwordx2 v[28:29], v6, s[24:27], s82 offen
L_back_117:
    s_mov_b64 exec, -1
    buffer_load_dword v16, v6, s[24:27], s73 offen sc1
    s_waitcnt lgkmcnt(0)
    s_barrier
    ds_read_b128 v[32:35], v2 offset:0
    ds_read_b128 v[48:51], v2 offset:32768
    ds_read_b128 v[36:39], v2 offset:1024
    ds_read_b128 v[52:55], v2 offset:33792
L_warmb3:
    ds_write_b128 v5, a[96:99] offset:0
    ds_write_b128 v5, a[100:103] offset:1024
L_poll_118:
    s_add_u32 s98, s98, 1
    s_cmp_lt_u32 s98, 400000
    s_cselect_b64 s[94:95], -1, 0
    s_waitcnt vmcnt(0)
    v_cmp_ne_u32 vcc, s69, v16
    buffer_load_dword v16, v6, s[24:27], s73 offen sc1
    s_and_b64 vcc, vcc, s[94:95]
    s_cbranch_scc1 L_poll_118
    s_add_u32 s90, s70, s0
    buffer_load_dwordx4 v[128:131], v1, s[4:7], s90 offen offset:0 sc1
    buffer_load_dwordx4 v[132:135], v1, s[4:7], s90 offen offset:1024 sc1
    ds_write_b128 v5, a[104:107] offset:8192
    buffer_load_dwordx4 v[136:139], v1, s[4:7], s90 offen offset:2048 sc1
    ds_write_b128 v5, a[108:111] offset:9216
    buffer_load_dwordx4 v[140:143], v1, s[4:7], s90 offen offset:3072 sc1
    ds_write_b128 v5, a[112:115] offset:16384
    s_add_u32 s90, s90, 4096
    buffer_load_dwordx4 v[144:147], v1, s[4:7], s90 offen offset:0 sc1
    ds_write_b128 v5, a[116:119] offset:17408
    buffer_load_dwordx4 v[148:151], v1, s[4:7], s90 offen offset:1024 sc1
    ds_write_b128 v5, a[120:123] offset:24576
    buffer_load_dwordx4 v[152:155], v1, s[4:7], s90 offen offset:2048 sc1
    ds_write_b128 v5, a[124:127] offset:25600
    buffer_load_dwordx4 v[156:159], v1, s[4:7], s90 offen offset:3072 sc1
    ds_write_b128 v19, a[0:3] offset:32768
    s_waitcnt vmcnt(7) lgkmcnt(11)
    v_mfma_f32_32x32x16_bf16 v[80:95], v[32:35], v[128:131], 0
    ds_read_b128 v[40:43], v2 offset:2048
    ds_read_b128 v[56:59], v2 offset:34816
    v_mfma_f32_32x32x16_bf16 v[96:111], v[128:131], v[48:51], 0
    buffer_load_dwordx4 v[112:115], v1, s[24:27], s72 offen offset:0 sc1
    s_waitcnt vmcnt(7) lgkmcnt(11)
    v_mfma_f32_32x32x16_bf16 v[80:95], v[36:39], v[132:135], v[80:95]
    ds_read_b128 v[44:47], v2 offset:3072
    ds_read_b128 v[60:63], v2 offset:35840
    v_mfma_f32_32x32x16_bf16 v[96:111], v[132:135], v[52:55], v[96:111]
    buffer_load_dwordx4 v[116:119], v1, s[24:27], s72 offen offset:1024 sc1
    ds_write_b128 v19, a[4:7] offset:33792
    s_waitcnt vmcnt(7) lgkmcnt(3)
    v_mfma_f32_32x32x16_bf16 v[80:95], v[40:43], v[136:139], v[80:95]
    ds_read_b128 v[32:35], v2 offset:4096
    ds_read_b128 v[48:51], v2 offset:36864
    v_mfma_f32_32x32x16_bf16 v[96:111], v[136:139], v[56:59], v[96:111]
    s_add_u32 s90, s70, s1
    buffer_load_dwordx4 v[160:163], v1, s[4:7], s90 offen offset:0 sc1
    s_waitcnt vmcnt(7) lgkmcnt(3)
    v_mfma_f32_32x32x16_bf16 v[80:95], v[44:47], v[140:143], v[80:95]
    ds_read_b128 v[36:39], v2 offset:5120
    ds_read_b128 v[52:55], v2 offset:37888
    v_mfma_f32_32x32x16_bf16 v[96:111], v[140:143], v[60:63], v[96:111]
    buffer_load_dwordx4 v[164:167], v1, s[4:7], s90 offen offset:1024 sc1
    ds_write_b128 v19, a[8:11] offset:34816
    s_waitcnt vmcnt(7) lgkmcnt(3)
    v_mfma_f32_32x32x16_bf16 v[80:95], v[32:35], v[144:147], v[80:95]
    ds_read_b128 v[40:43], v2 offset:6144
    ds_read_b128 v[56:59], v2 offset:38912
    v_mfma_f32_32x32x16_bf16 v[96:111], v[144:147], v[48:51], v[96:111]
    buffer_load_dwordx4 v[168:171], v1, s[4:7], s90 offen offset:2048 sc1
    s_waitcnt vmcnt(7) lgkmcnt(3)
    v_mfma_f32_32x32x16_bf16 v[80:95], v[36:39], v[148:151], v[80:95]
    ds_read_b128 v[44:47], v2 offset:7168
    ds_read_b128 v[60:63], v2 offset:39936
    v_mfma_f32_32x32x16_bf16 v[96:111], v[148:151], v[52:55], v[96:111]
    buffer_load_dwordx4 v[172:175], v1, s[4:7], s90 offen offset:3072 sc1
    ds_write_b128 v19, a[12:15] offset:35840
    s_waitcnt vmcnt(7) lgkmcnt(3)
    v_mfma_f32_32x32x16_bf16 v[80:95], v[40:43], v[152:155], v[80:95]
    ds_read_b128 v[32:35], v2 offset:8192
    ds_read_b128 v[48:51], v2 offset:40960
    v_mfma_f32_32x32x16_bf16 v[96:111], v[152:155], v[56:59], v[96:111]
    s_add_u32 s90, s90, 4096
    buffer_load_dwordx4 v[176:179], v1, s[4:7], s90 offen offset:0 sc1
    s_waitcnt vmcnt(7) lgkmcnt(3)
    v_mfma_f32_32x32x16_bf16 v[80:95], v[44:47], v[156:159], v[80:95]
    ds_read_b128 v[36:39], v2 offset:9216
    ds_read_b128 v[52:55], v2 offset:41984
    v_mfma_f32_32x32x16_bf16 v[96:111], v[156:159], v[60:63], v[96:111]
    buffer_load_dwordx4 v[180:183], v1, s[4:7], s90 offen offset:1024 sc1
    ds_write_b128 v19, a[16:19] offset:49152
    s_waitcnt vmcnt(5) lgkmcnt(3)
    v_mfma_f32_32x32x16_bf16 v[80:95], v[32:35], v[160:163], v[80:95]
    ds_read_b128 v[40:43], v2 offset:10240
    ds_read_b128 v[56:59], v2 offset:43008
    v_mfma_f32_32x32x16_bf16 v[96:111], v[160:163], v[48:51], v[96:111]
    buffer_load_dwordx4 v[184:187], v1, s[4:7], s90 offen offset:2048 sc1
    v_bitop3_b32 v14, v112, v113, v114 bitop3:0x80
    v_bitop3_b32 v14, v14, v115, v116 bitop3:0x80
    v_bitop3_b32 v14, v14, v117, v118 bitop3:0x80
    s_waitcnt vmcnt(5) lgkmcnt(3)
    v_mfma_f32_32x32x16_bf16 v[80:95], v[36:39], v[164:167], v[80:95]
    ds_read_b128 v[44:47], v2 offset:11264
    ds_read_b128 v[60:63], v2 offset:44032
    v_mfma_f32_32x32x16_bf16 v[96:111], v[164:167], v[52:55], v[96:111]
    buffer_load_dwordx4 v[188:191], v1, s[4:7], s90 offen offset:3072 sc1
    ds_write_b128 v19, a[20:23] offset:50176
    v_bitop3_b32 v14, v14, v119, v119 bitop3:0x80
    v_and_b32 v14, 1, v14
    v_cmp_ne_u32 vcc, 1, v14
    s_cbranch_vccnz L_ro_119
L_rb_120:
    s_waitcnt vmcnt(5) lgkmcnt(3)
    v_mfma_f32_32x32x16_bf16 v[80:95], v[40:43], v[168:171], v[80:95]
    ds_read_b128 v[32:35], v2 offset:12288
    ds_read_b128 v[48:51], v2 offset:45056
    v_mfma_f32_32x32x16_bf16 v[96:111], v[168:171], v[56:59], v[96:111]
    s_add_u32 s90, s70, s2
    buffer_load_dwordx4 v[192:195], v1, s[4:7], s90 offen offset:0 sc1
    v_pk_add_f32 v[112:113], v[112:113], v[116:117]
    s_waitcnt vmcnt(5) lgkmcnt(3)
    v_mfma_f32_32x32x16_bf16 v[80:95], v[44:47], v[172:175], v[80:95]
    ds_read_b128 v[36:39], v2 offset:13312
    ds_read_b128 v[52:55], v2 offset:46080
    v_mfma_f32_32x32x16_bf16 v[96:111], v[172:175], v[60:63], v[96:111]
    buffer_load_dwordx4 v[196:199], v1, s[4:7], s90 offen offset:1024 sc1
    ds_write_b128 v19, a[24:27] offset:51200
    v_pk_add_f32 v[114:115], v[114:115], v[118:119]
    v_pk_add_f32 v[112:113], v[112:113], v[114:115]
    v_add_f32 v14, v112, v113
    s_waitcnt vmcnt(5) lgkmcnt(3)
    v_mfma_f32_32x32x16_bf16 v[80:95], v[32:35], v[176:179], v[80:95]
    ds_read_b128 v[40:43], v2 offset:14336
    ds_read_b128 v[56:59], v2 offset:47104
    v_mfma_f32_32x32x16_bf16 v[96:111], v[176:179], v[48:51], v[96:111]
    buffer_load_dwordx4 v[200:203], v1, s[4:7], s90 offen offset:2048 sc1
    buffer_load_dwordx4 v[204:207], v1, s[4:7], s90 offen offset:3072 sc1
    v_mov_b32 v15, v14
    s_nop 1
    v_permlane32_swap_b32 v14, v15
    v_mul_f32 v14, 0xbb000000, v14
    s_waitcnt vmcnt(6) lgkmcnt(3)
    v_mfma_f32_32x32x16_bf16 v[80:95], v[36:39], v[180:183], v[80:95]
    ds_read_b128 v[44:47], v2 offset:15360
    ds_read_b128 v[60:63], v2 offset:48128
    v_mfma_f32_32x32x16_bf16 v[96:111], v[180:183], v[52:55], v[96:111]
    s_add_u32 s90, s90, 4096
    buffer_load_dwordx4 v[208:211], v1, s[4:7], s90 offen offset:0 sc1
    ds_write_b128 v19, a[28:31] offset:52224
    v_mul_f32 v15, 0x3b000000, v15
    v_fma_f32 v15, -v14, v14, v15
    v_max_f32 v15, 0, v15
    s_waitcnt vmcnt(6) lgkmcnt(3)
    v_mfma_f32_32x32x16_bf16 v[80:95], v[40:43], v[184:187], v[80:95]
    ds_read_b128 v[32:35], v2 offset:16384
    ds_read_b128 v[48:51], v2 offset:49152
    v_mfma_f32_32x32x16_bf16 v[96:111], v[184:187], v[56:59], v[96:111]
    buffer_load_dwordx4 v[212:215], v1, s[4:7], s90 offen offset:1024 sc1
    v_add_f32 v15, 0x3727c5ac, v15
    v_rsq_f32 v8, v15
    v_cvt_pk_bf16_f32 v15, v14, v14
    s_waitcnt vmcnt(6) lgkmcnt(3)
    v_mfma_f32_32x32x16_bf16 v[80:95], v[44:47], v[188:191], v[80:95]
    ds_read_b128 v[36:39], v2 offset:17408
    ds_read_b128 v[52:55], v2 offset:50176
    v_mfma_f32_32x32x16_bf16 v[96:111], v[188:191], v[60:63], v[96:111]
    buffer_load_dwordx4 v[216:219], v1, s[4:7], s90 offen offset:2048 sc1
    buffer_load_dwordx4 v[220:223], v1, s[4:7], s90 offen offset:3072 sc1
    v_lshlrev_b32 v15, 16, v15
    s_lshl_b32 s91, s64, 7
    s_add_u32 s91, s91, 162816
    v_add_u32 v20, s91, v6
    s_waitcnt vmcnt(7) lgkmcnt(2)
    v_mfma_f32_32x32x16_bf16 v[80:95], v[32:35], v[192:195], v[80:95]
    ds_read_b128 v[40:43], v2 offset:18432
    ds_read_b128 v[56:59], v2 offset:51200
    v_mfma_f32_32x32x16_bf16 v[96:111], v[192:195], v[48:51], v[96:111]
    s_add_u32 s90, s70, s3
    buffer_load_dwordx4 v[224:227], v1, s[4:7], s90 offen offset:0 sc1
    ds_write_b32 v20, v8
    v_sub_f32 v15, v14, v15
    s_waitcnt vmcnt(7) lgkmcnt(3)
    v_mfma_f32_32x32x16_bf16 v[80:95], v[36:39], v[196:199], v[80:95]
    ds_read_b128 v[44:47], v2 offset:19456
    ds_read_b128 v[60:63], v2 offset:52224
    v_mfma_f32_32x32x16_bf16 v[96:111], v[196:199], v[52:55], v[96:111]
    buffer_load_dwordx4 v[228:231], v1, s[4:7], s90 offen offset:1024 sc1
    v_cvt_pk_bf16_f32 v20, v14, v15
    v_cvt_pk_bf16_f32 v21, v14, v15
    v_cvt_pk_bf16_f32 v22, v14, v15
    s_waitcnt vmcnt(7) lgkmcnt(3)
    v_mfma_f32_32x32x16_bf16 v[80:95], v[40:43], v[200:203], v[80:95]
    ds_read_b128 v[32:35], v2 offset:20480
    ds_read_b128 v[48:51], v2 offset:53248
    v_mfma_f32_32x32x16_bf16 v[96:111], v[200:203], v[56:59], v[96:111]
    buffer_load_dwordx4 v[232:235], v1, s[4:7], s90 offen offset:2048 sc1
    buffer_load_dwordx4 v[236:239], v1, s[4:7], s90 offen offset:3072 sc1
    v_cvt_pk_bf16_f32 v23, v14, v15
    ds_read_b128 v[112:115], v10 offset:0
    ds_read_b128 v[116:119], v10 offset:32
    s_waitcnt vmcnt(8) lgkmcnt(4)
    v_mfma_f32_32x32x16_bf16 v[80:95], v[44:47], v[204:207], v[80:95]
    ds_read_b128 v[36:39], v2 offset:21504
    ds_read_b128 v[52:55], v2 offset:54272
    v_mfma_f32_32x32x16_bf16 v[96:111], v[204:207], v[60:63], v[96:111]
    s_add_u32 s90, s90, 4096
    buffer_load_dwordx4 v[240:243], v1, s[4:7], s90 offen offset:0 sc1
    ds_read_b128 v[120:123], v10 offset:64
    ds_read_b128 v[124:127], v10 offset:96
    s_waitcnt vmcnt(8) lgkmcnt(6)
    v_mfma_f32_32x32x16_bf16 v[80:95], v[32:35], v[208:211], v[80:95]
    ds_read_b128 v[40:43], v2 offset:22528
    ds_read_b128 v[56:59], v2 offset:55296
    v_mfma_f32_32x32x16_bf16 v[96:111], v[208:211], v[48:51], v[96:111]
    buffer_load_dwordx4 v[244:247], v1, s[4:7], s90 offen offset:1024 sc1
    buffer_load_dwordx4 v[248:251], v1, s[4:7], s90 offen offset:2048 sc1
    s_mul_i32 s91, s64, 4352
    v_add_u32 v12, s91, v11
    v_lshrrev_b32 v15, 3, v0
    v_lshl_add_u32 v15, v15, 10, v12
    s_waitcnt vmcnt(9) lgkmcnt(4)
    v_mfma_f32_32x32x16_bf16 v[80:95], v[36:39], v[212:215], v[80:95]
    ds_read_b128 v[44:47], v2 offset:23552
    ds_read_b128 v[60:63], v2 offset:56320
    v_mfma_f32_32x32x16_bf16 v[96:111], v[212:215], v[52:55], v[96:111]
    buffer_load_dwordx4 v[252:255], v1, s[4:7], s90 offen offset:3072 sc1
    v_mov_b32 v28, s68
    s_mov_b64 s[92:93], 0x101
    v_mov_b32 v25, 0x3f803f80
    v_cndmask_b32_e64 v24, 0, v25, s[92:93]
    v_mov_b32 v25, v24
    s_waitcnt vmcnt(9) lgkmcnt(2)
    v_mfma_f32_32x32x16_bf16 v[80:95], v[40:43], v[216:219], v[80:95]
    ds_read_b128 v[32:35], v2 offset:24576
    ds_read_b128 v[48:51], v2 offset:57344
    v_mfma_f32_32x32x16_bf16 v[96:111], v[216:219], v[56:59], v[96:111]
    v_mov_b32 v26, v24
    v_mov_b32 v27, v24
    s_lshl1_add_u32 s8, s76, s8
    s_lshl1_add_u32 s9, s76, s9
    s_waitcnt vmcnt(8) lgkmcnt(2)
    v_mfma_f32_32x32x16_bf16 v[80:95], v[44:47], v[220:223], v[80:95]
    ds_read_b128 v[36:39], v2 offset:25600
    ds_read_b128 v[52:55], v2 offset:58368
    v_mfma_f32_32x32x16_bf16 v[96:111], v[220:223], v[60:63], v[96:111]
    s_waitcnt vmcnt(7) lgkmcnt(2)
    v_mfma_f32_32x32x16_bf16 v[80:95], v[32:35], v[224:227], v[80:95]
    s_barrier
    ds_read_b128 v[40:43], v2 offset:26624
    ds_read_b128 v[56:59], v2 offset:59392
    v_mfma_f32_32x32x16_bf16 v[96:111], v[224:227], v[48:51], v[96:111]
    s_waitcnt vmcnt(6) lgkmcnt(2)
    v_mfma_f32_32x32x16_bf16 v[80:95], v[36:39], v[228:231], v[80:95]
    ds_read_b128 v[44:47], v2 offset:27648
    ds_read_b128 v[60:63], v2 offset:60416
    v_mfma_f32_32x32x16_bf16 v[96:111], v[228:231], v[52:55], v[96:111]
    s_waitcnt vmcnt(5) lgkmcnt(3)
    v_mfma_f32_32x32x16_bf16 v[80:95], v[40:43], v[232:235], v[80:95]
    ds_read_b128 v[32:35], v2 offset:28672
    ds_read_b128 v[36:39], v2 offset:29696
    s_waitcnt vmcnt(4) lgkmcnt(3)
    v_mfma_f32_32x32x16_bf16 v[80:95], v[44:47], v[236:239], v[80:95]
    ds_read_b128 v[40:43], v2 offset:30720
    ds_read_b128 v[48:51], v2 offset:61440
    s_waitcnt vmcnt(3) lgkmcnt(3)
    v_mfma_f32_32x32x16_bf16 v[80:95], v[32:35], v[240:243], v[80:95]
    ds_read_b128 v[44:47], v2 offset:31744
    ds_read_b128 v[52:55], v2 offset:62464
    s_waitcnt vmcnt(2) lgkmcnt(4)
    v_mfma_f32_32x32x16_bf16 v[80:95], v[36:39], v[244:247], v[80:95]
    ds_read_b128 v[32:35], v11 offset:28672
    s_waitcnt vmcnt(1) lgkmcnt(4)
    v_mfma_f32_32x32x16_bf16 v[80:95], v[40:43], v[248:251], v[80:95]
    s_waitcnt vmcnt(0) lgkmcnt(2)
    v_mfma_f32_32x32x16_bf16 v[80:95], v[44:47], v[252:255], v[80:95]
    s_waitcnt lgkmcnt(0)
    v_mfma_f32_32x32x16_bf16 v[80:95], v[32:35], v[20:23], v[80:95]
    v_mfma_f32_32x32x16_bf16 v[96:111], v[232:235], v[56:59], v[96:111]
    ds_read_b128 v[56:59], v2 offset:63488
    v_mfma_f32_32x32x16_bf16 v[96:111], v[236:239], v[60:63], v[96:111]
    ds_read_b128 v[60:63], v2 offset:64512
    s_nop 7
    v_pk_mul_f32 v[80:81], v[80:81], v[8:9] op_sel_hi:[1,0]
    v_pk_mul_f32 v[82:83], v[82:83], v[8:9] op_sel_hi:[1,0]
    v_pk_mul_f32 v[84:85], v[84:85], v[8:9] op_sel_hi:[1,0]
    v_pk_mul_f32 v[86:87], v[86:87], v[8:9] op_sel_hi:[1,0]
    v_mfma_f32_32x32x16_bf16 v[96:111], v[240:243], v[48:51], v[96:111]
    ds_read_b128 v[48:51], v11 offset:29696
    v_cvt_pk_bf16_f32 v32, v80, v81
    v_cvt_pk_bf16_f32 v33, v82, v83
    v_cvt_pk_bf16_f32 v34, v84, v85
    v_cvt_pk_bf16_f32 v35, v86, v87
    v_mfma_f32_32x32x16_bf16 v[96:111], v[244:247], v[52:55], v[96:111]
    buffer_store_dwordx4 v[32:35], v1, s[32:35], s48 offen offset:0 sc1
    v_pk_mul_f32 v[88:89], v[88:89], v[8:9] op_sel_hi:[1,0]
    v_pk_mul_f32 v[90:91], v[90:91], v[8:9] op_sel_hi:[1,0]
    v_pk_mul_f32 v[92:93], v[92:93], v[8:9] op_sel_hi:[1,0]
    s_waitcnt lgkmcnt(2)
    v_mfma_f32_32x32x16_bf16 v[96:111], v[248:251], v[56:59], v[96:111]
    v_pk_mul_f32 v[94:95], v[94:95], v[8:9] op_sel_hi:[1,0]
    v_cvt_pk_bf16_f32 v36, v88, v89
    v_cvt_pk_bf16_f32 v37, v90, v91
    v_cvt_pk_bf16_f32 v38, v92, v93
    s_waitcnt lgkmcnt(1)
    v_mfma_f32_32x32x16_bf16 v[96:111], v[252:255], v[60:63], v[96:111]
    v_cvt_pk_bf16_f32 v39, v94, v95
    buffer_store_dwordx4 v[36:39], v1, s[32:35], s48 offen offset:1024 sc1
    ds_write_b128 v12, v[32:35] offset:0
    ds_write_b128 v12, v[36:39] offset:1024
    s_waitcnt lgkmcnt(2)
    v_mfma_f32_32x32x16_bf16 v[96:111], v[20:23], v[48:51], v[96:111]
    s_mov_b64 exec, 0xffff
    ds_write_b128 v15, v[24:27] offset:3072
    s_mov_b64 exec, -1
    ds_read_b128 v[48:51], v3 offset:0
    ds_read_b128 v[52:55], v3 offset:1024
    ds_read_b128 v[56:59], v3 offset:2048
    ds_read_b128 v[60:63], v3 offset:3072
    s_nop 4
    v_pk_mul_f32 v[96:97], v[96:97], v[112:113]
    v_pk_mul_f32 v[98:99], v[98:99], v[114:115]
    v_pk_mul_f32 v[100:101], v[100:101], v[116:117]
    v_pk_mul_f32 v[102:103], v[102:103], v[118:119]
    v_cvt_pk_bf16_f32 v40, v96, v97
    v_cvt_pk_bf16_f32 v41, v98, v99
    v_cvt_pk_bf16_f32 v42, v100, v101
    v_cvt_pk_bf16_f32 v43, v102, v103
    buffer_store_dwordx4 v[40:43], v1, s[32:35], s48 offen offset:2048 sc1
    v_pk_mul_f32 v[104:105], v[104:105], v[120:121]
    v_pk_mul_f32 v[106:107], v[106:107], v[122:123]
    v_pk_mul_f32 v[108:109], v[108:109], v[124:125]
    v_pk_mul_f32 v[110:111], v[110:111], v[126:127]
    v_cvt_pk_bf16_f32 v44, v104, v105
    v_cvt_pk_bf16_f32 v45, v106, v107
    v_cvt_pk_bf16_f32 v46, v108, v109
    v_cvt_pk_bf16_f32 v47, v110, v111
    buffer_store_dwordx4 v[44:47], v1, s[32:35], s48 offen offset:3200 sc1
    s_waitcnt lgkmcnt(3)
    v_mfma_f32_32x32x16_bf16 v[112:127], v[48:51], v[128:131], 0
    ds_write_b128 v12, v[40:43] offset:2048
    ds_read_b128 v[32:35], v3 offset:4096
    s_lshr_b32 s92, s64, 1
    s_lshl_b32 s91, s92, 10
    v_add_u32 v17, s91, v1
    s_waitcnt lgkmcnt(4)
    v_mfma_f32_32x32x16_bf16 v[112:127], v[52:55], v[132:135], v[112:127]
    ds_read_b128 v[36:39], v3 offset:5120
    s_lshr_b32 s92, s64, 1
    s_lshl_b32 s91, s92, 8
    v_add_u32 v18, s91, v1
    s_waitcnt lgkmcnt(4)
    v_mfma_f32_32x32x16_bf16 v[112:127], v[56:59], v[136:139], v[112:127]
    ds_write_b128 v12, v[44:47] offset:3200
    ds_read_b128 v[40:43], v3 offset:6144
    v_and_b32 v16, 11, v0
    v_min_u32 v16, 1, v16
    v_or_b32 v16, 64, v16
    s_waitcnt lgkmcnt(5)
    v_mfma_f32_32x32x16_bf16 v[112:127], v[60:63], v[140:143], v[112:127]
    ds_read_b128 v[44:47], v3 offset:7168
    v_lshlrev_b32 v16, 4, v16
    v_cndmask_b32_e64 v18, v18, v16, s[96:97]
    s_waitcnt lgkmcnt(4)
    v_mfma_f32_32x32x16_bf16 v[112:127], v[32:35], v[144:147], v[112:127]
    ds_read_b128 v[48:51], v3 offset:8192
    v_add_u32 v14, 131072, v17
    v_add_u32 v15, 131072, v18
    s_waitcnt lgkmcnt(4)
    v_mfma_f32_32x32x16_bf16 v[112:127], v[36:39], v[148:151], v[112:127]
    ds_read_b128 v[52:55], v3 offset:9216
    v_mul_f32 v8, 0x3eb8aa3b, v8
    v_mov_b32 v16, 0xff800000
    s_waitcnt lgkmcnt(3)
    v_mfma_f32_32x32x16_bf16 v[112:127], v[40:43], v[152:155], v[112:127]
    ds_read_b128 v[56:59], v3 offset:10240
    v_lshrrev_b32 v29, 5, v0
    v_mad_i32_i24 v29, v29, -16, v6
    v_mov_b32 v30, 0
    v_cmp_le_i32 vcc, 0, v29
    s_waitcnt lgkmcnt(3)
    v_mfma_f32_32x32x16_bf16 v[112:127], v[44:47], v[156:159], v[112:127]
    ds_read_b128 v[60:63], v3 offset:11264
    v_cndmask_b32 v80, v16, v30, vcc
    v_cndmask_b32 v96, 0, v16, vcc
    v_cmp_le_i32 vcc, 4, v29
    s_waitcnt lgkmcnt(3)
    v_mfma_f32_32x32x16_bf16 v[112:127], v[48:51], v[160:163], v[112:127]
    ds_read_b128 v[32:35], v3 offset:12288
    v_cndmask_b32 v81, v16, v30, vcc
    v_cndmask_b32 v97, 0, v16, vcc
    v_cmp_le_i32 vcc, 8, v29
    s_waitcnt lgkmcnt(3)
    v_mfma_f32_32x32x16_bf16 v[112:127], v[52:55], v[164:167], v[112:127]
    ds_read_b128 v[36:39], v3 offset:13312
    v_cndmask_b32 v82, v16, v30, vcc
    v_cndmask_b32 v98, 0, v16, vcc
    v_cmp_le_i32 vcc, 12, v29
    s_waitcnt lgkmcnt(3)
    v_mfma_f32_32x32x16_bf16 v[112:127], v[56:59], v[168:171], v[112:127]
    ds_read_b128 v[40:43], v3 offset:14336
    v_cndmask_b32 v83, v16, v30, vcc
    v_cndmask_b32 v99, 0, v16, vcc
    v_cmp_le_i32 vcc, 32, v29
    s_waitcnt lgkmcnt(3)
    v_mfma_f32_32x32x16_bf16 v[112:127], v[60:63], v[172:175], v[112:127]
    ds_read_b128 v[44:47], v3 offset:15360
    v_cndmask_b32 v84, v16, v30, vcc
    v_cndmask_b32 v100, 0, v16, vcc
    v_cmp_le_i32 vcc, 36, v29
    s_waitcnt lgkmcnt(3)
    v_mfma_f32_32x32x16_bf16 v[112:127], v[32:35], v[176:179], v[112:127]
    ds_read_b128 v[48:51], v3 offset:16384
    v_cndmask_b32 v85, v16, v30, vcc
    v_cndmask_b32 v101, 0, v16, vcc
    v_cmp_le_i32 vcc, 40, v29
    s_barrier
    s_waitcnt lgkmcnt(3)
    v_mfma_f32_32x32x16_bf16 v[112:127], v[36:39], v[180:183], v[112:127]
    ds_read_b128 v[52:55], v3 offset:17408
    v_cndmask_b32 v86, v16, v30, vcc
    v_cndmask_b32 v102, 0, v16, vcc
    v_cmp_le_i32 vcc, 44, v29
    s_waitcnt lgkmcnt(3)
    v_mfma_f32_32x32x16_bf16 v[112:127], v[40:43], v[184:187], v[112:127]
    ds_read_b128 v[56:59], v3 offset:18432
    v_cndmask_b32 v87, v16, v30, vcc
    v_cndmask_b32 v103, 0, v16, vcc
    v_cmp_le_i32 vcc, 64, v29
    s_or_b32 s91, s67, s66
    s_cbranch_scc1 L_ep_121
    v_mov_b32 v31, s68
    buffer_store_dword v31, v6, s[24:27], 0 offen offset:0 sc1
L_pad8:
    s_cbranch_execz L_wback
L_ep_121:
    s_waitcnt lgkmcnt(3)
    v_mfma_f32_32x32x16_bf16 v[112:127], v[44:47], v[188:191], v[112:127]
    ds_read_b128 v[60:63], v3 offset:19456
    v_cndmask_b32 v88, v16, v30, vcc
    v_cndmask_b32 v104, 0, v16, vcc
    v_cmp_le_i32 vcc, 68, v29
    s_waitcnt lgkmcnt(3)
    v_mfma_f32_32x32x16_bf16 v[112:127], v[48:51], v[192:195], v[112:127]
    ds_read_b128 v[32:35], v3 offset:20480
    v_cndmask_b32 v89, v16, v30, vcc
    v_cndmask_b32 v105, 0, v16, vcc
    v_cmp_le_i32 vcc, 72, v29
    s_waitcnt lgkmcnt(3)
    v_mfma_f32_32x32x16_bf16 v[112:127], v[52:55], v[196:199], v[112:127]
    ds_read_b128 v[36:39], v3 offset:21504
    v_cndmask_b32 v90, v16, v30, vcc
    v_cndmask_b32 v106, 0, v16, vcc
    v_cmp_le_i32 vcc, 76, v29
    ds_read_b128 v[128:131], v14 offset:0
    s_waitcnt lgkmcnt(4)
    v_mfma_f32_32x32x16_bf16 v[112:127], v[56:59], v[200:203], v[112:127]
    ds_read_b128 v[40:43], v3 offset:22528
    v_cndmask_b32 v91, v16, v30, vcc
    v_cndmask_b32 v107, 0, v16, vcc
    v_cmp_le_i32 vcc, 96, v29
    ds_read_b128 v[132:135], v15 offset:2048
    s_waitcnt vmcnt(0)
    buffer_store_dword v28, v6, s[32:35], s49 offen sc1
    s_waitcnt lgkmcnt(5)
    v_mfma_f32_32x32x16_bf16 v[112:127], v[60:63], v[204:207], v[112:127]
    ds_read_b128 v[44:47], v3 offset:23552
    v_cndmask_b32 v92, v16, v30, vcc
    v_cndmask_b32 v108, 0, v16, vcc
    v_cmp_le_i32 vcc, 100, v29
    ds_read_b128 v[136:139], v15 offset:3200
    s_waitcnt lgkmcnt(6)
    v_mfma_f32_32x32x16_bf16 v[112:127], v[32:35], v[208:211], v[112:127]
    ds_read_b128 v[48:51], v3 offset:24576
    v_cndmask_b32 v93, v16, v30, vcc
    v_cndmask_b32 v109, 0, v16, vcc
    v_cmp_le_i32 vcc, 104, v29
    ds_read_b128 v[140:143], v14 offset:4352
    s_waitcnt lgkmcnt(7)
    v_mfma_f32_32x32x16_bf16 v[112:127], v[36:39], v[212:215], v[112:127]
    ds_read_b128 v[52:55], v3 offset:25600
    v_cndmask_b32 v94, v16, v30, vcc
    v_cndmask_b32 v110, 0, v16, vcc
    v_cmp_le_i32 vcc, 108, v29
    ds_read_b128 v[144:147], v15 offset:6400
    s_waitcnt lgkmcnt(7)
    v_mfma_f32_32x32x16_bf16 v[112:127], v[40:43], v[216:219], v[112:127]
    ds_read_b128 v[56:59], v3 offset:26624
    v_cndmask_b32 v95, v16, v30, vcc
    v_cndmask_b32 v111, 0, v16, vcc
    ds_read_b128 v[148:151], v15 offset:7552
    s_waitcnt lgkmcnt(7)
    v_mfma_f32_32x32x16_bf16 v[112:127], v[44:47], v[220:223], v[112:127]
    ds_read_b128 v[60:63], v3 offset:27648
    ds_read_b128 v[152:155], v14 offset:8704
    s_waitcnt lgkmcnt(7)
    v_mfma_f32_32x32x16_bf16 v[112:127], v[48:51], v[224:227], v[112:127]
    ds_read_b128 v[32:35], v3 offset:28672
    ds_read_b128 v[156:159], v15 offset:10752
    s_waitcnt lgkmcnt(7)
    v_mfma_f32_32x32x16_bf16 v[112:127], v[52:55], v[228:231], v[112:127]
    ds_read_b128 v[36:39], v3 offset:29696
    ds_read_b128 v[160:163], v15 offset:11904
    s_waitcnt lgkmcnt(7)
    v_mfma_f32_32x32x16_bf16 v[112:127], v[56:59], v[232:235], v[112:127]
    ds_read_b128 v[40:43], v3 offset:30720
    ds_read_b128 v[164:167], v14 offset:13056
    s_waitcnt lgkmcnt(7)
    v_mfma_f32_32x32x16_bf16 v[112:127], v[60:63], v[236:239], v[112:127]
    ds_read_b128 v[44:47], v3 offset:31744
    ds_read_b128 v[168:171], v15 offset:15104
    s_waitcnt lgkmcnt(7)
    v_mfma_f32_32x32x16_bf16 v[112:127], v[32:35], v[240:243], v[112:127]
    ds_read_b128 v[48:51], v11 offset:30720
    ds_read_b128 v[172:175], v15 offset:16256
    s_waitcnt lgkmcnt(7)
    v_mfma_f32_32x32x16_bf16 v[112:127], v[36:39], v[244:247], v[112:127]
    s_waitcnt lgkmcnt(5)
    v_mfma_f32_32x32x16_bf16 v[112:127], v[40:43], v[248:251], v[112:127]
    v_add_u32 v16, s51, v17
    v_add_u32 v12, s51, v18
    s_waitcnt lgkmcnt(3)
    v_mfma_f32_32x32x16_bf16 v[112:127], v[44:47], v[252:255], v[112:127]
    s_waitcnt lgkmcnt(1)
    v_mfma_f32_32x32x16_bf16 v[112:127], v[48:51], v[20:23], v[112:127]
    s_cmp_eq_u32 s64, 1
    s_cbranch_scc1 L_att1_123
    s_cmp_eq_u32 s64, 2
    s_cbranch_scc1 L_att2_124
    s_cmp_eq_u32 s64, 0
    s_cbranch_scc1 L_att0_122
L_att3_125:
    s_nop 5
    v_pk_mul_f32 v[112:113], v[112:113], v[8:9] op_sel_hi:[1,0]
    v_pk_mul_f32 v[114:115], v[114:115], v[8:9] op_sel_hi:[1,0]
    v_pk_mul_f32 v[116:117], v[116:117], v[8:9] op_sel_hi:[1,0]
    v_pk_mul_f32 v[118:119], v[118:119], v[8:9] op_sel_hi:[1,0]
    v_cvt_pk_bf16_f32 v24, v112, v113
    v_cvt_pk_bf16_f32 v25, v114, v115
    v_cvt_pk_bf16_f32 v26, v116, v117
    v_cvt_pk_bf16_f32 v27, v118, v119
    ds_write_b128 v11, v[24:27] offset:20480
    v_pk_mul_f32 v[120:121], v[120:121], v[8:9] op_sel_hi:[1,0]
    v_pk_mul_f32 v[122:123], v[122:123], v[8:9] op_sel_hi:[1,0]
    v_pk_mul_f32 v[124:125], v[124:125], v[8:9] op_sel_hi:[1,0]
    v_pk_mul_f32 v[126:127], v[126:127], v[8:9] op_sel_hi:[1,0]
    v_cvt_pk_bf16_f32 v28, v120, v121
    v_cvt_pk_bf16_f32 v29, v122, v123
    v_cvt_pk_bf16_f32 v30, v124, v125
    v_cvt_pk_bf16_f32 v31, v126, v127
    s_waitcnt lgkmcnt(0)
    s_nop 0
    v_mfma_f32_32x32x16_bf16 v[224:239], v[128:131], v[28:31], 0
    s_barrier
    ds_read_b128 v[24:27], v11 offset:17408
    s_mov_b64 exec, 0xff
    buffer_load_dword v13, v9, s[32:35], s50 offen sc1
    s_mov_b64 exec, -1
    s_nop 6
    v_exp_f32 v224, v224
    v_exp_f32 v225, v225
    v_exp_f32 v226, v226
    v_cvt_pk_bf16_f32 v112, v224, v225
    v_exp_f32 v227, v227
    v_exp_f32 v228, v228
    v_cvt_pk_bf16_f32 v113, v226, v227
    v_exp_f32 v229, v229
    v_exp_f32 v230, v230
    v_cvt_pk_bf16_f32 v114, v228, v229
    v_exp_f32 v231, v231
    s_waitcnt lgkmcnt(0)
    v_mfma_f32_32x32x16_bf16 v[240:255], v[128:131], v[24:27], v[80:95]
    v_exp_f32 v232, v232
    v_cvt_pk_bf16_f32 v115, v230, v231
    v_exp_f32 v233, v233
    v_exp_f32 v234, v234
    v_cvt_pk_bf16_f32 v116, v232, v233
    v_exp_f32 v235, v235
    v_mfma_f32_32x32x16_bf16 v[48:63], v[132:135], v[112:115], 0
    v_exp_f32 v236, v236
    v_cvt_pk_bf16_f32 v117, v234, v235
    v_exp_f32 v237, v237
    v_exp_f32 v238, v238
    v_cvt_pk_bf16_f32 v118, v236, v237
    v_exp_f32 v239, v239
    v_exp_f32 v240, v240
    v_cvt_pk_bf16_f32 v119, v238, v239
    v_exp_f32 v241, v241
    v_exp_f32 v242, v242
    v_cvt_pk_bf16_f32 v112, v240, v241
    v_mfma_f32_32x32x16_bf16 v[48:63], v[136:139], v[116:119], v[48:63]
    v_exp_f32 v243, v243
    v_exp_f32 v244, v244
    v_cvt_pk_bf16_f32 v113, v242, v243
    v_exp_f32 v245, v245
    v_mfma_f32_32x32x16_bf16 v[224:239], v[140:143], v[28:31], 0
    v_exp_f32 v246, v246
    v_cvt_pk_bf16_f32 v114, v244, v245
    v_exp_f32 v247, v247
    v_exp_f32 v248, v248
    v_cvt_pk_bf16_f32 v115, v246, v247
    v_exp_f32 v249, v249
    v_exp_f32 v250, v250
    v_cvt_pk_bf16_f32 v116, v248, v249
    v_exp_f32 v251, v251
    v_mfma_f32_32x32x16_bf16 v[32:47], v[132:135], v[112:115], 0
    v_exp_f32 v252, v252
    v_cvt_pk_bf16_f32 v117, v250, v251
    v_exp_f32 v253, v253
    v_exp_f32 v254, v254
    v_cvt_pk_bf16_f32 v118, v252, v253
    v_exp_f32 v255, v255
    s_waitcnt vmcnt(0)
L_ro_128:
    v_cmp_ne_u32 vcc, s68, v13
    s_nop 0
    s_and_b64 vcc, vcc, s[52:53]
    s_cbranch_vccz L_rb_129
    s_mov_b64 exec, 0xff
    buffer_load_dword v13, v9, s[32:35], s50 offen sc1
    s_mov_b64 exec, -1
    s_add_u32 s98, s98, 1
    s_cmp_lt_u32 s98, 400000
    s_waitcnt vmcnt(0)
    s_cbranch_scc1 L_ro_128
L_rb_129:
    v_exp_f32 v224, v224
    v_cvt_pk_bf16_f32 v119, v254, v255
    v_exp_f32 v225, v225
    v_exp_f32 v226, v226
    v_cvt_pk_bf16_f32 v112, v224, v225
    v_mfma_f32_32x32x16_bf16 v[32:47], v[136:139], v[116:119], v[32:47]
    s_branch L_attb_127
L_att0_122:
    s_nop 5
    v_pk_mul_f32 v[120:121], v[120:121], v[8:9] op_sel_hi:[1,0]
    v_pk_mul_f32 v[122:123], v[122:123], v[8:9] op_sel_hi:[1,0]
    v_pk_mul_f32 v[124:125], v[124:125], v[8:9] op_sel_hi:[1,0]
    v_pk_mul_f32 v[126:127], v[126:127], v[8:9] op_sel_hi:[1,0]
    v_cvt_pk_bf16_f32 v28, v120, v121
    v_cvt_pk_bf16_f32 v29, v122, v123
    v_cvt_pk_bf16_f32 v30, v124, v125
    v_cvt_pk_bf16_f32 v31, v126, v127
    ds_write_b128 v11, v[28:31] offset:17408
    v_pk_mul_f32 v[112:113], v[112:113], v[8:9] op_sel_hi:[1,0]
    v_pk_mul_f32 v[114:115], v[114:115], v[8:9] op_sel_hi:[1,0]
    v_pk_mul_f32 v[116:117], v[116:117], v[8:9] op_sel_hi:[1,0]
    v_pk_mul_f32 v[118:119], v[118:119], v[8:9] op_sel_hi:[1,0]
    v_cvt_pk_bf16_f32 v24, v112, v113
    v_cvt_pk_bf16_f32 v25, v114, v115
    v_cvt_pk_bf16_f32 v26, v116, v117
    v_cvt_pk_bf16_f32 v27, v118, v119
    s_waitcnt lgkmcnt(0)
    s_nop 0
    v_mfma_f32_32x32x16_bf16 v[224:239], v[128:131], v[24:27], v[80:95]
    s_barrier
    ds_read_b128 v[28:31], v11 offset:20480
    s_mov_b64 exec, 0xff
    buffer_load_dword v13, v9, s[32:35], s50 offen sc1
    s_mov_b64 exec, -1
    s_nop 6
    v_exp_f32 v224, v224
    v_exp_f32 v225, v225
    v_exp_f32 v226, v226
    v_cvt_pk_bf16_f32 v112, v224, v225
    v_exp_f32 v227, v227
    v_exp_f32 v228, v228
    v_cvt_pk_bf16_f32 v113, v226, v227
    v_exp_f32 v229, v229
    v_exp_f32 v230, v230
    v_cvt_pk_bf16_f32 v114, v228, v229
    v_exp_f32 v231, v231
    s_waitcnt lgkmcnt(0)
    v_mfma_f32_32x32x16_bf16 v[240:255], v[128:131], v[28:31], 0
    v_exp_f32 v232, v232
    v_cvt_pk_bf16_f32 v115, v230, v231
    v_exp_f32 v233, v233
    v_exp_f32 v234, v234
    v_cvt_pk_bf16_f32 v116, v232, v233
    v_exp_f32 v235, v235
    v_mfma_f32_32x32x16_bf16 v[32:47], v[132:135], v[112:115], 0
    v_exp_f32 v236, v236
    v_cvt_pk_bf16_f32 v117, v234, v235
    v_exp_f32 v237, v237
    v_exp_f32 v238, v238
    v_cvt_pk_bf16_f32 v118, v236, v237
    v_exp_f32 v239, v239
    v_exp_f32 v240, v240
    v_cvt_pk_bf16_f32 v119, v238, v239
    v_exp_f32 v241, v241
    v_exp_f32 v242, v242
    v_cvt_pk_bf16_f32 v112, v240, v241
    v_mfma_f32_32x32x16_bf16 v[32:47], v[136:139], v[116:119], v[32:47]
    v_exp_f32 v243, v243
    v_exp_f32 v244, v244
    v_cvt_pk_bf16_f32 v113, v242, v243
    v_exp_f32 v245, v245
    v_mfma_f32_32x32x16_bf16 v[224:239], v[140:143], v[28:31], 0
    v_exp_f32 v246, v246
    v_cvt_pk_bf16_f32 v114, v244, v245
    v_exp_f32 v247, v247
    v_exp_f32 v248, v248
    v_cvt_pk_bf16_f32 v115, v246, v247
    v_exp_f32 v249, v249
    v_exp_f32 v250, v250
    v_cvt_pk_bf16_f32 v116, v248, v249
    v_exp_f32 v251, v251
    v_mfma_f32_32x32x16_bf16 v[48:63], v[132:135], v[112:115], 0
    v_exp_f32 v252, v252
    v_cvt_pk_bf16_f32 v117, v250, v251
    v_exp_f32 v253, v253
    v_exp_f32 v254, v254
    v_cvt_pk_bf16_f32 v118, v252, v253
    v_exp_f32 v255, v255
    s_waitcnt vmcnt(0)
L_ro_130:
    v_cmp_ne_u32 vcc, s68, v13
    s_nop 0
    s_and_b64 vcc, vcc, s[52:53]
    s_cbranch_vccz L_rb_131
    s_mov_b64 exec, 0xff
    buffer_load_dword v13, v9, s[32:35], s50 offen sc1
    s_mov_b64 exec, -1
    s_add_u32 s98, s98, 1
    s_cmp_lt_u32 s98, 400000
    s_waitcnt vmcnt(0)
    s_cbranch_scc1 L_ro_130
L_rb_131:
    v_exp_f32 v224, v224
    v_cvt_pk_bf16_f32 v119, v254, v255
    v_exp_f32 v225, v225
    v_exp_f32 v226, v226
    v_cvt_pk_bf16_f32 v112, v224, v225
    v_mfma_f32_32x32x16_bf16 v[48:63], v[136:139], v[116:119], v[48:63]
L_attb_127:
    v_exp_f32 v227, v227
    buffer_load_dwordx4 v[176:179], v16, s[32:35], s12 offen sc1
    v_exp_f32 v228, v228
    v_cvt_pk_bf16_f32 v113, v226, v227
    v_exp_f32 v229, v229
    v_mfma_f32_32x32x16_bf16 v[240:255], v[152:155], v[28:31], 0
    v_exp_f32 v230, v230
    v_cvt_pk_bf16_f32 v114, v228, v229
    v_exp_f32 v231, v231
    v_exp_f32 v232, v232
    v_cvt_pk_bf16_f32 v115, v230, v231
    buffer_load_dwordx4 v[180:183], v12, s[32:35], s12 offen offset:2048 sc1
    v_exp_f32 v233, v233
    v_exp_f32 v234, v234
    v_cvt_pk_bf16_f32 v116, v232, v233
    v_exp_f32 v235, v235
    v_mfma_f32_32x32x16_bf16 v[48:63], v[144:147], v[112:115], v[48:63]
    v_exp_f32 v236, v236
    v_cvt_pk_bf16_f32 v117, v234, v235
    v_exp_f32 v237, v237
    buffer_load_dwordx4 v[184:187], v12, s[32:35], s12 offen offset:3200 sc1
    v_exp_f32 v238, v238
    v_cvt_pk_bf16_f32 v118, v236, v237
    v_exp_f32 v239, v239
    v_exp_f32 v240, v240
    v_cvt_pk_bf16_f32 v119, v238, v239
    v_exp_f32 v241, v241
    v_exp_f32 v242, v242
    v_cvt_pk_bf16_f32 v112, v240, v241
    v_mfma_f32_32x32x16_bf16 v[48:63], v[148:151], v[116:119], v[48:63]
    v_exp_f32 v243, v243
    buffer_load_dwordx4 v[188:191], v16, s[32:35], s13 offen sc1
    v_exp_f32 v244, v244
    v_cvt_pk_bf16_f32 v113, v242, v243
    v_exp_f32 v245, v245
    v_mfma_f32_32x32x16_bf16 v[224:239], v[164:167], v[28:31], v[80:95]
    v_exp_f32 v246, v246
    v_cvt_pk_bf16_f32 v114, v244, v245
    v_exp_f32 v247, v247
    v_exp_f32 v248, v248
    v_cvt_pk_bf16_f32 v115, v246, v247
    buffer_load_dwordx4 v[192:195], v12, s[32:35], s13 offen offset:2048 sc1
    v_exp_f32 v249, v249
    v_exp_f32 v250, v250
    v_cvt_pk_bf16_f32 v116, v248, v249
    v_exp_f32 v251, v251
    v_mfma_f32_32x32x16_bf16 v[48:63], v[156:159], v[112:115], v[48:63]
    v_exp_f32 v252, v252
    v_cvt_pk_bf16_f32 v117, v250, v251
    v_exp_f32 v253, v253
    buffer_load_dwordx4 v[196:199], v12, s[32:35], s13 offen offset:3200 sc1
    v_exp_f32 v254, v254
    v_cvt_pk_bf16_f32 v118, v252, v253
    v_exp_f32 v255, v255
    s_add_u32 s69, s68, 11
    v_mov_b32 v13, s69
    v_exp_f32 v224, v224
    v_cvt_pk_bf16_f32 v119, v254, v255
    v_exp_f32 v225, v225
    v_exp_f32 v226, v226
    v_cvt_pk_bf16_f32 v112, v224, v225
    v_mfma_f32_32x32x16_bf16 v[48:63], v[160:163], v[116:119], v[48:63]
    v_exp_f32 v227, v227
    buffer_load_dwordx4 v[200:203], v16, s[32:35], s14 offen sc1
    v_exp_f32 v228, v228
    v_cvt_pk_bf16_f32 v113, v226, v227
    v_exp_f32 v229, v229
    s_waitcnt vmcnt(6)
    v_mfma_f32_32x32x16_bf16 v[240:255], v[176:179], v[24:27], 0
    v_exp_f32 v230, v230
    v_cvt_pk_bf16_f32 v114, v228, v229
    v_exp_f32 v231, v231
    v_exp_f32 v232, v232
    v_cvt_pk_bf16_f32 v115, v230, v231
    buffer_load_dwordx4 v[204:207], v12, s[32:35], s14 offen offset:2048 sc1
    v_exp_f32 v233, v233
    v_exp_f32 v234, v234
    v_cvt_pk_bf16_f32 v116, v232, v233
    v_exp_f32 v235, v235
    v_mfma_f32_32x32x16_bf16 v[48:63], v[168:171], v[112:115], v[48:63]
    v_exp_f32 v236, v236
    v_cvt_pk_bf16_f32 v117, v234, v235
    v_exp_f32 v237, v237
    buffer_load_dwordx4 v[208:211], v12, s[32:35], s14 offen offset:3200 sc1
    v_exp_f32 v238, v238
    v_cvt_pk_bf16_f32 v118, v236, v237
    v_exp_f32 v239, v239
    v_exp_f32 v240, v240
    v_cvt_pk_bf16_f32 v119, v238, v239
    v_exp_f32 v241, v241
    v_exp_f32 v242, v242
    v_cvt_pk_bf16_f32 v112, v240, v241
    v_mfma_f32_32x32x16_bf16 v[48:63], v[172:175], v[116:119], v[48:63]
    v_exp_f32 v243, v243
    buffer_load_dwordx4 v[212:215], v16, s[32:35], s15 offen sc1
    v_exp_f32 v244, v244
    v_cvt_pk_bf16_f32 v113, v242, v243
    v_exp_f32 v245, v245
    v_mfma_f32_32x32x16_bf16 v[224:239], v[176:179], v[28:31], 0
    v_exp_f32 v246, v246
    v_cvt_pk_bf16_f32 v114, v244, v245
    v_exp_f32 v247, v247
    v_exp_f32 v248, v248
    v_cvt_pk_bf16_f32 v115, v246, v247
    buffer_load_dwordx4 v[216:219], v12, s[32:35], s15 offen offset:2048 sc1
    v_exp_f32 v249, v249
    v_exp_f32 v250, v250
    v_cvt_pk_bf16_f32 v116, v248, v249
    v_exp_f32 v251, v251
    s_waitcnt vmcnt(8)
    v_mfma_f32_32x32x16_bf16 v[32:47], v[180:183], v[112:115], v[32:47]
    v_exp_f32 v252, v252
    v_cvt_pk_bf16_f32 v117, v250, v251
    v_exp_f32 v253, v253
    buffer_load_dwordx4 v[220:223], v12, s[32:35], s15 offen offset:3200 sc1
    v_exp_f32 v254, v254
    v_cvt_pk_bf16_f32 v118, v252, v253
    v_exp_f32 v255, v255
    v_exp_f32 v224, v224
    v_cvt_pk_bf16_f32 v119, v254, v255
    v_exp_f32 v225, v225
    v_exp_f32 v226, v226
    v_cvt_pk_bf16_f32 v112, v224, v225
    v_mfma_f32_32x32x16_bf16 v[32:47], v[184:187], v[116:119], v[32:47]
    v_exp_f32 v227, v227
    v_add_u32 v16, s54, v17
    v_add_u32 v12, s54, v18
    buffer_load_dwordx4 v[128:131], v16, s[32:35], s16 offen sc1
    v_exp_f32 v228, v228
    v_cvt_pk_bf16_f32 v113, v226, v227
    v_exp_f32 v229, v229
    s_waitcnt vmcnt(9)
    v_mfma_f32_32x32x16_bf16 v[240:255], v[188:191], v[24:27], 0
    v_exp_f32 v230, v230
    v_cvt_pk_bf16_f32 v114, v228, v229
    v_exp_f32 v231, v231
    v_exp_f32 v232, v232
    v_cvt_pk_bf16_f32 v115, v230, v231
    buffer_load_dwordx4 v[132:135], v12, s[32:35], s16 offen offset:2048 sc1
    v_exp_f32 v233, v233
    v_exp_f32 v234, v234
    v_cvt_pk_bf16_f32 v116, v232, v233
    v_exp_f32 v235, v235
    v_mfma_f32_32x32x16_bf16 v[48:63], v[180:183], v[112:115], v[48:63]
    v_exp_f32 v236, v236
    v_cvt_pk_bf16_f32 v117, v234, v235
    v_exp_f32 v237, v237
    buffer_load_dwordx4 v[136:139], v12, s[32:35], s16 offen offset:3200 sc1
    v_exp_f32 v238, v238
    v_cvt_pk_bf16_f32 v118, v236, v237
    v_exp_f32 v239, v239
    v_exp_f32 v240, v240
    v_cvt_pk_bf16_f32 v119, v238, v239
    v_exp_f32 v241, v241
    v_exp_f32 v242, v242
    v_cvt_pk_bf16_f32 v112, v240, v241
    v_mfma_f32_32x32x16_bf16 v[48:63], v[184:187], v[116:119], v[48:63]
    v_exp_f32 v243, v243
    buffer_load_dwordx4 v[140:143], v16, s[32:35], s17 offen sc1
    v_exp_f32 v244, v244
    v_cvt_pk_bf16_f32 v113, v242, v243
    v_exp_f32 v245, v245
    v_mfma_f32_32x32x16_bf16 v[224:239], v[188:191], v[28:31], 0
    v_exp_f32 v246, v246
    v_cvt_pk_bf16_f32 v114, v244, v245
    v_exp_f32 v247, v247
    v_exp_f32 v248, v248
    v_cvt_pk_bf16_f32 v115, v246, v247
    buffer_load_dwordx4 v[144:147], v12, s[32:35], s17 offen offset:2048 sc1
    v_exp_f32 v249, v249
    v_exp_f32 v250, v250
    v_cvt_pk_bf16_f32 v116, v248, v249
    v_exp_f32 v251, v251
    s_waitcnt vmcnt(11)
    v_mfma_f32_32x32x16_bf16 v[32:47], v[192:195], v[112:115], v[32:47]
    v_exp_f32 v252, v252
    v_cvt_pk_bf16_f32 v117, v250, v251
    v_exp_f32 v253, v253
    buffer_load_dwordx4 v[148:151], v12, s[32:35], s17 offen offset:3200 sc1
    v_exp_f32 v254, v254
    v_cvt_pk_bf16_f32 v118, v252, v253
    v_exp_f32 v255, v255
    v_exp_f32 v224, v224
    v_cvt_pk_bf16_f32 v119, v254, v255
    v_exp_f32 v225, v225
    v_exp_f32 v226, v226
    v_cvt_pk_bf16_f32 v112, v224, v225
    v_mfma_f32_32x32x16_bf16 v[32:47], v[196:199], v[116:119], v[32:47]
    v_exp_f32 v227, v227
    buffer_load_dwordx4 v[152:155], v16, s[32:35], s18 offen sc1
    v_exp_f32 v228, v228
    v_cvt_pk_bf16_f32 v113, v226, v227
    v_exp_f32 v229, v229
    s_waitcnt vmcnt(12)
    v_mfma_f32_32x32x16_bf16 v[240:255], v[200:203], v[24:27], 0
    v_exp_f32 v230, v230
    v_cvt_pk_bf16_f32 v114, v228, v229
    v_exp_f32 v231, v231
    v_exp_f32 v232, v232
    v_cvt_pk_bf16_f32 v115, v230, v231
    buffer_load_dwordx4 v[156:159], v12, s[32:35], s18 offen offset:2048 sc1
    v_exp_f32 v233, v233
    v_exp_f32 v234, v234
    v_cvt_pk_bf16_f32 v116, v232, v233
    v_exp_f32 v235, v235
    v_mfma_f32_32x32x16_bf16 v[48:63], v[192:195], v[112:115], v[48:63]
    v_exp_f32 v236, v236
    v_cvt_pk_bf16_f32 v117, v234, v235
    v_exp_f32 v237, v237
    buffer_load_dwordx4 v[160:163], v12, s[32:35], s18 offen offset:3200 sc1
    v_exp_f32 v238, v238
    v_cvt_pk_bf16_f32 v118, v236, v237
    v_exp_f32 v239, v239
    v_exp_f32 v240, v240
    v_cvt_pk_bf16_f32 v119, v238, v239
    v_exp_f32 v241, v241
    v_exp_f32 v242, v242
    v_cvt_pk_bf16_f32 v112, v240, v241
    v_mfma_f32_32x32x16_bf16 v[48:63], v[196:199], v[116:119], v[48:63]
    v_exp_f32 v243, v243
    buffer_load_dwordx4 v[164:167], v16, s[32:35], s19 offen sc1
    v_exp_f32 v244, v244
    v_cvt_pk_bf16_f32 v113, v242, v243
    v_exp_f32 v245, v245
    v_mfma_f32_32x32x16_bf16 v[224:239], v[200:203], v[28:31], 0
    v_exp_f32 v246, v246
    v_cvt_pk_bf16_f32 v114, v244, v245
    v_exp_f32 v247, v247
    v_exp_f32 v248, v248
    v_cvt_pk_bf16_f32 v115, v246, v247
    buffer_load_dwordx4 v[168:171], v12, s[32:35], s19 offen offset:2048 sc1
    v_exp_f32 v249, v249
    v_exp_f32 v250, v250
    v_cvt_pk_bf16_f32 v116, v248, v249
    v_exp_f32 v251, v251
    s_waitcnt vmcnt(14)
    v_mfma_f32_32x32x16_bf16 v[32:47], v[204:207], v[112:115], v[32:47]
    v_exp_f32 v252, v252
    v_cvt_pk_bf16_f32 v117, v250, v251
    v_exp_f32 v253, v253
    buffer_load_dwordx4 v[172:175], v12, s[32:35], s19 offen offset:3200 sc1
    v_exp_f32 v254, v254
    v_cvt_pk_bf16_f32 v118, v252, v253
    v_exp_f32 v255, v255
    v_exp_f32 v224, v224
    v_cvt_pk_bf16_f32 v119, v254, v255
    v_exp_f32 v225, v225
    v_exp_f32 v226, v226
    v_cvt_pk_bf16_f32 v112, v224, v225
    v_mfma_f32_32x32x16_bf16 v[32:47], v[208:211], v[116:119], v[32:47]
    v_exp_f32 v227, v227
    v_exp_f32 v228, v228
    v_cvt_pk_bf16_f32 v113, v226, v227
    v_exp_f32 v229, v229
    s_waitcnt vmcnt(14)
    v_mfma_f32_32x32x16_bf16 v[240:255], v[212:215], v[24:27], 0
    v_exp_f32 v230, v230
    v_cvt_pk_bf16_f32 v114, v228, v229
    v_exp_f32 v231, v231
    v_exp_f32 v232, v232
    v_cvt_pk_bf16_f32 v115, v230, v231
    v_exp_f32 v233, v233
    v_exp_f32 v234, v234
    v_cvt_pk_bf16_f32 v116, v232, v233
    v_exp_f32 v235, v235
    v_mfma_f32_32x32x16_bf16 v[48:63], v[204:207], v[112:115], v[48:63]
    v_exp_f32 v236, v236
    v_cvt_pk_bf16_f32 v117, v234, v235
    v_exp_f32 v237, v237
    v_exp_f32 v238, v238
    v_cvt_pk_bf16_f32 v118, v236, v237
    v_exp_f32 v239, v239
    v_exp_f32 v240, v240
    v_cvt_pk_bf16_f32 v119, v238, v239
    v_exp_f32 v241, v241
    v_exp_f32 v242, v242
    v_cvt_pk_bf16_f32 v112, v240, v241
    v_mfma_f32_32x32x16_bf16 v[48:63], v[208:211], v[116:119], v[48:63]
    v_exp_f32 v243, v243
    v_exp_f32 v244, v244
    v_cvt_pk_bf16_f32 v113, v242, v243
    v_exp_f32 v245, v245
    v_mfma_f32_32x32x16_bf16 v[224:239], v[212:215], v[28:31], 0
    v_exp_f32 v246, v246
    v_cvt_pk_bf16_f32 v114, v244, v245
    v_exp_f32 v247, v247
    v_exp_f32 v248, v248
    v_cvt_pk_bf16_f32 v115, v246, v247
    v_exp_f32 v249, v249
    v_exp_f32 v250, v250
    v_cvt_pk_bf16_f32 v116, v248, v249
    v_exp_f32 v251, v251
    s_waitcnt vmcnt(12)
    v_mfma_f32_32x32x16_bf16 v[32:47], v[216:219], v[112:115], v[32:47]
    v_exp_f32 v252, v252
    v_cvt_pk_bf16_f32 v117, v250, v251
    v_exp_f32 v253, v253
    v_exp_f32 v254, v254
    v_cvt_pk_bf16_f32 v118, v252, v253
    v_exp_f32 v255, v255
    v_exp_f32 v224, v224
    v_cvt_pk_bf16_f32 v119, v254, v255
    v_exp_f32 v225, v225
    v_exp_f32 v226, v226
    v_cvt_pk_bf16_f32 v112, v224, v225
    v_mfma_f32_32x32x16_bf16 v[32:47], v[220:223], v[116:119], v[32:47]
    v_exp_f32 v227, v227
    v_exp_f32 v228, v228
    v_cvt_pk_bf16_f32 v113, v226, v227
    v_exp_f32 v229, v229
    s_waitcnt vmcnt(11)
    v_mfma_f32_32x32x16_bf16 v[240:255], v[128:131], v[28:31], v[96:111]
    v_exp_f32 v230, v230
    v_cvt_pk_bf16_f32 v114, v228, v229
    v_exp_f32 v231, v231
    v_exp_f32 v232, v232
    v_cvt_pk_bf16_f32 v115, v230, v231
    v_exp_f32 v233, v233
    v_exp_f32 v234, v234
    v_cvt_pk_bf16_f32 v116, v232, v233
    v_exp_f32 v235, v235
    v_mfma_f32_32x32x16_bf16 v[48:63], v[216:219], v[112:115], v[48:63]
    v_exp_f32 v236, v236
    v_cvt_pk_bf16_f32 v117, v234, v235
    v_exp_f32 v237, v237
    v_exp_f32 v238, v238
    v_cvt_pk_bf16_f32 v118, v236, v237
    v_exp_f32 v239, v239
    v_exp_f32 v240, v240
    v_cvt_pk_bf16_f32 v119, v238, v239
    v_exp_f32 v241, v241
    v_exp_f32 v242, v242
    v_cvt_pk_bf16_f32 v112, v240, v241
    v_mfma_f32_32x32x16_bf16 v[48:63], v[220:223], v[116:119], v[48:63]
    v_exp_f32 v243, v243
    v_exp_f32 v244, v244
    v_cvt_pk_bf16_f32 v113, v242, v243
    v_exp_f32 v245, v245
    v_mfma_f32_32x32x16_bf16 v[224:239], v[128:131], v[24:27], 0
    v_exp_f32 v246, v246
    v_cvt_pk_bf16_f32 v114, v244, v245
    v_exp_f32 v247, v247
    v_exp_f32 v248, v248
    v_cvt_pk_bf16_f32 v115, v246, v247
    v_exp_f32 v249, v249
    v_exp_f32 v250, v250
    v_cvt_pk_bf16_f32 v116, v248, v249
    v_exp_f32 v251, v251
    s_waitcnt vmcnt(9)
    v_mfma_f32_32x32x16_bf16 v[48:63], v[132:135], v[112:115], v[48:63]
    v_exp_f32 v252, v252
    v_cvt_pk_bf16_f32 v117, v250, v251
    v_exp_f32 v253, v253
    v_exp_f32 v254, v254
    v_cvt_pk_bf16_f32 v118, v252, v253
    v_exp_f32 v255, v255
    v_exp_f32 v224, v224
    v_cvt_pk_bf16_f32 v119, v254, v255
    v_exp_f32 v225, v225
    v_exp_f32 v226, v226
    v_cvt_pk_bf16_f32 v112, v224, v225
    v_mfma_f32_32x32x16_bf16 v[48:63], v[136:139], v[116:119], v[48:63]
    v_exp_f32 v227, v227
    v_exp_f32 v228, v228
    v_cvt_pk_bf16_f32 v113, v226, v227
    v_exp_f32 v229, v229
    s_waitcnt vmcnt(8)
    v_mfma_f32_32x32x16_bf16 v[240:255], v[140:143], v[24:27], 0
    v_exp_f32 v230, v230
    v_cvt_pk_bf16_f32 v114, v228, v229
    v_exp_f32 v231, v231
    v_exp_f32 v232, v232
    v_cvt_pk_bf16_f32 v115, v230, v231
    v_exp_f32 v233, v233
    v_exp_f32 v234, v234
    v_cvt_pk_bf16_f32 v116, v232, v233
    v_exp_f32 v235, v235
    v_mfma_f32_32x32x16_bf16 v[32:47], v[132:135], v[112:115], v[32:47]
    v_exp_f32 v236, v236
    v_subrev_u32 v57, 0x1f800000, v56
    v_cmp_le_u32 vcc, 0x40000000, v57
    v_rcp_f32 v56, v56
    s_nop 0
    v_pk_mul_f32 v[48:49], v[48:49], v[56:57] op_sel_hi:[1,0]
    v_pk_mul_f32 v[50:51], v[50:51], v[56:57] op_sel_hi:[1,0]
    v_pk_mul_f32 v[52:53], v[52:53], v[56:57] op_sel_hi:[1,0]
    v_pk_mul_f32 v[54:55], v[54:55], v[56:57] op_sel_hi:[1,0]
    v_cvt_pk_bf16_f32 v124, v48, v49
    v_cvt_pk_bf16_f32 v125, v50, v51
    v_cvt_pk_bf16_f32 v126, v52, v53
    v_cvt_pk_bf16_f32 v127, v54, v55
    s_or_b32 s86, vcc_lo, vcc_hi
    s_cmp_lg_u32 s76, 0
    s_cbranch_scc1 L_slow_132
    buffer_store_dwordx4 v[124:127], v1, s[24:27], s9 offen
L_back_133:
    v_cvt_pk_bf16_f32 v117, v234, v235
    v_exp_f32 v237, v237
    v_exp_f32 v238, v238
    v_cvt_pk_bf16_f32 v118, v236, v237
    v_exp_f32 v239, v239
    v_exp_f32 v240, v240
    v_cvt_pk_bf16_f32 v119, v238, v239
    v_exp_f32 v241, v241
    v_exp_f32 v242, v242
    v_cvt_pk_bf16_f32 v112, v240, v241
    v_mfma_f32_32x32x16_bf16 v[32:47], v[136:139], v[116:119], v[32:47]
    v_exp_f32 v243, v243
L_pad9:
    s_cbranch_execz L_pad10
    v_exp_f32 v244, v244
    v_cvt_pk_bf16_f32 v113, v242, v243
    v_exp_f32 v245, v245
    s_waitcnt vmcnt(6)
    v_mfma_f32_32x32x16_bf16 v[224:239], v[152:155], v[24:27], 0
    v_exp_f32 v246, v246
    v_cvt_pk_bf16_f32 v114, v244, v245
    v_exp_f32 v247, v247
    v_exp_f32 v248, v248
    v_cvt_pk_bf16_f32 v115, v246, v247
    v_exp_f32 v249, v249
    v_exp_f32 v250, v250
    v_cvt_pk_bf16_f32 v116, v248, v249
    v_exp_f32 v251, v251
    v_mfma_f32_32x32x16_bf16 v[32:47], v[144:147], v[112:115], v[32:47]
    v_exp_f32 v252, v252
    v_cvt_pk_bf16_f32 v117, v250, v251
    v_exp_f32 v253, v253
    v_exp_f32 v254, v254
    v_cvt_pk_bf16_f32 v118, v252, v253
    v_exp_f32 v255, v255
    v_exp_f32 v224, v224
    v_cvt_pk_bf16_f32 v119, v254, v255
    v_exp_f32 v225, v225
    v_exp_f32 v226, v226
    v_cvt_pk_bf16_f32 v112, v224, v225
    v_mfma_f32_32x32x16_bf16 v[32:47], v[148:151], v[116:119], v[32:47]
    v_exp_f32 v227, v227
    v_exp_f32 v228, v228
    v_cvt_pk_bf16_f32 v113, v226, v227
    v_exp_f32 v229, v229
    s_waitcnt vmcnt(3)
    v_mfma_f32_32x32x16_bf16 v[240:255], v[164:167], v[24:27], v[96:111]
    v_exp_f32 v230, v230
    v_cvt_pk_bf16_f32 v114, v228, v229
    v_exp_f32 v231, v231
    v_exp_f32 v232, v232
    v_cvt_pk_bf16_f32 v115, v230, v231
    v_exp_f32 v233, v233
    s_cmp_lg_u32 s86, 0
    s_cbranch_scc1 L_nof_134
    s_mov_b64 exec, 1
    s_cmp_lg_u32 s76, 0
    s_cbranch_scc1 L_slow_135
    s_waitcnt vmcnt(0)
    buffer_store_dword v13, v6, s[24:27], s11 offen
L_back_136:
    s_mov_b64 exec, -1
L_nof_134:
    v_exp_f32 v234, v234
    v_cvt_pk_bf16_f32 v116, v232, v233
    v_exp_f32 v235, v235
    v_mfma_f32_32x32x16_bf16 v[32:47], v[156:159], v[112:115], v[32:47]
    v_exp_f32 v236, v236
    v_cvt_pk_bf16_f32 v117, v234, v235
    v_exp_f32 v237, v237
    v_exp_f32 v238, v238
    v_cvt_pk_bf16_f32 v118, v236, v237
    v_exp_f32 v239, v239
    v_exp_f32 v240, v240
    v_cvt_pk_bf16_f32 v119, v238, v239
    v_exp_f32 v241, v241
    v_exp_f32 v242, v242
    v_cvt_pk_bf16_f32 v112, v240, v241
    v_mfma_f32_32x32x16_bf16 v[32:47], v[160:163], v[116:119], v[32:47]
    v_exp_f32 v243, v243
    v_exp_f32 v244, v244
    v_cvt_pk_bf16_f32 v113, v242, v243
    v_exp_f32 v245, v245
    v_exp_f32 v246, v246
    v_cvt_pk_bf16_f32 v114, v244, v245
    v_exp_f32 v247, v247
    v_exp_f32 v248, v248
    v_cvt_pk_bf16_f32 v115, v246, v247
    v_exp_f32 v249, v249
    v_exp_f32 v250, v250
    v_cvt_pk_bf16_f32 v116, v248, v249
    v_exp_f32 v251, v251
    s_waitcnt vmcnt(1)
    v_mfma_f32_32x32x16_bf16 v[32:47], v[168:171], v[112:115], v[32:47]
    v_exp_f32 v252, v252
    v_cvt_pk_bf16_f32 v117, v250, v251
    v_exp_f32 v253, v253
    v_exp_f32 v254, v254
    v_cvt_pk_bf16_f32 v118, v252, v253
    v_exp_f32 v255, v255
    s_nop 0
    v_cvt_pk_bf16_f32 v119, v254, v255
    s_nop 1
    v_mfma_f32_32x32x16_bf16 v[32:47], v[172:175], v[116:119], v[32:47]
    s_branch L_attj_126
L_warm3:
    s_branch L_warmb3
L_att2_124:
    s_nop 7
    v_pk_mul_f32 v[112:113], v[112:113], v[8:9] op_sel_hi:[1,0]
    v_pk_mul_f32 v[114:115], v[114:115], v[8:9] op_sel_hi:[1,0]
    v_pk_mul_f32 v[116:117], v[116:117], v[8:9] op_sel_hi:[1,0]
    v_pk_mul_f32 v[118:119], v[118:119], v[8:9] op_sel_hi:[1,0]
    v_cvt_pk_bf16_f32 v24, v112, v113
    v_cvt_pk_bf16_f32 v25, v114, v115
    v_cvt_pk_bf16_f32 v26, v116, v117
    v_cvt_pk_bf16_f32 v27, v118, v119
    ds_write_b128 v11, v[24:27] offset:19456
    v_pk_mul_f32 v[120:121], v[120:121], v[8:9] op_sel_hi:[1,0]
    v_pk_mul_f32 v[122:123], v[122:123], v[8:9] op_sel_hi:[1,0]
    v_pk_mul_f32 v[124:125], v[124:125], v[8:9] op_sel_hi:[1,0]
    v_pk_mul_f32 v[126:127], v[126:127], v[8:9] op_sel_hi:[1,0]
    v_cvt_pk_bf16_f32 v28, v120, v121
    v_cvt_pk_bf16_f32 v29, v122, v123
    v_cvt_pk_bf16_f32 v30, v124, v125
    v_cvt_pk_bf16_f32 v31, v126, v127
    s_waitcnt lgkmcnt(0)
    s_nop 0
    v_mfma_f32_32x32x16_bf16 v[224:239], v[128:131], v[28:31], 0
    s_barrier
    ds_read_b128 v[24:27], v11 offset:18432
    s_mov_b64 exec, 0xff
    buffer_load_dword v13, v9, s[32:35], s50 offen sc1
    s_mov_b64 exec, -1
    s_nop 6
    v_exp_f32 v224, v224
    v_exp_f32 v225, v225
    v_exp_f32 v226, v226
    v_cvt_pk_bf16_f32 v112, v224, v225
    v_exp_f32 v227, v227
    v_exp_f32 v228, v228
    v_cvt_pk_bf16_f32 v113, v226, v227
    v_exp_f32 v229, v229
    v_exp_f32 v230, v230
    v_cvt_pk_bf16_f32 v114, v228, v229
    v_exp_f32 v231, v231
    s_waitcnt lgkmcnt(0)
    v_mfma_f32_32x32x16_bf16 v[240:255], v[128:131], v[24:27], 0
    v_exp_f32 v232, v232
    v_cvt_pk_bf16_f32 v115, v230, v231
    v_exp_f32 v233, v233
    v_exp_f32 v234, v234
    v_cvt_pk_bf16_f32 v116, v232, v233
    v_exp_f32 v235, v235
    v_mfma_f32_32x32x16_bf16 v[48:63], v[132:135], v[112:115], 0
    v_exp_f32 v236, v236
    v_cvt_pk_bf16_f32 v117, v234, v235
    v_exp_f32 v237, v237
    v_exp_f32 v238, v238
    v_cvt_pk_bf16_f32 v118, v236, v237
    v_exp_f32 v239, v239
    v_exp_f32 v240, v240
    v_cvt_pk_bf16_f32 v119, v238, v239
    v_exp_f32 v241, v241
    v_exp_f32 v242, v242
    v_cvt_pk_bf16_f32 v112, v240, v241
    v_mfma_f32_32x32x16_bf16 v[48:63], v[136:139], v[116:119], v[48:63]
    v_exp_f32 v243, v243
    v_exp_f32 v244, v244
    v_cvt_pk_bf16_f32 v113, v242, v243
    v_exp_f32 v245, v245
    v_mfma_f32_32x32x16_bf16 v[224:239], v[140:143], v[24:27], v[80:95]
    v_exp_f32 v246, v246
    v_cvt_pk_bf16_f32 v114, v244, v245
    v_exp_f32 v247, v247
    v_exp_f32 v248, v248
    v_cvt_pk_bf16_f32 v115, v246, v247
    v_exp_f32 v249, v249
    v_exp_f32 v250, v250
    v_cvt_pk_bf16_f32 v116, v248, v249
    v_exp_f32 v251, v251
    v_mfma_f32_32x32x16_bf16 v[32:47], v[132:135], v[112:115], 0
    v_exp_f32 v252, v252
    v_cvt_pk_bf16_f32 v117, v250, v251
    v_exp_f32 v253, v253
    v_exp_f32 v254, v254
    v_cvt_pk_bf16_f32 v118, v252, v253
    v_exp_f32 v255, v255
    s_waitcnt vmcnt(0)
L_ro_138:
    v_cmp_ne_u32 vcc, s68, v13
    s_nop 0
    s_and_b64 vcc, vcc, s[52:53]
    s_cbranch_vccz L_rb_139
    s_mov_b64 exec, 0xff
    buffer_load_dword v13, v9, s[32:35], s50 offen sc1
    s_mov_b64 exec, -1
    s_add_u32 s98, s98, 1
    s_cmp_lt_u32 s98, 400000
    s_waitcnt vmcnt(0)
    s_cbranch_scc1 L_ro_138
L_rb_139:
    v_exp_f32 v224, v224
    v_cvt_pk_bf16_f32 v119, v254, v255
    v_exp_f32 v225, v225
    v_exp_f32 v226, v226
    v_cvt_pk_bf16_f32 v112, v224, v225
    v_mfma_f32_32x32x16_bf16 v[32:47], v[136:139], v[116:119], v[32:47]
    s_branch L_attb_137
L_att1_123:
    s_nop 9
    v_pk_mul_f32 v[120:121], v[120:121], v[8:9] op_sel_hi:[1,0]
    v_pk_mul_f32 v[122:123], v[122:123], v[8:9] op_sel_hi:[1,0]
    v_pk_mul_f32 v[124:125], v[124:125], v[8:9] op_sel_hi:[1,0]
    v_pk_mul_f32 v[126:127], v[126:127], v[8:9] op_sel_hi:[1,0]
    v_cvt_pk_bf16_f32 v28, v120, v121
    v_cvt_pk_bf16_f32 v29, v122, v123
    v_cvt_pk_bf16_f32 v30, v124, v125
    v_cvt_pk_bf16_f32 v31, v126, v127
    ds_write_b128 v11, v[28:31] offset:18432
    v_pk_mul_f32 v[112:113], v[112:113], v[8:9] op_sel_hi:[1,0]
    v_pk_mul_f32 v[114:115], v[114:115], v[8:9] op_sel_hi:[1,0]
    v_pk_mul_f32 v[116:117], v[116:117], v[8:9] op_sel_hi:[1,0]
    v_pk_mul_f32 v[118:119], v[118:119], v[8:9] op_sel_hi:[1,0]
    v_cvt_pk_bf16_f32 v24, v112, v113
    v_cvt_pk_bf16_f32 v25, v114, v115
    v_cvt_pk_bf16_f32 v26, v116, v117
    v_cvt_pk_bf16_f32 v27, v118, v119
    s_waitcnt lgkmcnt(0)
    s_nop 0
    v_mfma_f32_32x32x16_bf16 v[224:239], v[128:131], v[24:27], 0
    s_barrier
    ds_read_b128 v[28:31], v11 offset:19456
    s_mov_b64 exec, 0xff
    buffer_load_dword v13, v9, s[32:35], s50 offen sc1
    s_mov_b64 exec, -1
    s_nop 6
    v_exp_f32 v224, v224
    v_exp_f32 v225, v225
    v_exp_f32 v226, v226
    v_cvt_pk_bf16_f32 v112, v224, v225
    v_exp_f32 v227, v227
    v_exp_f32 v228, v228
    v_cvt_pk_bf16_f32 v113, v226, v227
    v_exp_f32 v229, v229
    v_exp_f32 v230, v230
    v_cvt_pk_bf16_f32 v114, v228, v229
    v_exp_f32 v231, v231
    s_waitcnt lgkmcnt(0)
    v_mfma_f32_32x32x16_bf16 v[240:255], v[128:131], v[28:31], 0
    v_exp_f32 v232, v232
    v_cvt_pk_bf16_f32 v115, v230, v231
    v_exp_f32 v233, v233
    v_exp_f32 v234, v234
    v_cvt_pk_bf16_f32 v116, v232, v233
    v_exp_f32 v235, v235
    v_mfma_f32_32x32x16_bf16 v[32:47], v[132:135], v[112:115], 0
    v_exp_f32 v236, v236
    v_cvt_pk_bf16_f32 v117, v234, v235
    v_exp_f32 v237, v237
    v_exp_f32 v238, v238
    v_cvt_pk_bf16_f32 v118, v236, v237
    v_exp_f32 v239, v239
    v_exp_f32 v240, v240
    v_cvt_pk_bf16_f32 v119, v238, v239
    v_exp_f32 v241, v241
    v_exp_f32 v242, v242
    v_cvt_pk_bf16_f32 v112, v240, v241
    v_mfma_f32_32x32x16_bf16 v[32:47], v[136:139], v[116:119], v[32:47]
    v_exp_f32 v243, v243
    v_exp_f32 v244, v244
    v_cvt_pk_bf16_f32 v113, v242, v243
    v_exp_f32 v245, v245
    v_mfma_f32_32x32x16_bf16 v[224:239], v[140:143], v[24:27], v[80:95]
    v_exp_f32 v246, v246
    v_cvt_pk_bf16_f32 v114, v244, v245
    v_exp_f32 v247, v247
    v_exp_f32 v248, v248
    v_cvt_pk_bf16_f32 v115, v246, v247
    v_exp_f32 v249, v249
    v_exp_f32 v250, v250
    v_cvt_pk_bf16_f32 v116, v248, v249
    v_exp_f32 v251, v251
    v_mfma_f32_32x32x16_bf16 v[48:63], v[132:135], v[112:115], 0
    v_exp_f32 v252, v252
    v_cvt_pk_bf16_f32 v117, v250, v251
    v_exp_f32 v253, v253
    v_exp_f32 v254, v254
    v_cvt_pk_bf16_f32 v118, v252, v253
    v_exp_f32 v255, v255
    s_waitcnt vmcnt(0)
L_ro_140:
    v_cmp_ne_u32 vcc, s68, v13
    s_nop 0
    s_and_b64 vcc, vcc, s[52:53]
    s_cbranch_vccz L_rb_141
    s_mov_b64 exec, 0xff
    buffer_load_dword v13, v9, s[32:35], s50 offen sc1
    s_mov_b64 exec, -1
    s_add_u32 s98, s98, 1
    s_cmp_lt_u32 s98, 400000
    s_waitcnt vmcnt(0)
    s_cbranch_scc1 L_ro_140
L_rb_141:
    v_exp_f32 v224, v224
    v_cvt_pk_bf16_f32 v119, v254, v255
    v_exp_f32 v225, v225
    v_exp_f32 v226, v226
    v_cvt_pk_bf16_f32 v112, v224, v225
    v_mfma_f32_32x32x16_bf16 v[48:63], v[136:139], v[116:119], v[48:63]
L_attb_137:
    v_exp_f32 v227, v227
    buffer_load_dwordx4 v[176:179], v16, s[32:35], s12 offen sc1
    v_exp_f32 v228, v228
    v_cvt_pk_bf16_f32 v113, v226, v227
    v_exp_f32 v229, v229
    v_mfma_f32_32x32x16_bf16 v[240:255], v[140:143], v[28:31], 0
    v_exp_f32 v230, v230
    v_cvt_pk_bf16_f32 v114, v228, v229
    v_exp_f32 v231, v231
    v_exp_f32 v232, v232
    v_cvt_pk_bf16_f32 v115, v230, v231
    buffer_load_dwordx4 v[180:183], v12, s[32:35], s12 offen offset:2048 sc1
    v_exp_f32 v233, v233
    v_exp_f32 v234, v234
    v_cvt_pk_bf16_f32 v116, v232, v233
    v_exp_f32 v235, v235
    v_mfma_f32_32x32x16_bf16 v[32:47], v[144:147], v[112:115], v[32:47]
    v_exp_f32 v236, v236
    v_cvt_pk_bf16_f32 v117, v234, v235
    v_exp_f32 v237, v237
    buffer_load_dwordx4 v[184:187], v12, s[32:35], s12 offen offset:3200 sc1
    v_exp_f32 v238, v238
    v_cvt_pk_bf16_f32 v118, v236, v237
    v_exp_f32 v239, v239
    v_exp_f32 v240, v240
    v_cvt_pk_bf16_f32 v119, v238, v239
    v_exp_f32 v241, v241
    v_exp_f32 v242, v242
    v_cvt_pk_bf16_f32 v112, v240, v241
    v_mfma_f32_32x32x16_bf16 v[32:47], v[148:151], v[116:119], v[32:47]
    v_exp_f32 v243, v243
    buffer_load_dwordx4 v[188:191], v16, s[32:35], s13 offen sc1
    v_exp_f32 v244, v244
    v_cvt_pk_bf16_f32 v113, v242, v243
    v_exp_f32 v245, v245
    v_mfma_f32_32x32x16_bf16 v[224:239], v[152:155], v[28:31], v[80:95]
    v_exp_f32 v246, v246
    v_cvt_pk_bf16_f32 v114, v244, v245
    v_exp_f32 v247, v247
    v_exp_f32 v248, v248
    v_cvt_pk_bf16_f32 v115, v246, v247
    buffer_load_dwordx4 v[192:195], v12, s[32:35], s13 offen offset:2048 sc1
    v_exp_f32 v249, v249
    v_exp_f32 v250, v250
    v_cvt_pk_bf16_f32 v116, v248, v249
    v_exp_f32 v251, v251
    v_mfma_f32_32x32x16_bf16 v[48:63], v[144:147], v[112:115], v[48:63]
    v_exp_f32 v252, v252
    v_cvt_pk_bf16_f32 v117, v250, v251
    v_exp_f32 v253, v253
    buffer_load_dwordx4 v[196:199], v12, s[32:35], s13 offen offset:3200 sc1
    v_exp_f32 v254, v254
    v_cvt_pk_bf16_f32 v118, v252, v253
    v_exp_f32 v255, v255
    s_add_u32 s69, s68, 11
    v_mov_b32 v13, s69
    v_exp_f32 v224, v224
    v_cvt_pk_bf16_f32 v119, v254, v255
    v_exp_f32 v225, v225
    v_exp_f32 v226, v226
    v_cvt_pk_bf16_f32 v112, v224, v225
    v_mfma_f32_32x32x16_bf16 v[48:63], v[148:151], v[116:119], v[48:63]
    v_exp_f32 v227, v227
    buffer_load_dwordx4 v[200:203], v16, s[32:35], s14 offen sc1
    v_exp_f32 v228, v228
    v_cvt_pk_bf16_f32 v113, v226, v227
    v_exp_f32 v229, v229
    s_waitcnt vmcnt(6)
    v_mfma_f32_32x32x16_bf16 v[240:255], v[176:179], v[24:27], 0
    v_exp_f32 v230, v230
    v_cvt_pk_bf16_f32 v114, v228, v229
    v_exp_f32 v231, v231
    v_exp_f32 v232, v232
    v_cvt_pk_bf16_f32 v115, v230, v231
    buffer_load_dwordx4 v[204:207], v12, s[32:35], s14 offen offset:2048 sc1
    v_exp_f32 v233, v233
    v_exp_f32 v234, v234
    v_cvt_pk_bf16_f32 v116, v232, v233
    v_exp_f32 v235, v235
    v_mfma_f32_32x32x16_bf16 v[48:63], v[156:159], v[112:115], v[48:63]
    v_exp_f32 v236, v236
    v_cvt_pk_bf16_f32 v117, v234, v235
    v_exp_f32 v237, v237
    buffer_load_dwordx4 v[208:211], v12, s[32:35], s14 offen offset:3200 sc1
    v_exp_f32 v238, v238
    v_cvt_pk_bf16_f32 v118, v236, v237
    v_exp_f32 v239, v239
    v_exp_f32 v240, v240
    v_cvt_pk_bf16_f32 v119, v238, v239
    v_exp_f32 v241, v241
    v_exp_f32 v242, v242
    v_cvt_pk_bf16_f32 v112, v240, v241
    v_mfma_f32_32x32x16_bf16 v[48:63], v[160:163], v[116:119], v[48:63]
    v_exp_f32 v243, v243
    buffer_load_dwordx4 v[212:215], v16, s[32:35], s15 offen sc1
    v_exp_f32 v244, v244
    v_cvt_pk_bf16_f32 v113, v242, v243
    v_exp_f32 v245, v245
    v_mfma_f32_32x32x16_bf16 v[224:239], v[176:179], v[28:31], 0
    v_exp_f32 v246, v246
    v_cvt_pk_bf16_f32 v114, v244, v245
    v_exp_f32 v247, v247
    v_exp_f32 v248, v248
    v_cvt_pk_bf16_f32 v115, v246, v247
    buffer_load_dwordx4 v[216:219], v12, s[32:35], s15 offen offset:2048 sc1
    v_exp_f32 v249, v249
    v_exp_f32 v250, v250
    v_cvt_pk_bf16_f32 v116, v248, v249
    v_exp_f32 v251, v251
    s_waitcnt vmcnt(8)
    v_mfma_f32_32x32x16_bf16 v[32:47], v[180:183], v[112:115], v[32:47]
    v_exp_f32 v252, v252
    v_cvt_pk_bf16_f32 v117, v250, v251
    v_exp_f32 v253, v253
    buffer_load_dwordx4 v[220:223], v12, s[32:35], s15 offen offset:3200 sc1
    v_exp_f32 v254, v254
    v_cvt_pk_bf16_f32 v118, v252, v253
    v_exp_f32 v255, v255
    v_exp_f32 v224, v224
    v_cvt_pk_bf16_f32 v119, v254, v255
    v_exp_f32 v225, v225
    v_exp_f32 v226, v226
    v_cvt_pk_bf16_f32 v112, v224, v225
    v_mfma_f32_32x32x16_bf16 v[32:47], v[184:187], v[116:119], v[32:47]
    v_exp_f32 v227, v227
    v_add_u32 v16, s54, v17
    v_add_u32 v12, s54, v18
    buffer_load_dwordx4 v[128:131], v16, s[32:35], s16 offen sc1
    v_exp_f32 v228, v228
    v_cvt_pk_bf16_f32 v113, v226, v227
    v_exp_f32 v229, v229
    s_waitcnt vmcnt(9)
    v_mfma_f32_32x32x16_bf16 v[240:255], v[188:191], v[24:27], 0
    v_exp_f32 v230, v230
    v_cvt_pk_bf16_f32 v114, v228, v229
    v_exp_f32 v231, v231
    v_exp_f32 v232, v232
    v_cvt_pk_bf16_f32 v115, v230, v231
    buffer_load_dwordx4 v[132:135], v12, s[32:35], s16 offen offset:2048 sc1
    v_exp_f32 v233, v233
    v_exp_f32 v234, v234
    v_cvt_pk_bf16_f32 v116, v232, v233
    v_exp_f32 v235, v235
    v_mfma_f32_32x32x16_bf16 v[48:63], v[180:183], v[112:115], v[48:63]
    v_exp_f32 v236, v236
    v_cvt_pk_bf16_f32 v117, v234, v235
    v_exp_f32 v237, v237
    buffer_load_dwordx4 v[136:139], v12, s[32:35], s16 offen offset:3200 sc1
    v_exp_f32 v238, v238
    v_cvt_pk_bf16_f32 v118, v236, v237
    v_exp_f32 v239, v239
    v_exp_f32 v240, v240
    v_cvt_pk_bf16_f32 v119, v238, v239
    v_exp_f32 v241, v241
    v_exp_f32 v242, v242
    v_cvt_pk_bf16_f32 v112, v240, v241
    v_mfma_f32_32x32x16_bf16 v[48:63], v[184:187], v[116:119], v[48:63]
    v_exp_f32 v243, v243
    buffer_load_dwordx4 v[140:143], v16, s[32:35], s17 offen sc1
    v_exp_f32 v244, v244
    v_cvt_pk_bf16_f32 v113, v242, v243
    v_exp_f32 v245, v245
    v_mfma_f32_32x32x16_bf16 v[224:239], v[188:191], v[28:31], 0
    v_exp_f32 v246, v246
    v_cvt_pk_bf16_f32 v114, v244, v245
    v_exp_f32 v247, v247
    v_exp_f32 v248, v248
    v_cvt_pk_bf16_f32 v115, v246, v247
    buffer_load_dwordx4 v[144:147], v12, s[32:35], s17 offen offset:2048 sc1
    v_exp_f32 v249, v249
    v_exp_f32 v250, v250
    v_cvt_pk_bf16_f32 v116, v248, v249
    v_exp_f32 v251, v251
    s_waitcnt vmcnt(11)
    v_mfma_f32_32x32x16_bf16 v[32:47], v[192:195], v[112:115], v[32:47]
    v_exp_f32 v252, v252
    v_cvt_pk_bf16_f32 v117, v250, v251
    v_exp_f32 v253, v253
    buffer_load_dwordx4 v[148:151], v12, s[32:35], s17 offen offset:3200 sc1
    v_exp_f32 v254, v254
    v_cvt_pk_bf16_f32 v118, v252, v253
    v_exp_f32 v255, v255
    v_exp_f32 v224, v224
    v_cvt_pk_bf16_f32 v119, v254, v255
    v_exp_f32 v225, v225
    v_exp_f32 v226, v226
    v_cvt_pk_bf16_f32 v112, v224, v225
    v_mfma_f32_32x32x16_bf16 v[32:47], v[196:199], v[116:119], v[32:47]
    v_exp_f32 v227, v227
    buffer_load_dwordx4 v[152:155], v16, s[32:35], s18 offen sc1
    v_exp_f32 v228, v228
    v_cvt_pk_bf16_f32 v113, v226, v227
    v_exp_f32 v229, v229
    s_waitcnt vmcnt(12)
    v_mfma_f32_32x32x16_bf16 v[240:255], v[200:203], v[24:27], 0
    v_exp_f32 v230, v230
    v_cvt_pk_bf16_f32 v114, v228, v229
    v_exp_f32 v231, v231
    v_exp_f32 v232, v232
    v_cvt_pk_bf16_f32 v115, v230, v231
    buffer_load_dwordx4 v[156:159], v12, s[32:35], s18 offen offset:2048 sc1
    v_exp_f32 v233, v233
    v_exp_f32 v234, v234
    v_cvt_pk_bf16_f32 v116, v232, v233
    v_exp_f32 v235, v235
    v_mfma_f32_32x32x16_bf16 v[48:63], v[192:195], v[112:115], v[48:63]
    v_exp_f32 v236, v236
    v_cvt_pk_bf16_f32 v117, v234, v235
    v_exp_f32 v237, v237
    buffer_load_dwordx4 v[160:163], v12, s[32:35], s18 offen offset:3200 sc1
    v_exp_f32 v238, v238
    v_cvt_pk_bf16_f32 v118, v236, v237
    v_exp_f32 v239, v239
    v_exp_f32 v240, v240
    v_cvt_pk_bf16_f32 v119, v238, v239
    v_exp_f32 v241, v241
    v_exp_f32 v242, v242
    v_cvt_pk_bf16_f32 v112, v240, v241
    v_mfma_f32_32x32x16_bf16 v[48:63], v[196:199], v[116:119], v[48:63]
    v_exp_f32 v243, v243
    v_exp_f32 v244, v244
    v_cvt_pk_bf16_f32 v113, v242, v243
    v_exp_f32 v245, v245
    v_mfma_f32_32x32x16_bf16 v[224:239], v[200:203], v[28:31], 0
    v_exp_f32 v246, v246
    v_cvt_pk_bf16_f32 v114, v244, v245
    v_exp_f32 v247, v247
    v_exp_f32 v248, v248
    v_cvt_pk_bf16_f32 v115, v246, v247
    v_exp_f32 v249, v249
    v_exp_f32 v250, v250
    v_cvt_pk_bf16_f32 v116, v248, v249
    v_exp_f32 v251, v251
    s_waitcnt vmcnt(12)
    v_mfma_f32_32x32x16_bf16 v[32:47], v[204:207], v[112:115], v[32:47]
    v_exp_f32 v252, v252
    v_cvt_pk_bf16_f32 v117, v250, v251
    v_exp_f32 v253, v253
    v_exp_f32 v254, v254
    v_cvt_pk_bf16_f32 v118, v252, v253
    v_exp_f32 v255, v255
    v_exp_f32 v224, v224
    v_cvt_pk_bf16_f32 v119, v254, v255
    v_exp_f32 v225, v225
    v_exp_f32 v226, v226
    v_cvt_pk_bf16_f32 v112, v224, v225
    v_mfma_f32_32x32x16_bf16 v[32:47], v[208:211], v[116:119], v[32:47]
    v_exp_f32 v227, v227
    v_exp_f32 v228, v228
    v_cvt_pk_bf16_f32 v113, v226, v227
    v_exp_f32 v229, v229
    s_waitcnt vmcnt(11)
    v_mfma_f32_32x32x16_bf16 v[240:255], v[212:215], v[24:27], 0
    v_exp_f32 v230, v230
    v_cvt_pk_bf16_f32 v114, v228, v229
    v_exp_f32 v231, v231
    v_exp_f32 v232, v232
    v_cvt_pk_bf16_f32 v115, v230, v231
    v_exp_f32 v233, v233
    v_exp_f32 v234, v234
    v_cvt_pk_bf16_f32 v116, v232, v233
    v_exp_f32 v235, v235
    v_mfma_f32_32x32x16_bf16 v[48:63], v[204:207], v[112:115], v[48:63]
    v_exp_f32 v236, v236
    v_cvt_pk_bf16_f32 v117, v234, v235
    v_exp_f32 v237, v237
    v_exp_f32 v238, v238
    v_cvt_pk_bf16_f32 v118, v236, v237
    v_exp_f32 v239, v239
    v_exp_f32 v240, v240
    v_cvt_pk_bf16_f32 v119, v238, v239
    v_exp_f32 v241, v241
    v_exp_f32 v242, v242
    v_cvt_pk_bf16_f32 v112, v240, v241
    v_mfma_f32_32x32x16_bf16 v[48:63], v[208:211], v[116:119], v[48:63]
    v_exp_f32 v243, v243
    v_exp_f32 v244, v244
    v_cvt_pk_bf16_f32 v113, v242, v243
    v_exp_f32 v245, v245
    v_mfma_f32_32x32x16_bf16 v[224:239], v[212:215], v[28:31], 0
    v_exp_f32 v246, v246
    v_cvt_pk_bf16_f32 v114, v244, v245
    v_exp_f32 v247, v247
    v_exp_f32 v248, v248
    v_cvt_pk_bf16_f32 v115, v246, v247
    v_exp_f32 v249, v249
    v_exp_f32 v250, v250
    v_cvt_pk_bf16_f32 v116, v248, v249
    v_exp_f32 v251, v251
    s_waitcnt vmcnt(9)
    v_mfma_f32_32x32x16_bf16 v[32:47], v[216:219], v[112:115], v[32:47]
    v_exp_f32 v252, v252
    v_cvt_pk_bf16_f32 v117, v250, v251
    v_exp_f32 v253, v253
    v_exp_f32 v254, v254
    v_cvt_pk_bf16_f32 v118, v252, v253
    v_exp_f32 v255, v255
    v_exp_f32 v224, v224
    v_cvt_pk_bf16_f32 v119, v254, v255
    v_exp_f32 v225, v225
    v_exp_f32 v226, v226
    v_cvt_pk_bf16_f32 v112, v224, v225
    v_mfma_f32_32x32x16_bf16 v[32:47], v[220:223], v[116:119], v[32:47]
    v_exp_f32 v227, v227
    v_exp_f32 v228, v228
    v_cvt_pk_bf16_f32 v113, v226, v227
    v_exp_f32 v229, v229
    s_waitcnt vmcnt(8)
    v_mfma_f32_32x32x16_bf16 v[240:255], v[128:131], v[28:31], 0
    v_exp_f32 v230, v230
    v_cvt_pk_bf16_f32 v114, v228, v229
    v_exp_f32 v231, v231
    v_exp_f32 v232, v232
    v_cvt_pk_bf16_f32 v115, v230, v231
    v_exp_f32 v233, v233
    v_exp_f32 v234, v234
    v_cvt_pk_bf16_f32 v116, v232, v233
    v_exp_f32 v235, v235
    v_mfma_f32_32x32x16_bf16 v[48:63], v[216:219], v[112:115], v[48:63]
    v_exp_f32 v236, v236
    v_cvt_pk_bf16_f32 v117, v234, v235
    v_exp_f32 v237, v237
    v_exp_f32 v238, v238
    v_cvt_pk_bf16_f32 v118, v236, v237
    v_exp_f32 v239, v239
    v_exp_f32 v240, v240
    v_cvt_pk_bf16_f32 v119, v238, v239
    v_exp_f32 v241, v241
    v_exp_f32 v242, v242
    v_cvt_pk_bf16_f32 v112, v240, v241
    v_mfma_f32_32x32x16_bf16 v[48:63], v[220:223], v[116:119], v[48:63]
    v_exp_f32 v243, v243
    v_exp_f32 v244, v244
    v_cvt_pk_bf16_f32 v113, v242, v243
    v_exp_f32 v245, v245
    s_waitcnt vmcnt(5)
    v_mfma_f32_32x32x16_bf16 v[224:239], v[140:143], v[28:31], v[96:111]
    v_exp_f32 v246, v246
    v_cvt_pk_bf16_f32 v114, v244, v245
    v_exp_f32 v247, v247
    v_exp_f32 v248, v248
    v_cvt_pk_bf16_f32 v115, v246, v247
    v_exp_f32 v249, v249
    v_exp_f32 v250, v250
    v_cvt_pk_bf16_f32 v116, v248, v249
    v_exp_f32 v251, v251
    v_mfma_f32_32x32x16_bf16 v[48:63], v[132:135], v[112:115], v[48:63]
    v_exp_f32 v252, v252
    v_cvt_pk_bf16_f32 v117, v250, v251
    v_exp_f32 v253, v253
    v_exp_f32 v254, v254
    v_cvt_pk_bf16_f32 v118, v252, v253
    v_exp_f32 v255, v255
    v_exp_f32 v224, v224
    v_cvt_pk_bf16_f32 v119, v254, v255
    v_exp_f32 v225, v225
    v_exp_f32 v226, v226
    v_cvt_pk_bf16_f32 v112, v224, v225
    v_mfma_f32_32x32x16_bf16 v[48:63], v[136:139], v[116:119], v[48:63]
    v_exp_f32 v227, v227
    v_exp_f32 v228, v228
    v_cvt_pk_bf16_f32 v113, v226, v227
    v_exp_f32 v229, v229
    v_mfma_f32_32x32x16_bf16 v[240:255], v[128:131], v[24:27], 0
    v_exp_f32 v230, v230
    v_cvt_pk_bf16_f32 v114, v228, v229
    v_exp_f32 v231, v231
    v_exp_f32 v232, v232
    v_cvt_pk_bf16_f32 v115, v230, v231
    v_exp_f32 v233, v233
    v_exp_f32 v234, v234
    v_cvt_pk_bf16_f32 v116, v232, v233
    v_exp_f32 v235, v235
    s_waitcnt vmcnt(3)
    v_mfma_f32_32x32x16_bf16 v[48:63], v[144:147], v[112:115], v[48:63]
    v_exp_f32 v236, v236
    v_cvt_pk_bf16_f32 v117, v234, v235
    v_exp_f32 v237, v237
    v_exp_f32 v238, v238
    v_cvt_pk_bf16_f32 v118, v236, v237
    v_exp_f32 v239, v239
    v_exp_f32 v240, v240
    v_cvt_pk_bf16_f32 v119, v238, v239
    v_exp_f32 v241, v241
    v_exp_f32 v242, v242
    v_cvt_pk_bf16_f32 v112, v240, v241
    v_mfma_f32_32x32x16_bf16 v[48:63], v[148:151], v[116:119], v[48:63]
    v_exp_f32 v243, v243
    v_exp_f32 v244, v244
    v_cvt_pk_bf16_f32 v113, v242, v243
    v_exp_f32 v245, v245
    v_mfma_f32_32x32x16_bf16 v[224:239], v[140:143], v[24:27], 0
    v_exp_f32 v246, v246
    v_cvt_pk_bf16_f32 v114, v244, v245
    v_exp_f32 v247, v247
    v_exp_f32 v248, v248
    v_cvt_pk_bf16_f32 v115, v246, v247
    v_exp_f32 v249, v249
    v_exp_f32 v250, v250
    v_cvt_pk_bf16_f32 v116, v248, v249
    v_exp_f32 v251, v251
    v_mfma_f32_32x32x16_bf16 v[32:47], v[132:135], v[112:115], v[32:47]
    v_exp_f32 v252, v252
    v_subrev_u32 v57, 0x1f800000, v56
    v_cmp_le_u32 vcc, 0x40000000, v57
    v_rcp_f32 v56, v56
    s_nop 0
    v_pk_mul_f32 v[48:49], v[48:49], v[56:57] op_sel_hi:[1,0]
    v_pk_mul_f32 v[50:51], v[50:51], v[56:57] op_sel_hi:[1,0]
    v_pk_mul_f32 v[52:53], v[52:53], v[56:57] op_sel_hi:[1,0]
    v_pk_mul_f32 v[54:55], v[54:55], v[56:57] op_sel_hi:[1,0]
    v_cvt_pk_bf16_f32 v124, v48, v49
    v_cvt_pk_bf16_f32 v125, v50, v51
    v_cvt_pk_bf16_f32 v126, v52, v53
    v_cvt_pk_bf16_f32 v127, v54, v55
    s_or_b32 s86, vcc_lo, vcc_hi
    s_cmp_lg_u32 s76, 0
    s_cbranch_scc1 L_slow_142
    buffer_store_dwordx4 v[124:127], v1, s[24:27], s9 offen
L_back_143:
    v_cvt_pk_bf16_f32 v117, v250, v251
    v_exp_f32 v253, v253
    v_exp_f32 v254, v254
    v_cvt_pk_bf16_f32 v118, v252, v253
    v_exp_f32 v255, v255
    v_exp_f32 v224, v224
    v_cvt_pk_bf16_f32 v119, v254, v255
    v_exp_f32 v225, v225
L_pad10:
    s_cbranch_execz L_wback
    v_exp_f32 v226, v226
    v_cvt_pk_bf16_f32 v112, v224, v225
    v_mfma_f32_32x32x16_bf16 v[32:47], v[136:139], v[116:119], v[32:47]
    v_exp_f32 v227, v227
    v_exp_f32 v228, v228
    v_cvt_pk_bf16_f32 v113, v226, v227
    v_exp_f32 v229, v229
    s_waitcnt vmcnt(3)
    v_mfma_f32_32x32x16_bf16 v[240:255], v[152:155], v[24:27], v[96:111]
    v_exp_f32 v230, v230
    v_cvt_pk_bf16_f32 v114, v228, v229
    v_exp_f32 v231, v231
    v_exp_f32 v232, v232
    v_cvt_pk_bf16_f32 v115, v230, v231
    v_exp_f32 v233, v233
    v_exp_f32 v234, v234
    v_cvt_pk_bf16_f32 v116, v232, v233
    v_exp_f32 v235, v235
    v_mfma_f32_32x32x16_bf16 v[32:47], v[144:147], v[112:115], v[32:47]
    v_exp_f32 v236, v236
    v_cvt_pk_bf16_f32 v117, v234, v235
    v_exp_f32 v237, v237
    v_exp_f32 v238, v238
    v_cvt_pk_bf16_f32 v118, v236, v237
    v_exp_f32 v239, v239
    v_exp_f32 v240, v240
    v_cvt_pk_bf16_f32 v119, v238, v239
    v_exp_f32 v241, v241
    v_exp_f32 v242, v242
    v_cvt_pk_bf16_f32 v112, v240, v241
    v_mfma_f32_32x32x16_bf16 v[32:47], v[148:151], v[116:119], v[32:47]
    v_exp_f32 v243, v243
    v_exp_f32 v244, v244
    v_cvt_pk_bf16_f32 v113, v242, v243
    v_exp_f32 v245, v245
    v_exp_f32 v246, v246
    v_cvt_pk_bf16_f32 v114, v244, v245
    v_exp_f32 v247, v247
    v_exp_f32 v248, v248
    v_cvt_pk_bf16_f32 v115, v246, v247
    v_exp_f32 v249, v249
    s_cmp_lg_u32 s86, 0
    s_cbranch_scc1 L_nof_144
    s_mov_b64 exec, 1
    s_cmp_lg_u32 s76, 0
    s_cbranch_scc1 L_slow_145
    s_waitcnt vmcnt(0)
    buffer_store_dword v13, v6, s[24:27], s11 offen
L_back_146:
    s_mov_b64 exec, -1
L_nof_144:
    v_exp_f32 v250, v250
    v_cvt_pk_bf16_f32 v116, v248, v249
    v_exp_f32 v251, v251
    s_waitcnt vmcnt(1)
    v_mfma_f32_32x32x16_bf16 v[32:47], v[156:159], v[112:115], v[32:47]
    v_exp_f32 v252, v252
    v_cvt_pk_bf16_f32 v117, v250, v251
    v_exp_f32 v253, v253
    v_exp_f32 v254, v254
    v_cvt_pk_bf16_f32 v118, v252, v253
    v_exp_f32 v255, v255
    s_nop 0
    v_cvt_pk_bf16_f32 v119, v254, v255
    s_nop 1
    v_mfma_f32_32x32x16_bf16 v[32:47], v[160:163], v[116:119], v[32:47]
L_attj_126:
    s_cmp_lg_u32 s86, 0
    s_cbranch_scc1 L_fbb_147
L_fbbr_148:
    s_nop 9
    v_subrev_u32 v41, 0x1f800000, v40
    v_cmp_le_u32 vcc, 0x40000000, v41
    s_cbranch_vccnz L_fb_151
L_fbr_152:
    v_rcp_f32 v40, v40
    s_nop 0
    v_pk_mul_f32 v[32:33], v[32:33], v[40:41] op_sel_hi:[1,0]
    v_pk_mul_f32 v[34:35], v[34:35], v[40:41] op_sel_hi:[1,0]
    v_pk_mul_f32 v[36:37], v[36:37], v[40:41] op_sel_hi:[1,0]
    v_pk_mul_f32 v[38:39], v[38:39], v[40:41] op_sel_hi:[1,0]
    v_cvt_pk_bf16_f32 v120, v32, v33
    v_cvt_pk_bf16_f32 v121, v34, v35
    v_cvt_pk_bf16_f32 v122, v36, v37
    v_cvt_pk_bf16_f32 v123, v38, v39
    s_cmp_lg_u32 s76, 0
    s_cbranch_scc1 L_slow_153
    buffer_store_dwordx4 v[120:123], v1, s[24:27], s8 offen
L_back_154:
    v_and_b32 v16, 48, v0
    v_lshl_add_u32 v15, v16, 4, v1
    v_and_b32 v16, 16, v0
    v_mad_u32_u24 v16, v16, 48, v1
    v_add_u32 v20, 0x10000, v1
    s_add_u32 s75, s75, s76
    ds_write_b128 v19, a[32:35] offset:0
    ds_write_b128 v19, a[36:39] offset:1024
    ds_write_b128 v19, a[40:43] offset:2048
    ds_write_b128 v19, a[44:47] offset:3072
    ds_write_b128 v19, a[48:51] offset:16384
    s_mov_b64 exec, 1
    s_cmp_lg_u32 s76, 0
    s_cbranch_scc1 L_slow_155
    s_waitcnt vmcnt(0)
    buffer_store_dword v13, v6, s[24:27], s10 offen
L_back_156:
    s_mov_b64 exec, -1
    buffer_load_dword v12, v6, s[24:27], s83 offen sc1
    ds_write_b128 v19, a[52:55] offset:17408
    ds_write_b128 v19, a[56:59] offset:18432
    ds_write_b128 v19, a[60:63] offset:19456
    s_waitcnt lgkmcnt(0)
    s_barrier
    ds_read_b128 v[192:195], v20 offset:32768
    ds_read_b128 v[196:199], v20 offset:33792
    ds_read_b128 v[200:203], v20 offset:34816
    ds_read_b128 v[204:207], v20 offset:35840
    ds_read_b128 v[208:211], v20 offset:36864
    ds_read_b128 v[212:215], v20 offset:37888
    ds_read_b128 v[216:219], v20 offset:38912
    ds_read_b128 v[220:223], v20 offset:39936
    ds_read_b128 v[224:227], v20 offset:40960
    ds_read_b128 v[228:231], v20 offset:41984
L_poll_157:
    s_add_u32 s98, s98, 1
    s_cmp_lt_u32 s98, 400000
    s_cselect_b64 s[94:95], -1, 0
    s_waitcnt vmcnt(0)
    v_cmp_ne_u32 vcc, s69, v12
    buffer_load_dword v12, v6, s[24:27], s83 offen sc1
    s_and_b64 vcc, vcc, s[94:95]
    s_cbranch_scc1 L_poll_157
    s_add_u32 s90, s75, s0
    buffer_load_dwordx4 v[128:131], v15, s[24:27], s90 offen offset:0 sc1
    buffer_load_dwordx4 v[132:135], v15, s[24:27], s90 offen offset:2048 sc1
    ds_read_b128 v[232:235], v20 offset:43008
    ds_read_b128 v[236:239], v20 offset:44032
    ds_read_b128 v[240:243], v20 offset:45056
    s_add_u32 s90, s90, 4096
    buffer_load_dwordx4 v[136:139], v15, s[24:27], s90 offen offset:0 sc1
    ds_read_b128 v[244:247], v20 offset:46080
    ds_read_b128 v[248:251], v20 offset:47104
    ds_read_b128 v[252:255], v20 offset:48128
    buffer_load_dwordx4 v[140:143], v15, s[24:27], s90 offen offset:2048 sc1
    ds_read_b128 v[32:35], v20 offset:49152
    ds_read_b128 v[36:39], v20 offset:50176
    ds_read_b128 v[40:43], v20 offset:51200
    s_add_u32 s90, s75, s1
    buffer_load_dwordx4 v[144:147], v15, s[24:27], s90 offen offset:0 sc1
    ds_read_b128 v[44:47], v20 offset:52224
    ds_read_b128 v[48:51], v20 offset:53248
    ds_read_b128 v[52:55], v20 offset:54272
    buffer_load_dwordx4 v[148:151], v15, s[24:27], s90 offen offset:2048 sc1
    ds_read_b128 v[56:59], v20 offset:55296
    ds_read_b128 v[60:63], v20 offset:56320
    ds_read_b128 v[80:83], v20 offset:57344
    s_add_u32 s90, s90, 4096
    buffer_load_dwordx4 v[152:155], v15, s[24:27], s90 offen offset:0 sc1
    ds_read_b128 v[84:87], v20 offset:58368
    ds_read_b128 v[88:91], v20 offset:59392
    ds_read_b128 v[92:95], v20 offset:60416
    buffer_load_dwordx4 v[156:159], v15, s[24:27], s90 offen offset:2048 sc1
    ds_read_b128 v[96:99], v20 offset:61440
    ds_read_b128 v[100:103], v20 offset:62464
    ds_read_b128 v[104:107], v20 offset:63488
    s_sub_u32 s91, s83, 16384
    s_lshl_b32 s91, s91, 8
    s_and_b32 s92, s64, 1
    s_lshl_b32 s92, s92, 14
    s_add_u32 s91, s91, s92
    s_lshr_b32 s92, s66, 1
    s_lshl_b32 s92, s92, 7
    s_add_u32 s91, s91, s92
    s_mov_b32 s84, s91
    s_add_u32 s85, s91, 8192
    v_bfe_u32 v17, v0, 4, 1
    v_lshrrev_b32 v18, 5, v0
    v_lshl_add_u32 v17, v17, 1, v18
    v_xor_b32 v17, v17, v0
    v_and_b32 v17, 7, v17
    v_and_b32 v18, 15, v0
    v_lshl_add_u32 v17, v18, 3, v17
    s_add_u32 s92, s77, 0
    v_lshl_add_u32 v17, v17, 4, s92
    v_xor_b32 v18, 64, v17
    v_lshrrev_b32 v13, 3, v0
    v_xor_b32 v14, v13, v0
    v_and_b32 v14, 7, v14
    v_lshlrev_b32 v14, 4, v14
    v_lshl_add_u32 v13, v13, 10, v14
    s_waitcnt vmcnt(7) lgkmcnt(15)
    v_mfma_f32_16x16x32_bf16 v[64:67], v[192:195], v[128:131], v[64:67]
    ds_read_b128 v[108:111], v20 offset:64512
    v_mfma_f32_16x16x32_bf16 v[68:71], v[196:199], v[128:131], v[68:71]
    s_add_u32 s90, s75, s2
    buffer_load_dwordx4 v[160:163], v15, s[24:27], s90 offen offset:0 sc1
    v_mfma_f32_16x16x32_bf16 v[72:75], v[200:203], v[128:131], v[72:75]
    ds_read_b128 v[192:195], v20 offset:0
    v_mfma_f32_16x16x32_bf16 v[76:79], v[204:207], v[128:131], v[76:79]
    s_waitcnt vmcnt(7) lgkmcnt(15)
    v_mfma_f32_16x16x32_bf16 v[64:67], v[208:211], v[132:135], v[64:67]
    ds_read_b128 v[196:199], v20 offset:1024
    v_mfma_f32_16x16x32_bf16 v[68:71], v[212:215], v[132:135], v[68:71]
    buffer_load_dwordx4 v[164:167], v15, s[24:27], s90 offen offset:2048 sc1
    v_mfma_f32_16x16x32_bf16 v[72:75], v[216:219], v[132:135], v[72:75]
    ds_read_b128 v[200:203], v20 offset:2048
    v_mfma_f32_16x16x32_bf16 v[76:79], v[220:223], v[132:135], v[76:79]
    s_waitcnt vmcnt(7) lgkmcnt(15)
    v_mfma_f32_16x16x32_bf16 v[64:67], v[224:227], v[136:139], v[64:67]
    ds_read_b128 v[204:207], v20 offset:3072
    v_mfma_f32_16x16x32_bf16 v[68:71], v[228:231], v[136:139], v[68:71]
    s_add_u32 s90, s90, 4096
    buffer_load_dwordx4 v[168:171], v15, s[24:27], s90 offen offset:0 sc1
    v_mfma_f32_16x16x32_bf16 v[72:75], v[232:235], v[136:139], v[72:75]
    ds_read_b128 v[208:211], v20 offset:4096
    v_mfma_f32_16x16x32_bf16 v[76:79], v[236:239], v[136:139], v[76:79]
    s_waitcnt vmcnt(7) lgkmcnt(15)
    v_mfma_f32_16x16x32_bf16 v[64:67], v[240:243], v[140:143], v[64:67]
    ds_read_b128 v[212:215], v20 offset:5120
    v_mfma_f32_16x16x32_bf16 v[68:71], v[244:247], v[140:143], v[68:71]
    buffer_load_dwordx4 v[172:175], v15, s[24:27], s90 offen offset:2048 sc1
    v_mfma_f32_16x16x32_bf16 v[72:75], v[248:251], v[140:143], v[72:75]
    ds_read_b128 v[216:219], v20 offset:6144
    v_mfma_f32_16x16x32_bf16 v[76:79], v[252:255], v[140:143], v[76:79]
    s_waitcnt vmcnt(7) lgkmcnt(15)
    v_mfma_f32_16x16x32_bf16 v[64:67], v[32:35], v[144:147], v[64:67]
    ds_read_b128 v[220:223], v20 offset:7168
    v_mfma_f32_16x16x32_bf16 v[68:71], v[36:39], v[144:147], v[68:71]
    s_add_u32 s90, s75, s3
    buffer_load_dwordx4 v[176:179], v15, s[24:27], s90 offen offset:0 sc1
    v_mfma_f32_16x16x32_bf16 v[72:75], v[40:43], v[144:147], v[72:75]
    ds_read_b128 v[224:227], v20 offset:8192
    v_mfma_f32_16x16x32_bf16 v[76:79], v[44:47], v[144:147], v[76:79]
    s_waitcnt vmcnt(7) lgkmcnt(15)
    v_mfma_f32_16x16x32_bf16 v[64:67], v[48:51], v[148:151], v[64:67]
    ds_read_b128 v[228:231], v20 offset:9216
    v_mfma_f32_16x16x32_bf16 v[68:71], v[52:55], v[148:151], v[68:71]
    buffer_load_dwordx4 v[180:183], v15, s[24:27], s90 offen offset:2048 sc1
    v_mfma_f32_16x16x32_bf16 v[72:75], v[56:59], v[148:151], v[72:75]
    ds_read_b128 v[232:235], v20 offset:10240
    v_mfma_f32_16x16x32_bf16 v[76:79], v[60:63], v[148:151], v[76:79]
    s_waitcnt vmcnt(7) lgkmcnt(15)
    v_mfma_f32_16x16x32_bf16 v[64:67], v[80:83], v[152:155], v[64:67]
    ds_read_b128 v[236:239], v20 offset:11264
    v_mfma_f32_16x16x32_bf16 v[68:71], v[84:87], v[152:155], v[68:71]
    s_add_u32 s90, s90, 4096
    buffer_load_dwordx4 v[184:187], v15, s[24:27], s90 offen offset:0 sc1
    v_mfma_f32_16x16x32_bf16 v[72:75], v[88:91], v[152:155], v[72:75]
    ds_read_b128 v[240:243], v20 offset:12288
    v_mfma_f32_16x16x32_bf16 v[76:79], v[92:95], v[152:155], v[76:79]
    s_waitcnt vmcnt(7) lgkmcnt(13)
    v_mfma_f32_16x16x32_bf16 v[64:67], v[96:99], v[156:159], v[64:67]
    ds_read_b128 v[244:247], v20 offset:13312
    v_mfma_f32_16x16x32_bf16 v[68:71], v[100:103], v[156:159], v[68:71]
    buffer_load_dwordx4 v[188:191], v15, s[24:27], s90 offen offset:2048 sc1
    v_mfma_f32_16x16x32_bf16 v[72:75], v[104:107], v[156:159], v[72:75]
    ds_read_b128 v[248:251], v20 offset:14336
    v_mfma_f32_16x16x32_bf16 v[76:79], v[108:111], v[156:159], v[76:79]
    s_waitcnt vmcnt(7) lgkmcnt(11)
    v_mfma_f32_16x16x32_bf16 v[64:67], v[192:195], v[160:163], v[64:67]
    ds_read_b128 v[252:255], v20 offset:15360
    v_mfma_f32_16x16x32_bf16 v[68:71], v[196:199], v[160:163], v[68:71]
    ds_read_b128 v[32:35], v20 offset:16384
    v_mfma_f32_16x16x32_bf16 v[72:75], v[200:203], v[160:163], v[72:75]
    ds_read_b128 v[36:39], v20 offset:17408
    v_mfma_f32_16x16x32_bf16 v[76:79], v[204:207], v[160:163], v[76:79]
    ds_read_b128 v[40:43], v20 offset:18432
    s_waitcnt vmcnt(6) lgkmcnt(11)
    v_mfma_f32_16x16x32_bf16 v[64:67], v[208:211], v[164:167], v[64:67]
    ds_read_b128 v[44:47], v20 offset:19456
    v_mfma_f32_16x16x32_bf16 v[68:71], v[212:215], v[164:167], v[68:71]
    ds_read_b128 v[48:51], v20 offset:20480
    v_mfma_f32_16x16x32_bf16 v[72:75], v[216:219], v[164:167], v[72:75]
    ds_read_b128 v[52:55], v20 offset:21504
    v_mfma_f32_16x16x32_bf16 v[76:79], v[220:223], v[164:167], v[76:79]
    ds_read_b128 v[56:59], v20 offset:22528
    s_waitcnt vmcnt(5) lgkmcnt(11)
    v_mfma_f32_16x16x32_bf16 v[64:67], v[224:227], v[168:171], v[64:67]
    ds_read_b128 v[60:63], v20 offset:23552
    v_mfma_f32_16x16x32_bf16 v[68:71], v[228:231], v[168:171], v[68:71]
    ds_read_b128 v[80:83], v20 offset:24576
    v_mfma_f32_16x16x32_bf16 v[72:75], v[232:235], v[168:171], v[72:75]
    ds_read_b128 v[84:87], v20 offset:25600
    v_mfma_f32_16x16x32_bf16 v[76:79], v[236:239], v[168:171], v[76:79]
    ds_read_b128 v[88:91], v20 offset:26624
    s_waitcnt vmcnt(4) lgkmcnt(11)
    v_mfma_f32_16x16x32_bf16 v[64:67], v[240:243], v[172:175], v[64:67]
    ds_read_b128 v[92:95], v20 offset:27648
    v_mfma_f32_16x16x32_bf16 v[68:71], v[244:247], v[172:175], v[68:71]
    ds_read_b128 v[96:99], v20 offset:28672
    v_mfma_f32_16x16x32_bf16 v[72:75], v[248:251], v[172:175], v[72:75]
    ds_read_b128 v[100:103], v20 offset:29696
    v_mfma_f32_16x16x32_bf16 v[76:79], v[252:255], v[172:175], v[76:79]
    ds_read_b128 v[104:107], v20 offset:30720
    s_waitcnt vmcnt(3) lgkmcnt(11)
    v_mfma_f32_16x16x32_bf16 v[64:67], v[32:35], v[176:179], v[64:67]
    ds_read_b128 v[108:111], v20 offset:31744
    v_mfma_f32_16x16x32_bf16 v[68:71], v[36:39], v[176:179], v[68:71]
    v_mfma_f32_16x16x32_bf16 v[72:75], v[40:43], v[176:179], v[72:75]
    v_mfma_f32_16x16x32_bf16 v[76:79], v[44:47], v[176:179], v[76:79]
    s_waitcnt vmcnt(2) lgkmcnt(8)
    v_mfma_f32_16x16x32_bf16 v[64:67], v[48:51], v[180:183], v[64:67]
    v_mfma_f32_16x16x32_bf16 v[68:71], v[52:55], v[180:183], v[68:71]
    v_mfma_f32_16x16x32_bf16 v[72:75], v[56:59], v[180:183], v[72:75]
    v_mfma_f32_16x16x32_bf16 v[76:79], v[60:63], v[180:183], v[76:79]
    s_waitcnt vmcnt(1) lgkmcnt(4)
    v_mfma_f32_16x16x32_bf16 v[64:67], v[80:83], v[184:187], v[64:67]
    v_mfma_f32_16x16x32_bf16 v[68:71], v[84:87], v[184:187], v[68:71]
    v_mfma_f32_16x16x32_bf16 v[72:75], v[88:91], v[184:187], v[72:75]
    v_mfma_f32_16x16x32_bf16 v[76:79], v[92:95], v[184:187], v[76:79]
    s_waitcnt vmcnt(0) lgkmcnt(0)
    v_mfma_f32_16x16x32_bf16 v[64:67], v[96:99], v[188:191], v[64:67]
    v_mfma_f32_16x16x32_bf16 v[68:71], v[100:103], v[188:191], v[68:71]
    v_mfma_f32_16x16x32_bf16 v[72:75], v[104:107], v[188:191], v[72:75]
    v_mfma_f32_16x16x32_bf16 v[76:79], v[108:111], v[188:191], v[76:79]
    s_nop 4
    v_cvt_pk_bf16_f32 v112, v64, v65
    v_cvt_pk_bf16_f32 v114, v68, v69
    v_cvt_pk_bf16_f32 v113, v66, v67
    v_cvt_pk_bf16_f32 v115, v70, v71
    v_cvt_pk_bf16_f32 v116, v72, v73
    v_cvt_pk_bf16_f32 v118, v76, v77
    v_cvt_pk_bf16_f32 v117, v74, v75
    v_cvt_pk_bf16_f32 v119, v78, v79
    v_permlane16_swap_b32 v112, v114
    v_permlane16_swap_b32 v113, v115
    ds_write_b128 v17, v[112:115]
    v_permlane16_swap_b32 v116, v118
    v_permlane16_swap_b32 v117, v119
    ds_write_b128 v18, v[116:119]
    ds_read_b128 v[120:123], v4 offset:0
    ds_read_b128 v[124:127], v4 offset:1024
    s_waitcnt lgkmcnt(1)
    buffer_store_dwordx4 v[120:123], v13, s[28:31], s84 offen
    s_waitcnt lgkmcnt(0)
    buffer_store_dwordx4 v[124:127], v13, s[28:31], s85 offen
L_tailpad:
L_end:
    s_endpgm
L_ro_2:
    buffer_load_dwordx2 v[14:15], v16, s[24:27], s87 offen sc1
    s_add_u32 s98, s98, 1
    s_cmp_lt_u32 s98, 400000
    s_cselect_b64 s[94:95], -1, 0
    s_waitcnt vmcnt(0)
    v_subrev_u32 v15, s85, v15
    v_cmp_lt_u32 vcc, 15, v15
    s_nop 0
    s_and_b64 vcc, vcc, s[94:95]
    s_cbranch_scc1 L_ro_2
    s_branch L_rb_3
L_slow_25:
    buffer_store_dwordx4 v[112:115], v1, s[24:27], s89 offen offset:0 sc1
    s_branch L_back_26
L_slow_27:
    buffer_store_dwordx4 v[116:119], v1, s[24:27], s89 offen offset:1024 sc1
    s_branch L_back_28
L_slow_29:
    s_waitcnt vmcnt(0)
    buffer_store_dwordx2 v[12:13], v6, s[24:27], s46 offen sc1
    s_branch L_back_30
L_slow_33:
    buffer_store_dwordx4 v[112:115], v16, s[4:7], s80 offen offset:0 sc1
    s_branch L_back_34
L_slow_35:
    buffer_store_dwordx4 v[116:119], v16, s[4:7], s80 offen offset:2048 sc1
    s_branch L_back_36
L_slow_37:
    s_mov_b64 exec, s[86:87]
    buffer_store_dword v12, v1, s[24:27], s81 offen sc1
    s_branch L_back_38
L_slow_39:
    s_waitcnt vmcnt(0)
    buffer_store_dwordx2 v[28:29], v6, s[24:27], s82 offen sc1
    s_branch L_back_40
L_ro_42:
    buffer_load_dwordx4 v[112:115], v1, s[24:27], s72 offen offset:0 sc1
    buffer_load_dwordx4 v[116:119], v1, s[24:27], s72 offen offset:1024 sc1
    s_add_u32 s98, s98, 1
    s_cmp_lt_u32 s98, 400000
    s_cselect_b64 s[94:95], -1, 0
    s_waitcnt vmcnt(0)
    v_bitop3_b32 v14, v112, v113, v114 bitop3:0x80
    v_bitop3_b32 v14, v14, v115, v116 bitop3:0x80
    v_bitop3_b32 v14, v14, v117, v118 bitop3:0x80
    v_bitop3_b32 v14, v14, v119, v119 bitop3:0x80
    v_and_b32 v14, 1, v14
    v_cmp_ne_u32 vcc, 1, v14
    s_nop 0
    s_and_b64 vcc, vcc, s[94:95]
    s_cbranch_scc1 L_ro_42
    s_branch L_rb_43
L_fb_61:
    v_mov_b32 v140, v28
    v_mov_b32 v141, v29
    v_mov_b32 v142, v30
    v_mov_b32 v143, v31
    s_sub_u32 s91, 3, s56
    s_mul_i32 s90, s91, 4352
    s_add_u32 s90, s90, s12
    s_add_u32 s90, s90, 4352
    s_lshl2_add_u32 s91, s65, s91
    s_call_b64 s[92:93], L_fallback
    s_nop 7
    s_nop 7
    v_mov_b32 v48, v144
    v_mov_b32 v49, v145
    v_mov_b32 v50, v146
    v_mov_b32 v51, v147
    v_mov_b32 v52, v148
    v_mov_b32 v53, v149
    v_mov_b32 v54, v150
    v_mov_b32 v55, v151
    v_mov_b32 v56, v152
    s_branch L_fbr_62
L_slow_63:
    buffer_store_dwordx4 v[124:127], v1, s[24:27], s9 offen sc1
    s_branch L_back_64
L_fb_65:
    v_mov_b32 v140, v24
    v_mov_b32 v141, v25
    v_mov_b32 v142, v26
    v_mov_b32 v143, v27
    s_mov_b32 s91, s56
    s_mul_i32 s90, s91, 4352
    s_add_u32 s90, s90, s12
    s_add_u32 s90, s90, 4352
    s_lshl2_add_u32 s91, s65, s91
    s_call_b64 s[92:93], L_fallback
    s_nop 7
    s_nop 7
    v_mov_b32 v32, v144
    v_mov_b32 v33, v145
    v_mov_b32 v34, v146
    v_mov_b32 v35, v147
    v_mov_b32 v36, v148
    v_mov_b32 v37, v149
    v_mov_b32 v38, v150
    v_mov_b32 v39, v151
    v_mov_b32 v40, v152
    s_branch L_fbr_66
L_slow_67:
    buffer_store_dwordx4 v[120:123], v1, s[24:27], s8 offen sc1
    s_branch L_back_68
L_slow_69:
    s_waitcnt vmcnt(0)
    buffer_store_dword v13, v6, s[24:27], s10 offen sc1
    buffer_store_dword v13, v6, s[24:27], s11 offen sc1
    s_branch L_back_70
L_slow_72:
    buffer_store_dwordx4 v[112:115], v16, s[4:7], s80 offen offset:0 sc1
    s_branch L_back_73
L_slow_74:
    buffer_store_dwordx4 v[116:119], v16, s[4:7], s80 offen offset:2048 sc1
    s_branch L_back_75
L_slow_76:
    s_mov_b64 exec, s[86:87]
    buffer_store_dword v12, v1, s[24:27], s81 offen sc1
    s_branch L_back_77
L_slow_78:
    s_waitcnt vmcnt(0)
    buffer_store_dwordx2 v[28:29], v6, s[24:27], s82 offen sc1
    s_branch L_back_79
L_ro_81:
    buffer_load_dwordx4 v[112:115], v1, s[24:27], s72 offen offset:0 sc1
    buffer_load_dwordx4 v[116:119], v1, s[24:27], s72 offen offset:1024 sc1
    s_add_u32 s98, s98, 1
    s_cmp_lt_u32 s98, 400000
    s_cselect_b64 s[94:95], -1, 0
    s_waitcnt vmcnt(0)
    v_bitop3_b32 v14, v112, v113, v114 bitop3:0xfe
    v_bitop3_b32 v14, v14, v115, v116 bitop3:0xfe
    v_bitop3_b32 v14, v14, v117, v118 bitop3:0xfe
    v_bitop3_b32 v14, v14, v119, v119 bitop3:0xfe
    v_and_b32 v14, 1, v14
    v_cmp_ne_u32 vcc, 0, v14
    s_nop 0
    s_and_b64 vcc, vcc, s[94:95]
    s_cbranch_scc1 L_ro_81
    s_branch L_rb_82
L_slow_103:
    buffer_store_dwordx4 v[112:115], v1, s[24:27], s89 offen offset:0 sc1
    s_branch L_back_104
L_slow_105:
    buffer_store_dwordx4 v[116:119], v1, s[24:27], s89 offen offset:1024 sc1
    s_branch L_back_106
L_slow_107:
    s_waitcnt vmcnt(0)
    buffer_store_dwordx2 v[12:13], v6, s[24:27], s46 offen sc1
    s_branch L_back_108
L_slow_110:
    buffer_store_dwordx4 v[112:115], v16, s[4:7], s80 offen offset:0 sc1
    s_branch L_back_111
L_slow_112:
    buffer_store_dwordx4 v[116:119], v16, s[4:7], s80 offen offset:2048 sc1
    s_branch L_back_113
L_slow_114:
    s_mov_b64 exec, s[86:87]
    buffer_store_dword v12, v1, s[24:27], s81 offen sc1
    s_branch L_back_115
L_slow_116:
    s_waitcnt vmcnt(0)
    buffer_store_dwordx2 v[28:29], v6, s[24:27], s82 offen sc1
    s_branch L_back_117
L_ro_119:
    buffer_load_dwordx4 v[112:115], v1, s[24:27], s72 offen offset:0 sc1
    buffer_load_dwordx4 v[116:119], v1, s[24:27], s72 offen offset:1024 sc1
    s_add_u32 s98, s98, 1
    s_cmp_lt_u32 s98, 400000
    s_cselect_b64 s[94:95], -1, 0
    s_waitcnt vmcnt(0)
    v_bitop3_b32 v14, v112, v113, v114 bitop3:0x80
    v_bitop3_b32 v14, v14, v115, v116 bitop3:0x80
    v_bitop3_b32 v14, v14, v117, v118 bitop3:0x80
    v_bitop3_b32 v14, v14, v119, v119 bitop3:0x80
    v_and_b32 v14, 1, v14
    v_cmp_ne_u32 vcc, 1, v14
    s_nop 0
    s_and_b64 vcc, vcc, s[94:95]
    s_cbranch_scc1 L_ro_119
    s_branch L_rb_120
L_slow_132:
    buffer_store_dwordx4 v[124:127], v1, s[24:27], s9 offen sc1
    s_branch L_back_133
L_slow_135:
    s_waitcnt vmcnt(0)
    buffer_store_dword v13, v6, s[24:27], s11 offen sc1
    s_branch L_back_136
L_slow_142:
    buffer_store_dwordx4 v[124:127], v1, s[24:27], s9 offen sc1
    s_branch L_back_143
L_slow_145:
    s_waitcnt vmcnt(0)
    buffer_store_dword v13, v6, s[24:27], s11 offen sc1
    s_branch L_back_146
L_fbb_147:
    v_mov_b32 v140, v28
    v_mov_b32 v141, v29
    v_mov_b32 v142, v30
    v_mov_b32 v143, v31
    s_sub_u32 s91, 3, s56
    s_mul_i32 s90, s91, 4352
    s_add_u32 s90, s90, s12
    s_add_u32 s90, s90, 4352
    s_lshl2_add_u32 s91, s65, s91
    s_call_b64 s[92:93], L_fallback
    s_nop 7
    s_nop 7
    v_mov_b32 v48, v144
    v_mov_b32 v49, v145
    v_mov_b32 v50, v146
    v_mov_b32 v51, v147
    v_mov_b32 v52, v148
    v_mov_b32 v53, v149
    v_mov_b32 v54, v150
    v_mov_b32 v55, v151
    v_mov_b32 v56, v152
    v_rcp_f32 v56, v56
    s_nop 0
    v_pk_mul_f32 v[48:49], v[48:49], v[56:57] op_sel_hi:[1,0]
    v_pk_mul_f32 v[50:51], v[50:51], v[56:57] op_sel_hi:[1,0]
    v_pk_mul_f32 v[52:53], v[52:53], v[56:57] op_sel_hi:[1,0]
    v_pk_mul_f32 v[54:55], v[54:55], v[56:57] op_sel_hi:[1,0]
    v_cvt_pk_bf16_f32 v124, v48, v49
    v_cvt_pk_bf16_f32 v125, v50, v51
    v_cvt_pk_bf16_f32 v126, v52, v53
    v_cvt_pk_bf16_f32 v127, v54, v55
    s_cmp_lg_u32 s76, 0
    s_cbranch_scc1 L_fbs_149
    buffer_store_dwordx4 v[124:127], v1, s[24:27], s9 offen
    s_waitcnt vmcnt(0)
    s_mov_b64 exec, 1
    buffer_store_dword v13, v6, s[24:27], s11 offen
    s_branch L_fbt_150
L_fbs_149:
    buffer_store_dwordx4 v[124:127], v1, s[24:27], s9 offen sc1
    s_waitcnt vmcnt(0)
    s_mov_b64 exec, 1
    buffer_store_dword v13, v6, s[24:27], s11 offen sc1
L_fbt_150:
    s_mov_b64 exec, -1
    s_branch L_fbbr_148
L_fb_151:
    v_mov_b32 v140, v24
    v_mov_b32 v141, v25
    v_mov_b32 v142, v26
    v_mov_b32 v143, v27
    s_mov_b32 s91, s56
    s_mul_i32 s90, s91, 4352
    s_add_u32 s90, s90, s12
    s_add_u32 s90, s90, 4352
    s_lshl2_add_u32 s91, s65, s91
    s_call_b64 s[92:93], L_fallback
    s_nop 7
    s_nop 7
    v_mov_b32 v32, v144
    v_mov_b32 v33, v145
    v_mov_b32 v34, v146
    v_mov_b32 v35, v147
    v_mov_b32 v36, v148
    v_mov_b32 v37, v149
    v_mov_b32 v38, v150
    v_mov_b32 v39, v151
    v_mov_b32 v40, v152
    s_branch L_fbr_152
L_slow_153:
    buffer_store_dwordx4 v[120:123], v1, s[24:27], s8 offen sc1
    s_branch L_back_154
L_slow_155:
    s_waitcnt vmcnt(0)
    buffer_store_dword v13, v6, s[24:27], s10 offen sc1
    s_branch L_back_156
L_fallback:
    s_nop 7
    s_nop 7
    v_mov_b32 v168, 0xff800000
    v_mov_b32 v144, 0
    v_mov_b32 v145, 0
    v_mov_b32 v146, 0
    v_mov_b32 v147, 0
    v_mov_b32 v148, 0
    v_mov_b32 v149, 0
    v_mov_b32 v150, 0
    v_mov_b32 v151, 0
    v_mov_b32 v152, 0
    v_mov_b32 v153, 0
    v_mov_b32 v154, 0
    v_mov_b32 v155, 0
    v_mov_b32 v156, 0
    v_mov_b32 v157, 0
    v_mov_b32 v158, 0
    v_mov_b32 v159, 0
    s_mov_b32 s95, 0
    s_mov_b32 s94, s90
L_fb_loop0:
    buffer_load_dwordx4 v[128:131], v17, s[32:35], s94 offen sc1
    s_waitcnt vmcnt(0)
    s_cmp_eq_u32 s95, 0
    s_cbranch_scc1 L_fb_d0
    s_cmp_eq_u32 s95, 8
    s_cbranch_scc1 L_fb_f0
    v_mfma_f32_32x32x16_bf16 v[224:239], v[128:131], v[140:143], 0
    s_branch L_fb_j0
L_fb_d0:
    v_mfma_f32_32x32x16_bf16 v[224:239], v[128:131], v[140:143], v[80:95]
    s_branch L_fb_j0
L_fb_f0:
    v_mfma_f32_32x32x16_bf16 v[224:239], v[128:131], v[140:143], v[96:111]
L_fb_j0:
    s_nop 11
    v_max3_f32 v168, v168, v224, v225
    v_max3_f32 v168, v168, v226, v227
    v_max3_f32 v168, v168, v228, v229
    v_max3_f32 v168, v168, v230, v231
    v_max3_f32 v168, v168, v232, v233
    v_max3_f32 v168, v168, v234, v235
    v_max3_f32 v168, v168, v236, v237
    v_max3_f32 v168, v168, v238, v239
    s_sub_u32 s94, s94, 4352
    s_add_u32 s95, s95, 1
    s_cmp_gt_u32 s95, s91
    s_cbranch_scc1 L_fb_x0
    s_cmp_le_u32 s95, 8
    s_cbranch_scc1 L_fb_loop0
L_fb_x0:
    v_mov_b32 v169, v168
    s_nop 1
    v_permlane32_swap_b32 v168, v169
    v_max_f32 v168, v168, v169
    s_mov_b32 s95, 0
    s_mov_b32 s94, s90
L_fb_loop1:
    buffer_load_dwordx4 v[128:131], v17, s[32:35], s94 offen sc1
    buffer_load_dwordx4 v[132:135], v18, s[32:35], s94 offen offset:2048 sc1
    buffer_load_dwordx4 v[136:139], v18, s[32:35], s94 offen offset:3200 sc1
    s_waitcnt vmcnt(0)
    s_cmp_eq_u32 s95, 0
    s_cbranch_scc1 L_fb_d1
    s_cmp_eq_u32 s95, 8
    s_cbranch_scc1 L_fb_f1
    v_mfma_f32_32x32x16_bf16 v[224:239], v[128:131], v[140:143], 0
    s_branch L_fb_j1
L_fb_d1:
    v_mfma_f32_32x32x16_bf16 v[224:239], v[128:131], v[140:143], v[80:95]
    s_branch L_fb_j1
L_fb_f1:
    v_mfma_f32_32x32x16_bf16 v[224:239], v[128:131], v[140:143], v[96:111]
L_fb_j1:
    s_nop 11
    v_sub_f32 v224, v224, v168
    v_sub_f32 v225, v225, v168
    v_sub_f32 v226, v226, v168
    v_sub_f32 v227, v227, v168
    v_sub_f32 v228, v228, v168
    v_sub_f32 v229, v229, v168
    v_sub_f32 v230, v230, v168
    v_sub_f32 v231, v231, v168
    v_sub_f32 v232, v232, v168
    v_sub_f32 v233, v233, v168
    v_sub_f32 v234, v234, v168
    v_sub_f32 v235, v235, v168
    v_sub_f32 v236, v236, v168
    v_sub_f32 v237, v237, v168
    v_sub_f32 v238, v238, v168
    v_sub_f32 v239, v239, v168
    v_exp_f32 v224, v224
    v_exp_f32 v225, v225
    v_exp_f32 v226, v226
    v_exp_f32 v227, v227
    v_exp_f32 v228, v228
    v_exp_f32 v229, v229
    v_exp_f32 v230, v230
    v_exp_f32 v231, v231
    v_exp_f32 v232, v232
    v_exp_f32 v233, v233
    v_exp_f32 v234, v234
    v_exp_f32 v235, v235
    v_exp_f32 v236, v236
    v_exp_f32 v237, v237
    v_exp_f32 v238, v238
    v_exp_f32 v239, v239
    v_cvt_pk_bf16_f32 v160, v224, v225
    v_cvt_pk_bf16_f32 v161, v226, v227
    v_cvt_pk_bf16_f32 v162, v228, v229
    v_cvt_pk_bf16_f32 v163, v230, v231
    v_cvt_pk_bf16_f32 v164, v232, v233
    v_cvt_pk_bf16_f32 v165, v234, v235
    v_cvt_pk_bf16_f32 v166, v236, v237
    v_cvt_pk_bf16_f32 v167, v238, v239
    v_mfma_f32_32x32x16_bf16 v[144:159], v[132:135], v[160:163], v[144:159]
    s_nop 0
    v_mfma_f32_32x32x16_bf16 v[144:159], v[136:139], v[164:167], v[144:159]
    s_nop 7
    s_nop 7
    s_sub_u32 s94, s94, 4352
    s_add_u32 s95, s95, 1
    s_cmp_gt_u32 s95, s91
    s_cbranch_scc1 L_fb_x1
    s_cmp_le_u32 s95, 8
    s_cbranch_scc1 L_fb_loop1
L_fb_x1:
    s_setpc_b64 s[92:93]
L_codeend:
.fill 5120, 4, 0xbf810000
.section .rodata,"a"
.p2align 6
.amdhsa_kernel interleave_layers__linear_attn_block__sliding_block__prompt_kernel
.amdhsa_next_free_vgpr 512
.amdhsa_next_free_sgpr 102
.amdhsa_accum_offset 256
.amdhsa_group_segment_fixed_size 0
.amdhsa_kernarg_size 72
.amdhsa_user_sgpr_count 2
.amdhsa_user_sgpr_kernarg_segment_ptr 1
.amdhsa_system_sgpr_workgroup_id_x 1
.end_amdhsa_kernel
```
